```python
import torch

def _softmax(x, axis=-1):
    return torch.softmax(x, dim=axis)
def _gelu(x):
    return torch.nn.functional.gelu(x, approximate="tanh")
def _silu(x):
    return torch.nn.functional.silu(x)
def _sigmoid(x):
    return torch.sigmoid(x)
def _layernorm(x, axis=-1, eps=1e-5):
    m = x.mean(dim=axis, keepdim=True)
    v = x.var(dim=axis, keepdim=True, unbiased=False)
    return (x - m) / torch.sqrt(v + eps)
def _scatter_add(tgt, idx, src, axis=0):
    return tgt.clone().index_add_(axis, idx, src)
def _segment_sum(src, seg, n):
    out = torch.zeros((n,) + src.shape[1:], dtype=src.dtype)
    return out.index_add_(0, seg, src)
def _pad(x, pw):
    flat = tuple(v for pair in reversed(pw) for v in pair)
    return torch.nn.functional.pad(x, flat)

kernel_name = 'interleave_layers__ssm_conv_s4d__glu_gated_swiglu__prompt'

def setup_inputs():

    _w = (lambda a: (lambda t: t.to(torch.bfloat16) if t.is_floating_point() else t)(torch.as_tensor(a)))
    def _A_setup():
        Bsz, L, D, N = 1, 2048, 512, 128
        return {
            "u": _w((lambda *s: torch.randn(*s, dtype=torch.bfloat16) * 0.05)(Bsz, L, D)),
            "log_A_real": _w((lambda *s: torch.randn(*s, dtype=torch.bfloat16) * 3.2)(D, N) * 0.5),
            "A_imag": _w((lambda *s: torch.randn(*s, dtype=torch.bfloat16) * 0.05)(D, N) * 3.14),
            "C_real": _w((lambda *s: torch.randn(*s, dtype=torch.bfloat16) * 0.05)(D, N) / N ** 0.5),
            "C_imag": _w((lambda *s: torch.randn(*s, dtype=torch.bfloat16) * 0.05)(D, N) / N ** 0.5),
            "log_dt": _w((lambda *s: torch.randn(*s, dtype=torch.bfloat16) * 0.05)(D) * 0.5 - 4.0),
            "D_skip": _w((lambda *s: torch.randn(*s, dtype=torch.bfloat16) * 0.05)(D)),
        }
    _A_in = _A_setup()

    def _B_setup():
        B, S, D, F = 1, 2048, 512, 1376
        return {
            "x": _w((lambda *s: torch.randn(*s, dtype=torch.bfloat16) * 0.05)(B, S, D)),
            "w1": _w((lambda *s: torch.randn(*s, dtype=torch.bfloat16) * 0.4)(D, F) * (2.0 / D) ** 0.5),
            "w3": _w((lambda *s: torch.randn(*s, dtype=torch.bfloat16) * 0.4)(D, F) * (2.0 / D) ** 0.5),
            "w2": _w((lambda *s: torch.randn(*s, dtype=torch.bfloat16) * 0.4)(F, D) * (2.0 / F) ** 0.5),
        }
    _B_in = _B_setup()

    return {
        "A_u": _A_in["u"],
        "A_log_A_real": _A_in["log_A_real"],
        "A_A_imag": _A_in["A_imag"],
        "A_C_real": _A_in["C_real"],
        "A_C_imag": _A_in["C_imag"],
        "A_log_dt": _A_in["log_dt"],
        "A_D_skip": _A_in["D_skip"],
        "B_x": _B_in["x"],
        "B_w1": _B_in["w1"],
        "B_w3": _B_in["w3"],
        "B_w2": _B_in["w2"],
    }

def reference(A_u, A_log_A_real, A_A_imag, A_C_real, A_C_imag, A_log_dt, A_D_skip, B_x, B_w1, B_w3, B_w2):
    def _A_ref(u, log_A_real, A_imag, C_real, C_imag, log_dt, D_skip):
        L = u.shape[1]
        dt = torch.exp(log_dt)
        A = -torch.exp(log_A_real) + 1j * A_imag
        C = (C_real + 1j * C_imag) * dt[:, None]
        pos = (lambda x, dt: x.to(dt))(torch.arange(L), log_dt.dtype)
        P = torch.exp((A * dt[:, None])[:, :, None] * pos[None, None, :])
        K = 2.0 * torch.einsum("dn,dnl->dl", C, P).real
        L2 = 2 * L
        u_t = (lambda x, *d: x.permute(*d))(u, 0, 2, 1)
        Kf = (lambda x, *a, **k: torch.fft.rfft(x.float(), *a, **k))(K, L2)
        Uf = (lambda x, *a, **k: torch.fft.rfft(x.float(), *a, **k))(u_t, L2)
        y = (lambda x, *a, **k: torch.fft.irfft(x, *a, **k).to(torch.bfloat16))(Uf * Kf[None, :, :], L2)[:, :, :L]
        y = (lambda x, *d: x.permute(*d))(y, 0, 2, 1)
        return y + u * D_skip[None, None, :]

    def _B_ref(x, w1, w3, w2):
        gate = torch.einsum("bsd,df->bsf", x, w1)
        up = torch.einsum("bsd,df->bsf", x, w3)
        h = _silu(gate) * up
        out = torch.einsum("bsf,fd->bsd", h, w2)
        return out

    x = A_u
    x = x + _A_ref(_layernorm(x, axis=-1), A_log_A_real, A_A_imag, A_C_real, A_C_imag, A_log_dt, A_D_skip)
    x = x + _B_ref(_layernorm(x, axis=-1), B_w1, B_w3, B_w2)
    x = x + _A_ref(_layernorm(x, axis=-1), A_log_A_real, A_A_imag, A_C_real, A_C_imag, A_log_dt, A_D_skip)
    x = x + _B_ref(_layernorm(x, axis=-1), B_w1, B_w3, B_w2)
    return x
```

```asm
; @launch kernel=prep_kernel grid=(640,1,1) block=(256,1,1) lds=26624
; @launch kernel=conv1_kernel grid=(512,1,1) block=(256,1,1) lds=48416
; @launch kernel=gemm1a_kernel grid=(256,1,1) block=(704,1,1) lds=156672
; @launch kernel=gemm2a_kernel grid=(256,1,1) block=(256,1,1) lds=147456
; @launch kernel=conv2_kernel grid=(512,1,1) block=(256,1,1) lds=48416
; @launch kernel=gemm1b_kernel grid=(256,1,1) block=(704,1,1) lds=156672
; @launch kernel=gemm2b_kernel grid=(256,1,1) block=(256,1,1) lds=147456
.amdgcn_target "amdgcn-amd-amdhsa--gfx950"
.text
.globl prep_kernel
.p2align 8
.type prep_kernel,@function
prep_kernel:
    s_cmp_ge_u32 s2, 640
    s_cbranch_scc1 prep_end
    s_load_dwordx2 s[4:5], s[0:1], 0
    s_load_dwordx4 s[8:11], s[0:1], 8
    s_load_dwordx4 s[12:15], s[0:1], 24
    s_load_dwordx2 s[16:17], s[0:1], 40
    s_load_dwordx2 s[18:19], s[0:1], 104
    s_waitcnt lgkmcnt(0)
    s_cmp_lt_u32 s2, 128
    s_cbranch_scc1 prep_ln
    s_sub_u32 s20, s2, 128
    s_mov_b32 s24, s8
    s_mov_b32 s25, s9
    s_mov_b32 s26, 0x20000
    s_mov_b32 s27, 0x00020000
    s_mov_b32 s28, s10
    s_mov_b32 s29, s11
    s_mov_b32 s30, 0x20000
    s_mov_b32 s31, 0x00020000
    s_mov_b32 s32, s12
    s_mov_b32 s33, s13
    s_mov_b32 s34, 0x20000
    s_mov_b32 s35, 0x00020000
    s_mov_b32 s36, s14
    s_mov_b32 s37, s15
    s_mov_b32 s38, 0x20000
    s_mov_b32 s39, 0x00020000
    s_mov_b32 s40, s16
    s_mov_b32 s41, s17
    s_mov_b32 s42, 0x400
    s_mov_b32 s43, 0x00020000
    s_add_u32 s44, s18, 0x1400000
    s_addc_u32 s45, s19, 0
    s_mov_b32 s46, 0x480000
    s_mov_b32 s47, 0x00020000
    s_mov_b32 s60, 0x3fb8aa3b
    s_mov_b32 s61, 0x32a57060
    s_mov_b32 s62, 0x3f317218
    s_mov_b32 s63, 256
    v_and_b32 v1, 127, v0
    s_lshl_b32 s21, s20, 8
    v_lshlrev_b32 v2, 1, v1
    v_add_u32 v2, s21, v2
    buffer_load_ushort v3, v2, s[24:27], 0 offen
    buffer_load_ushort v4, v2, s[28:31], 0 offen
    buffer_load_ushort v5, v2, s[32:35], 0 offen
    buffer_load_ushort v6, v2, s[36:39], 0 offen
    s_lshl_b32 s21, s20, 1
    v_mov_b32 v7, s21
    buffer_load_ushort v7, v7, s[40:43], 0 offen
    s_waitcnt vmcnt(0)
    v_lshlrev_b32 v3, 16, v3
    v_lshlrev_b32 v4, 16, v4
    v_lshlrev_b32 v5, 16, v5
    v_lshlrev_b32 v6, 16, v6
    v_lshlrev_b32 v7, 16, v7
    v_mul_f32 v12, s60, v7
    v_fma_f32 v13, v7, s60, -v12
    v_fma_f32 v13, v7, s61, v13
    v_exp_f32 v8, v12
    v_mul_f32 v13, s62, v13
    v_fma_f32 v8, v8, v13, v8
    v_cvt_pk_bf16_f32 v8, v8, v8
    v_lshlrev_b32 v8, 16, v8
    v_mul_f32 v12, s60, v3
    v_fma_f32 v13, v3, s60, -v12
    v_fma_f32 v13, v3, s61, v13
    v_exp_f32 v9, v12
    v_mul_f32 v13, s62, v13
    v_fma_f32 v9, v9, v13, v9
    v_cvt_pk_bf16_f32 v9, v9, v9
    v_lshlrev_b32 v9, 16, v9
    v_mul_f32 v9, v9, v8
    v_mul_f32 v4, v4, v8
    v_mul_f32 v5, v5, v8
    v_mul_f32 v6, v6, v8
    v_mul_f32 v20, s60, v9
    v_sub_f32 v20, 0, v20
    v_mul_f32 v21, 0.15915494, v4
    v_add_f32 v22, v5, v5
    v_add_f32 v23, v6, v6
    v_lshlrev_b32 v2, 4, v1
    ds_write_b128 v2, v[20:23]
    v_and_b32 v10, 15, v0
    v_bfe_u32 v11, v0, 4, 2
    v_lshrrev_b32 v12, 6, v0
    v_lshlrev_b32 v12, 9, v12
    v_lshl_add_u32 v12, v11, 4, v12
    v_lshlrev_b32 v13, 3, v10
    v_cvt_f32_u32 v13, v13
    v_lshrrev_b32 v18, 3, v10
    v_lshlrev_b32 v18, 7, v18
    v_and_b32 v19, 7, v10
    v_or_b32 v14, v18, v19
    v_cvt_f32_u32 v14, v14
    v_lshrrev_b32 v18, 2, v10
    v_lshlrev_b32 v18, 7, v18
    v_and_b32 v19, 3, v10
    v_lshlrev_b32 v19, 1, v19
    v_add3_u32 v15, v18, v19, s63
    v_lshrrev_b32 v18, 1, v10
    v_lshlrev_b32 v18, 7, v18
    v_and_b32 v19, 1, v10
    v_lshlrev_b32 v19, 2, v19
    v_add_u32 v18, v18, v19
    v_cmp_lt_u32 vcc, 7, v10
    s_nop 1
    v_cndmask_b32 v15, v15, v18, vcc
    v_cvt_f32_u32 v15, v15
    v_lshlrev_b32 v18, 7, v10
    v_add_u32 v16, 0x400, v18
    v_cvt_f32_u32 v16, v16
    v_mov_b32 v40, 0
    v_mov_b32 v41, 0
    v_mov_b32 v42, 0
    v_mov_b32 v43, 0
    v_mov_b32 v44, 0
    v_mov_b32 v45, 0
    v_mov_b32 v46, 0
    v_mov_b32 v47, 0
    v_mov_b32 v48, 0
    v_mov_b32 v49, 0
    v_mov_b32 v50, 0
    v_mov_b32 v51, 0
    s_waitcnt lgkmcnt(0)
    s_barrier
    ds_read_b128 v[20:23], v12 offset:0
    s_waitcnt lgkmcnt(0)
    v_mul_f32 v32, v20, v13
    v_exp_f32 v32, v32
    v_mul_f32 v33, v21, v13
    v_fract_f32 v33, v33
    v_sin_f32 v34, v33
    v_cos_f32 v35, v33
    s_nop 0
    v_mul_f32 v24, v32, v35
    v_mul_f32 v25, v32, v34
    v_mul_f32 v32, v20, v14
    v_exp_f32 v32, v32
    v_mul_f32 v33, v21, v14
    v_fract_f32 v33, v33
    v_sin_f32 v34, v33
    v_cos_f32 v35, v33
    s_nop 0
    v_mul_f32 v26, v32, v35
    v_mul_f32 v27, v32, v34
    v_mul_f32 v28, v22, v26
    v_fma_f32 v28, -v23, v27, v28
    v_mul_f32 v29, v22, v27
    v_fma_f32 v29, -v23, v26, -v29
    s_nop 1
    v_mfma_f32_16x16x4_f32 v[40:43], v28, v24, v[40:43]
    v_mfma_f32_16x16x4_f32 v[40:43], v29, v25, v[40:43]
    v_mul_f32 v32, v20, v15
    v_exp_f32 v32, v32
    v_mul_f32 v33, v21, v15
    v_fract_f32 v33, v33
    v_sin_f32 v34, v33
    v_cos_f32 v35, v33
    s_nop 0
    v_mul_f32 v26, v32, v35
    v_mul_f32 v27, v32, v34
    v_mul_f32 v28, v22, v26
    v_fma_f32 v28, -v23, v27, v28
    v_mul_f32 v29, v22, v27
    v_fma_f32 v29, -v23, v26, -v29
    s_nop 1
    v_mfma_f32_16x16x4_f32 v[44:47], v28, v24, v[44:47]
    v_mfma_f32_16x16x4_f32 v[44:47], v29, v25, v[44:47]
    v_mul_f32 v32, v20, v16
    v_exp_f32 v32, v32
    v_mul_f32 v33, v21, v16
    v_fract_f32 v33, v33
    v_sin_f32 v34, v33
    v_cos_f32 v35, v33
    s_nop 0
    v_mul_f32 v26, v32, v35
    v_mul_f32 v27, v32, v34
    v_mul_f32 v28, v22, v26
    v_fma_f32 v28, -v23, v27, v28
    v_mul_f32 v29, v22, v27
    v_fma_f32 v29, -v23, v26, -v29
    s_nop 1
    v_mfma_f32_16x16x4_f32 v[48:51], v28, v24, v[48:51]
    v_mfma_f32_16x16x4_f32 v[48:51], v29, v25, v[48:51]
    ds_read_b128 v[20:23], v12 offset:64
    s_waitcnt lgkmcnt(0)
    v_mul_f32 v32, v20, v13
    v_exp_f32 v32, v32
    v_mul_f32 v33, v21, v13
    v_fract_f32 v33, v33
    v_sin_f32 v34, v33
    v_cos_f32 v35, v33
    s_nop 0
    v_mul_f32 v24, v32, v35
    v_mul_f32 v25, v32, v34
    v_mul_f32 v32, v20, v14
    v_exp_f32 v32, v32
    v_mul_f32 v33, v21, v14
    v_fract_f32 v33, v33
    v_sin_f32 v34, v33
    v_cos_f32 v35, v33
    s_nop 0
    v_mul_f32 v26, v32, v35
    v_mul_f32 v27, v32, v34
    v_mul_f32 v28, v22, v26
    v_fma_f32 v28, -v23, v27, v28
    v_mul_f32 v29, v22, v27
    v_fma_f32 v29, -v23, v26, -v29
    s_nop 1
    v_mfma_f32_16x16x4_f32 v[40:43], v28, v24, v[40:43]
    v_mfma_f32_16x16x4_f32 v[40:43], v29, v25, v[40:43]
    v_mul_f32 v32, v20, v15
    v_exp_f32 v32, v32
    v_mul_f32 v33, v21, v15
    v_fract_f32 v33, v33
    v_sin_f32 v34, v33
    v_cos_f32 v35, v33
    s_nop 0
    v_mul_f32 v26, v32, v35
    v_mul_f32 v27, v32, v34
    v_mul_f32 v28, v22, v26
    v_fma_f32 v28, -v23, v27, v28
    v_mul_f32 v29, v22, v27
    v_fma_f32 v29, -v23, v26, -v29
    s_nop 1
    v_mfma_f32_16x16x4_f32 v[44:47], v28, v24, v[44:47]
    v_mfma_f32_16x16x4_f32 v[44:47], v29, v25, v[44:47]
    v_mul_f32 v32, v20, v16
    v_exp_f32 v32, v32
    v_mul_f32 v33, v21, v16
    v_fract_f32 v33, v33
    v_sin_f32 v34, v33
    v_cos_f32 v35, v33
    s_nop 0
    v_mul_f32 v26, v32, v35
    v_mul_f32 v27, v32, v34
    v_mul_f32 v28, v22, v26
    v_fma_f32 v28, -v23, v27, v28
    v_mul_f32 v29, v22, v27
    v_fma_f32 v29, -v23, v26, -v29
    s_nop 1
    v_mfma_f32_16x16x4_f32 v[48:51], v28, v24, v[48:51]
    v_mfma_f32_16x16x4_f32 v[48:51], v29, v25, v[48:51]
    ds_read_b128 v[20:23], v12 offset:128
    s_waitcnt lgkmcnt(0)
    v_mul_f32 v32, v20, v13
    v_exp_f32 v32, v32
    v_mul_f32 v33, v21, v13
    v_fract_f32 v33, v33
    v_sin_f32 v34, v33
    v_cos_f32 v35, v33
    s_nop 0
    v_mul_f32 v24, v32, v35
    v_mul_f32 v25, v32, v34
    v_mul_f32 v32, v20, v14
    v_exp_f32 v32, v32
    v_mul_f32 v33, v21, v14
    v_fract_f32 v33, v33
    v_sin_f32 v34, v33
    v_cos_f32 v35, v33
    s_nop 0
    v_mul_f32 v26, v32, v35
    v_mul_f32 v27, v32, v34
    v_mul_f32 v28, v22, v26
    v_fma_f32 v28, -v23, v27, v28
    v_mul_f32 v29, v22, v27
    v_fma_f32 v29, -v23, v26, -v29
    s_nop 1
    v_mfma_f32_16x16x4_f32 v[40:43], v28, v24, v[40:43]
    v_mfma_f32_16x16x4_f32 v[40:43], v29, v25, v[40:43]
    v_mul_f32 v32, v20, v15
    v_exp_f32 v32, v32
    v_mul_f32 v33, v21, v15
    v_fract_f32 v33, v33
    v_sin_f32 v34, v33
    v_cos_f32 v35, v33
    s_nop 0
    v_mul_f32 v26, v32, v35
    v_mul_f32 v27, v32, v34
    v_mul_f32 v28, v22, v26
    v_fma_f32 v28, -v23, v27, v28
    v_mul_f32 v29, v22, v27
    v_fma_f32 v29, -v23, v26, -v29
    s_nop 1
    v_mfma_f32_16x16x4_f32 v[44:47], v28, v24, v[44:47]
    v_mfma_f32_16x16x4_f32 v[44:47], v29, v25, v[44:47]
    v_mul_f32 v32, v20, v16
    v_exp_f32 v32, v32
    v_mul_f32 v33, v21, v16
    v_fract_f32 v33, v33
    v_sin_f32 v34, v33
    v_cos_f32 v35, v33
    s_nop 0
    v_mul_f32 v26, v32, v35
    v_mul_f32 v27, v32, v34
    v_mul_f32 v28, v22, v26
    v_fma_f32 v28, -v23, v27, v28
    v_mul_f32 v29, v22, v27
    v_fma_f32 v29, -v23, v26, -v29
    s_nop 1
    v_mfma_f32_16x16x4_f32 v[48:51], v28, v24, v[48:51]
    v_mfma_f32_16x16x4_f32 v[48:51], v29, v25, v[48:51]
    ds_read_b128 v[20:23], v12 offset:192
    s_waitcnt lgkmcnt(0)
    v_mul_f32 v32, v20, v13
    v_exp_f32 v32, v32
    v_mul_f32 v33, v21, v13
    v_fract_f32 v33, v33
    v_sin_f32 v34, v33
    v_cos_f32 v35, v33
    s_nop 0
    v_mul_f32 v24, v32, v35
    v_mul_f32 v25, v32, v34
    v_mul_f32 v32, v20, v14
    v_exp_f32 v32, v32
    v_mul_f32 v33, v21, v14
    v_fract_f32 v33, v33
    v_sin_f32 v34, v33
    v_cos_f32 v35, v33
    s_nop 0
    v_mul_f32 v26, v32, v35
    v_mul_f32 v27, v32, v34
    v_mul_f32 v28, v22, v26
    v_fma_f32 v28, -v23, v27, v28
    v_mul_f32 v29, v22, v27
    v_fma_f32 v29, -v23, v26, -v29
    s_nop 1
    v_mfma_f32_16x16x4_f32 v[40:43], v28, v24, v[40:43]
    v_mfma_f32_16x16x4_f32 v[40:43], v29, v25, v[40:43]
    v_mul_f32 v32, v20, v15
    v_exp_f32 v32, v32
    v_mul_f32 v33, v21, v15
    v_fract_f32 v33, v33
    v_sin_f32 v34, v33
    v_cos_f32 v35, v33
    s_nop 0
    v_mul_f32 v26, v32, v35
    v_mul_f32 v27, v32, v34
    v_mul_f32 v28, v22, v26
    v_fma_f32 v28, -v23, v27, v28
    v_mul_f32 v29, v22, v27
    v_fma_f32 v29, -v23, v26, -v29
    s_nop 1
    v_mfma_f32_16x16x4_f32 v[44:47], v28, v24, v[44:47]
    v_mfma_f32_16x16x4_f32 v[44:47], v29, v25, v[44:47]
    v_mul_f32 v32, v20, v16
    v_exp_f32 v32, v32
    v_mul_f32 v33, v21, v16
    v_fract_f32 v33, v33
    v_sin_f32 v34, v33
    v_cos_f32 v35, v33
    s_nop 0
    v_mul_f32 v26, v32, v35
    v_mul_f32 v27, v32, v34
    v_mul_f32 v28, v22, v26
    v_fma_f32 v28, -v23, v27, v28
    v_mul_f32 v29, v22, v27
    v_fma_f32 v29, -v23, v26, -v29
    s_nop 1
    v_mfma_f32_16x16x4_f32 v[48:51], v28, v24, v[48:51]
    v_mfma_f32_16x16x4_f32 v[48:51], v29, v25, v[48:51]
    ds_read_b128 v[20:23], v12 offset:256
    s_waitcnt lgkmcnt(0)
    v_mul_f32 v32, v20, v13
    v_exp_f32 v32, v32
    v_mul_f32 v33, v21, v13
    v_fract_f32 v33, v33
    v_sin_f32 v34, v33
    v_cos_f32 v35, v33
    s_nop 0
    v_mul_f32 v24, v32, v35
    v_mul_f32 v25, v32, v34
    v_mul_f32 v32, v20, v14
    v_exp_f32 v32, v32
    v_mul_f32 v33, v21, v14
    v_fract_f32 v33, v33
    v_sin_f32 v34, v33
    v_cos_f32 v35, v33
    s_nop 0
    v_mul_f32 v26, v32, v35
    v_mul_f32 v27, v32, v34
    v_mul_f32 v28, v22, v26
    v_fma_f32 v28, -v23, v27, v28
    v_mul_f32 v29, v22, v27
    v_fma_f32 v29, -v23, v26, -v29
    s_nop 1
    v_mfma_f32_16x16x4_f32 v[40:43], v28, v24, v[40:43]
    v_mfma_f32_16x16x4_f32 v[40:43], v29, v25, v[40:43]
    v_mul_f32 v32, v20, v15
    v_exp_f32 v32, v32
    v_mul_f32 v33, v21, v15
    v_fract_f32 v33, v33
    v_sin_f32 v34, v33
    v_cos_f32 v35, v33
    s_nop 0
    v_mul_f32 v26, v32, v35
    v_mul_f32 v27, v32, v34
    v_mul_f32 v28, v22, v26
    v_fma_f32 v28, -v23, v27, v28
    v_mul_f32 v29, v22, v27
    v_fma_f32 v29, -v23, v26, -v29
    s_nop 1
    v_mfma_f32_16x16x4_f32 v[44:47], v28, v24, v[44:47]
    v_mfma_f32_16x16x4_f32 v[44:47], v29, v25, v[44:47]
    v_mul_f32 v32, v20, v16
    v_exp_f32 v32, v32
    v_mul_f32 v33, v21, v16
    v_fract_f32 v33, v33
    v_sin_f32 v34, v33
    v_cos_f32 v35, v33
    s_nop 0
    v_mul_f32 v26, v32, v35
    v_mul_f32 v27, v32, v34
    v_mul_f32 v28, v22, v26
    v_fma_f32 v28, -v23, v27, v28
    v_mul_f32 v29, v22, v27
    v_fma_f32 v29, -v23, v26, -v29
    s_nop 1
    v_mfma_f32_16x16x4_f32 v[48:51], v28, v24, v[48:51]
    v_mfma_f32_16x16x4_f32 v[48:51], v29, v25, v[48:51]
    ds_read_b128 v[20:23], v12 offset:320
    s_waitcnt lgkmcnt(0)
    v_mul_f32 v32, v20, v13
    v_exp_f32 v32, v32
    v_mul_f32 v33, v21, v13
    v_fract_f32 v33, v33
    v_sin_f32 v34, v33
    v_cos_f32 v35, v33
    s_nop 0
    v_mul_f32 v24, v32, v35
    v_mul_f32 v25, v32, v34
    v_mul_f32 v32, v20, v14
    v_exp_f32 v32, v32
    v_mul_f32 v33, v21, v14
    v_fract_f32 v33, v33
    v_sin_f32 v34, v33
    v_cos_f32 v35, v33
    s_nop 0
    v_mul_f32 v26, v32, v35
    v_mul_f32 v27, v32, v34
    v_mul_f32 v28, v22, v26
    v_fma_f32 v28, -v23, v27, v28
    v_mul_f32 v29, v22, v27
    v_fma_f32 v29, -v23, v26, -v29
    s_nop 1
    v_mfma_f32_16x16x4_f32 v[40:43], v28, v24, v[40:43]
    v_mfma_f32_16x16x4_f32 v[40:43], v29, v25, v[40:43]
    v_mul_f32 v32, v20, v15
    v_exp_f32 v32, v32
    v_mul_f32 v33, v21, v15
    v_fract_f32 v33, v33
    v_sin_f32 v34, v33
    v_cos_f32 v35, v33
    s_nop 0
    v_mul_f32 v26, v32, v35
    v_mul_f32 v27, v32, v34
    v_mul_f32 v28, v22, v26
    v_fma_f32 v28, -v23, v27, v28
    v_mul_f32 v29, v22, v27
    v_fma_f32 v29, -v23, v26, -v29
    s_nop 1
    v_mfma_f32_16x16x4_f32 v[44:47], v28, v24, v[44:47]
    v_mfma_f32_16x16x4_f32 v[44:47], v29, v25, v[44:47]
    v_mul_f32 v32, v20, v16
    v_exp_f32 v32, v32
    v_mul_f32 v33, v21, v16
    v_fract_f32 v33, v33
    v_sin_f32 v34, v33
    v_cos_f32 v35, v33
    s_nop 0
    v_mul_f32 v26, v32, v35
    v_mul_f32 v27, v32, v34
    v_mul_f32 v28, v22, v26
    v_fma_f32 v28, -v23, v27, v28
    v_mul_f32 v29, v22, v27
    v_fma_f32 v29, -v23, v26, -v29
    s_nop 1
    v_mfma_f32_16x16x4_f32 v[48:51], v28, v24, v[48:51]
    v_mfma_f32_16x16x4_f32 v[48:51], v29, v25, v[48:51]
    ds_read_b128 v[20:23], v12 offset:384
    s_waitcnt lgkmcnt(0)
    v_mul_f32 v32, v20, v13
    v_exp_f32 v32, v32
    v_mul_f32 v33, v21, v13
    v_fract_f32 v33, v33
    v_sin_f32 v34, v33
    v_cos_f32 v35, v33
    s_nop 0
    v_mul_f32 v24, v32, v35
    v_mul_f32 v25, v32, v34
    v_mul_f32 v32, v20, v14
    v_exp_f32 v32, v32
    v_mul_f32 v33, v21, v14
    v_fract_f32 v33, v33
    v_sin_f32 v34, v33
    v_cos_f32 v35, v33
    s_nop 0
    v_mul_f32 v26, v32, v35
    v_mul_f32 v27, v32, v34
    v_mul_f32 v28, v22, v26
    v_fma_f32 v28, -v23, v27, v28
    v_mul_f32 v29, v22, v27
    v_fma_f32 v29, -v23, v26, -v29
    s_nop 1
    v_mfma_f32_16x16x4_f32 v[40:43], v28, v24, v[40:43]
    v_mfma_f32_16x16x4_f32 v[40:43], v29, v25, v[40:43]
    v_mul_f32 v32, v20, v15
    v_exp_f32 v32, v32
    v_mul_f32 v33, v21, v15
    v_fract_f32 v33, v33
    v_sin_f32 v34, v33
    v_cos_f32 v35, v33
    s_nop 0
    v_mul_f32 v26, v32, v35
    v_mul_f32 v27, v32, v34
    v_mul_f32 v28, v22, v26
    v_fma_f32 v28, -v23, v27, v28
    v_mul_f32 v29, v22, v27
    v_fma_f32 v29, -v23, v26, -v29
    s_nop 1
    v_mfma_f32_16x16x4_f32 v[44:47], v28, v24, v[44:47]
    v_mfma_f32_16x16x4_f32 v[44:47], v29, v25, v[44:47]
    v_mul_f32 v32, v20, v16
    v_exp_f32 v32, v32
    v_mul_f32 v33, v21, v16
    v_fract_f32 v33, v33
    v_sin_f32 v34, v33
    v_cos_f32 v35, v33
    s_nop 0
    v_mul_f32 v26, v32, v35
    v_mul_f32 v27, v32, v34
    v_mul_f32 v28, v22, v26
    v_fma_f32 v28, -v23, v27, v28
    v_mul_f32 v29, v22, v27
    v_fma_f32 v29, -v23, v26, -v29
    s_nop 1
    v_mfma_f32_16x16x4_f32 v[48:51], v28, v24, v[48:51]
    v_mfma_f32_16x16x4_f32 v[48:51], v29, v25, v[48:51]
    ds_read_b128 v[20:23], v12 offset:448
    s_waitcnt lgkmcnt(0)
    v_mul_f32 v32, v20, v13
    v_exp_f32 v32, v32
    v_mul_f32 v33, v21, v13
    v_fract_f32 v33, v33
    v_sin_f32 v34, v33
    v_cos_f32 v35, v33
    s_nop 0
    v_mul_f32 v24, v32, v35
    v_mul_f32 v25, v32, v34
    v_mul_f32 v32, v20, v14
    v_exp_f32 v32, v32
    v_mul_f32 v33, v21, v14
    v_fract_f32 v33, v33
    v_sin_f32 v34, v33
    v_cos_f32 v35, v33
    s_nop 0
    v_mul_f32 v26, v32, v35
    v_mul_f32 v27, v32, v34
    v_mul_f32 v28, v22, v26
    v_fma_f32 v28, -v23, v27, v28
    v_mul_f32 v29, v22, v27
    v_fma_f32 v29, -v23, v26, -v29
    s_nop 1
    v_mfma_f32_16x16x4_f32 v[40:43], v28, v24, v[40:43]
    v_mfma_f32_16x16x4_f32 v[40:43], v29, v25, v[40:43]
    v_mul_f32 v32, v20, v15
    v_exp_f32 v32, v32
    v_mul_f32 v33, v21, v15
    v_fract_f32 v33, v33
    v_sin_f32 v34, v33
    v_cos_f32 v35, v33
    s_nop 0
    v_mul_f32 v26, v32, v35
    v_mul_f32 v27, v32, v34
    v_mul_f32 v28, v22, v26
    v_fma_f32 v28, -v23, v27, v28
    v_mul_f32 v29, v22, v27
    v_fma_f32 v29, -v23, v26, -v29
    s_nop 1
    v_mfma_f32_16x16x4_f32 v[44:47], v28, v24, v[44:47]
    v_mfma_f32_16x16x4_f32 v[44:47], v29, v25, v[44:47]
    v_mul_f32 v32, v20, v16
    v_exp_f32 v32, v32
    v_mul_f32 v33, v21, v16
    v_fract_f32 v33, v33
    v_sin_f32 v34, v33
    v_cos_f32 v35, v33
    s_nop 0
    v_mul_f32 v26, v32, v35
    v_mul_f32 v27, v32, v34
    v_mul_f32 v28, v22, v26
    v_fma_f32 v28, -v23, v27, v28
    v_mul_f32 v29, v22, v27
    v_fma_f32 v29, -v23, v26, -v29
    s_nop 1
    v_mfma_f32_16x16x4_f32 v[48:51], v28, v24, v[48:51]
    v_mfma_f32_16x16x4_f32 v[48:51], v29, v25, v[48:51]
    s_nop 15
    s_nop 7
    v_lshrrev_b32 v12, 6, v0
    v_mul_u32_u24 v12, 3072, v12
    v_and_b32 v18, 63, v0
    v_lshl_add_u32 v12, v18, 2, v12
    ds_write_b32 v12, v40 offset:2048
    ds_write_b32 v12, v41 offset:2304
    ds_write_b32 v12, v42 offset:2560
    ds_write_b32 v12, v43 offset:2816
    ds_write_b32 v12, v44 offset:3072
    ds_write_b32 v12, v45 offset:3328
    ds_write_b32 v12, v46 offset:3584
    ds_write_b32 v12, v47 offset:3840
    ds_write_b32 v12, v48 offset:4096
    ds_write_b32 v12, v49 offset:4352
    ds_write_b32 v12, v50 offset:4608
    ds_write_b32 v12, v51 offset:4864
    s_waitcnt lgkmcnt(0)
    s_barrier
    v_lshrrev_b32 v12, 6, v0
    v_and_b32 v18, 63, v0
    v_lshlrev_b32 v19, 8, v12
    v_lshl_add_u32 v19, v18, 2, v19
    v_lshrrev_b32 v30, 4, v18
    v_lshl_add_u32 v30, v30, 2, v12
    v_and_b32 v31, 15, v18
    v_lshlrev_b32 v31, 3, v31
    ds_read_b32 v32, v19 offset:2048
    ds_read_b32 v33, v19 offset:5120
    ds_read_b32 v34, v19 offset:8192
    ds_read_b32 v35, v19 offset:11264
    v_lshrrev_b32 v37, 3, v30
    v_lshlrev_b32 v37, 7, v37
    v_and_b32 v38, 7, v30
    v_or_b32 v36, v37, v38
    v_add_u32 v36, v36, v31
    v_lshlrev_b32 v36, 2, v36
    s_waitcnt lgkmcnt(0)
    v_add_f32 v32, v32, v33
    v_add_f32 v34, v34, v35
    v_add_f32 v32, v32, v34
    ds_write_b32 v36, v32 offset:14336
    ds_read_b32 v32, v19 offset:3072
    ds_read_b32 v33, v19 offset:6144
    ds_read_b32 v34, v19 offset:9216
    ds_read_b32 v35, v19 offset:12288
    v_lshrrev_b32 v37, 2, v30
    v_lshlrev_b32 v37, 7, v37
    v_and_b32 v38, 3, v30
    v_lshlrev_b32 v38, 1, v38
    v_add3_u32 v36, v37, v38, s63
    v_lshrrev_b32 v37, 1, v30
    v_lshlrev_b32 v37, 7, v37
    v_and_b32 v38, 1, v30
    v_lshlrev_b32 v38, 2, v38
    v_add_u32 v37, v37, v38
    v_cmp_lt_u32 vcc, 7, v30
    s_nop 1
    v_cndmask_b32 v36, v36, v37, vcc
    v_add_u32 v36, v36, v31
    v_lshlrev_b32 v36, 2, v36
    s_waitcnt lgkmcnt(0)
    v_add_f32 v32, v32, v33
    v_add_f32 v34, v34, v35
    v_add_f32 v32, v32, v34
    ds_write_b32 v36, v32 offset:14336
    ds_read_b32 v32, v19 offset:4096
    ds_read_b32 v33, v19 offset:7168
    ds_read_b32 v34, v19 offset:10240
    ds_read_b32 v35, v19 offset:13312
    v_lshlrev_b32 v37, 7, v30
    v_add_u32 v36, 0x400, v37
    v_add_u32 v36, v36, v31
    v_lshlrev_b32 v36, 2, v36
    s_waitcnt lgkmcnt(0)
    v_add_f32 v32, v32, v33
    v_add_f32 v34, v34, v35
    v_add_f32 v32, v32, v34
    ds_write_b32 v36, v32 offset:14336
    s_waitcnt lgkmcnt(0)
    s_barrier
    s_mul_i32 s21, s20, 9216
    v_lshlrev_b32 v12, 3, v0
    v_add_u32 v12, 0xffffff88, v12
    v_add_u32 v50, 0, v12
    v_cmp_gt_u32 vcc, 0x800, v50
    s_nop 1
    v_cndmask_b32 v60, 0, 1.0, vcc
    v_cndmask_b32 v50, 0, v50, vcc
    v_cvt_f32_u32 v50, v50
    v_add_u32 v51, 1, v12
    v_cmp_gt_u32 vcc, 0x800, v51
    s_nop 1
    v_cndmask_b32 v61, 0, 1.0, vcc
    v_cndmask_b32 v51, 0, v51, vcc
    v_cvt_f32_u32 v51, v51
    v_add_u32 v52, 2, v12
    v_cmp_gt_u32 vcc, 0x800, v52
    s_nop 1
    v_cndmask_b32 v62, 0, 1.0, vcc
    v_cndmask_b32 v52, 0, v52, vcc
    v_cvt_f32_u32 v52, v52
    v_add_u32 v53, 3, v12
    v_cmp_gt_u32 vcc, 0x800, v53
    s_nop 1
    v_cndmask_b32 v63, 0, 1.0, vcc
    v_cndmask_b32 v53, 0, v53, vcc
    v_cvt_f32_u32 v53, v53
    v_add_u32 v54, 4, v12
    v_cmp_gt_u32 vcc, 0x800, v54
    s_nop 1
    v_cndmask_b32 v64, 0, 1.0, vcc
    v_cndmask_b32 v54, 0, v54, vcc
    v_cvt_f32_u32 v54, v54
    v_add_u32 v55, 5, v12
    v_cmp_gt_u32 vcc, 0x800, v55
    s_nop 1
    v_cndmask_b32 v65, 0, 1.0, vcc
    v_cndmask_b32 v55, 0, v55, vcc
    v_cvt_f32_u32 v55, v55
    v_add_u32 v56, 6, v12
    v_cmp_gt_u32 vcc, 0x800, v56
    s_nop 1
    v_cndmask_b32 v66, 0, 1.0, vcc
    v_cndmask_b32 v56, 0, v56, vcc
    v_cvt_f32_u32 v56, v56
    v_add_u32 v57, 7, v12
    v_cmp_gt_u32 vcc, 0x800, v57
    s_nop 1
    v_cndmask_b32 v67, 0, 1.0, vcc
    v_cndmask_b32 v57, 0, v57, vcc
    v_cvt_f32_u32 v57, v57
    v_cvt_pk_bf16_f32 v50, v50, v51
    v_and_b32 v51, 0xffff0000, v50
    v_lshlrev_b32 v50, 16, v50
    v_cvt_pk_bf16_f32 v52, v52, v53
    v_and_b32 v53, 0xffff0000, v52
    v_lshlrev_b32 v52, 16, v52
    v_cvt_pk_bf16_f32 v54, v54, v55
    v_and_b32 v55, 0xffff0000, v54
    v_lshlrev_b32 v54, 16, v54
    v_cvt_pk_bf16_f32 v56, v56, v57
    v_and_b32 v57, 0xffff0000, v56
    v_lshlrev_b32 v56, 16, v56
    v_cvt_u32_f32 v50, v50
    v_lshlrev_b32 v50, 2, v50
    ds_read_b32 v50, v50 offset:14336
    v_cvt_u32_f32 v51, v51
    v_lshlrev_b32 v51, 2, v51
    ds_read_b32 v51, v51 offset:14336
    v_cvt_u32_f32 v52, v52
    v_lshlrev_b32 v52, 2, v52
    ds_read_b32 v52, v52 offset:14336
    v_cvt_u32_f32 v53, v53
    v_lshlrev_b32 v53, 2, v53
    ds_read_b32 v53, v53 offset:14336
    v_cvt_u32_f32 v54, v54
    v_lshlrev_b32 v54, 2, v54
    ds_read_b32 v54, v54 offset:14336
    v_cvt_u32_f32 v55, v55
    v_lshlrev_b32 v55, 2, v55
    ds_read_b32 v55, v55 offset:14336
    v_cvt_u32_f32 v56, v56
    v_lshlrev_b32 v56, 2, v56
    ds_read_b32 v56, v56 offset:14336
    v_cvt_u32_f32 v57, v57
    v_lshlrev_b32 v57, 2, v57
    ds_read_b32 v57, v57 offset:14336
    s_waitcnt lgkmcnt(0)
    v_mul_f32 v50, v50, v60
    v_mul_f32 v51, v51, v61
    v_mul_f32 v52, v52, v62
    v_mul_f32 v53, v53, v63
    v_mul_f32 v54, v54, v64
    v_mul_f32 v55, v55, v65
    v_mul_f32 v56, v56, v66
    v_mul_f32 v57, v57, v67
    v_cvt_pk_bf16_f32 v70, v50, v51
    v_lshlrev_b32 v60, 16, v70
    v_and_b32 v61, 0xffff0000, v70
    v_sub_f32 v60, v50, v60
    v_sub_f32 v61, v51, v61
    v_cvt_pk_bf16_f32 v74, v60, v61
    v_cvt_pk_bf16_f32 v71, v52, v53
    v_lshlrev_b32 v60, 16, v71
    v_and_b32 v61, 0xffff0000, v71
    v_sub_f32 v60, v52, v60
    v_sub_f32 v61, v53, v61
    v_cvt_pk_bf16_f32 v75, v60, v61
    v_cvt_pk_bf16_f32 v72, v54, v55
    v_lshlrev_b32 v60, 16, v72
    v_and_b32 v61, 0xffff0000, v72
    v_sub_f32 v60, v54, v60
    v_sub_f32 v61, v55, v61
    v_cvt_pk_bf16_f32 v76, v60, v61
    v_cvt_pk_bf16_f32 v73, v56, v57
    v_lshlrev_b32 v60, 16, v73
    v_and_b32 v61, 0xffff0000, v73
    v_sub_f32 v60, v56, v60
    v_sub_f32 v61, v57, v61
    v_cvt_pk_bf16_f32 v77, v60, v61
    v_lshlrev_b32 v12, 4, v0
    v_add_u32 v12, s21, v12
    buffer_store_dwordx4 v[70:73], v12, s[44:47], 0 offen
    v_add_u32 v12, 4608, v12
    buffer_store_dwordx4 v[74:77], v12, s[44:47], 0 offen
    v_cmp_gt_u32 vcc, 32, v0
    s_and_saveexec_b64 s[64:65], vcc
    s_cbranch_execz prep_kdone
    v_lshlrev_b32 v12, 3, v0
    v_add_u32 v12, 0x788, v12
    v_add_u32 v50, 0, v12
    v_cmp_gt_u32 vcc, 0x800, v50
    s_nop 1
    v_cndmask_b32 v60, 0, 1.0, vcc
    v_cndmask_b32 v50, 0, v50, vcc
    v_cvt_f32_u32 v50, v50
    v_add_u32 v51, 1, v12
    v_cmp_gt_u32 vcc, 0x800, v51
    s_nop 1
    v_cndmask_b32 v61, 0, 1.0, vcc
    v_cndmask_b32 v51, 0, v51, vcc
    v_cvt_f32_u32 v51, v51
    v_add_u32 v52, 2, v12
    v_cmp_gt_u32 vcc, 0x800, v52
    s_nop 1
    v_cndmask_b32 v62, 0, 1.0, vcc
    v_cndmask_b32 v52, 0, v52, vcc
    v_cvt_f32_u32 v52, v52
    v_add_u32 v53, 3, v12
    v_cmp_gt_u32 vcc, 0x800, v53
    s_nop 1
    v_cndmask_b32 v63, 0, 1.0, vcc
    v_cndmask_b32 v53, 0, v53, vcc
    v_cvt_f32_u32 v53, v53
    v_add_u32 v54, 4, v12
    v_cmp_gt_u32 vcc, 0x800, v54
    s_nop 1
    v_cndmask_b32 v64, 0, 1.0, vcc
    v_cndmask_b32 v54, 0, v54, vcc
    v_cvt_f32_u32 v54, v54
    v_add_u32 v55, 5, v12
    v_cmp_gt_u32 vcc, 0x800, v55
    s_nop 1
    v_cndmask_b32 v65, 0, 1.0, vcc
    v_cndmask_b32 v55, 0, v55, vcc
    v_cvt_f32_u32 v55, v55
    v_add_u32 v56, 6, v12
    v_cmp_gt_u32 vcc, 0x800, v56
    s_nop 1
    v_cndmask_b32 v66, 0, 1.0, vcc
    v_cndmask_b32 v56, 0, v56, vcc
    v_cvt_f32_u32 v56, v56
    v_add_u32 v57, 7, v12
    v_cmp_gt_u32 vcc, 0x800, v57
    s_nop 1
    v_cndmask_b32 v67, 0, 1.0, vcc
    v_cndmask_b32 v57, 0, v57, vcc
    v_cvt_f32_u32 v57, v57
    v_cvt_pk_bf16_f32 v50, v50, v51
    v_and_b32 v51, 0xffff0000, v50
    v_lshlrev_b32 v50, 16, v50
    v_cvt_pk_bf16_f32 v52, v52, v53
    v_and_b32 v53, 0xffff0000, v52
    v_lshlrev_b32 v52, 16, v52
    v_cvt_pk_bf16_f32 v54, v54, v55
    v_and_b32 v55, 0xffff0000, v54
    v_lshlrev_b32 v54, 16, v54
    v_cvt_pk_bf16_f32 v56, v56, v57
    v_and_b32 v57, 0xffff0000, v56
    v_lshlrev_b32 v56, 16, v56
    v_cvt_u32_f32 v50, v50
    v_lshlrev_b32 v50, 2, v50
    ds_read_b32 v50, v50 offset:14336
    v_cvt_u32_f32 v51, v51
    v_lshlrev_b32 v51, 2, v51
    ds_read_b32 v51, v51 offset:14336
    v_cvt_u32_f32 v52, v52
    v_lshlrev_b32 v52, 2, v52
    ds_read_b32 v52, v52 offset:14336
    v_cvt_u32_f32 v53, v53
    v_lshlrev_b32 v53, 2, v53
    ds_read_b32 v53, v53 offset:14336
    v_cvt_u32_f32 v54, v54
    v_lshlrev_b32 v54, 2, v54
    ds_read_b32 v54, v54 offset:14336
    v_cvt_u32_f32 v55, v55
    v_lshlrev_b32 v55, 2, v55
    ds_read_b32 v55, v55 offset:14336
    v_cvt_u32_f32 v56, v56
    v_lshlrev_b32 v56, 2, v56
    ds_read_b32 v56, v56 offset:14336
    v_cvt_u32_f32 v57, v57
    v_lshlrev_b32 v57, 2, v57
    ds_read_b32 v57, v57 offset:14336
    s_waitcnt lgkmcnt(0)
    v_mul_f32 v50, v50, v60
    v_mul_f32 v51, v51, v61
    v_mul_f32 v52, v52, v62
    v_mul_f32 v53, v53, v63
    v_mul_f32 v54, v54, v64
    v_mul_f32 v55, v55, v65
    v_mul_f32 v56, v56, v66
    v_mul_f32 v57, v57, v67
    v_cvt_pk_bf16_f32 v70, v50, v51
    v_lshlrev_b32 v60, 16, v70
    v_and_b32 v61, 0xffff0000, v70
    v_sub_f32 v60, v50, v60
    v_sub_f32 v61, v51, v61
    v_cvt_pk_bf16_f32 v74, v60, v61
    v_cvt_pk_bf16_f32 v71, v52, v53
    v_lshlrev_b32 v60, 16, v71
    v_and_b32 v61, 0xffff0000, v71
    v_sub_f32 v60, v52, v60
    v_sub_f32 v61, v53, v61
    v_cvt_pk_bf16_f32 v75, v60, v61
    v_cvt_pk_bf16_f32 v72, v54, v55
    v_lshlrev_b32 v60, 16, v72
    v_and_b32 v61, 0xffff0000, v72
    v_sub_f32 v60, v54, v60
    v_sub_f32 v61, v55, v61
    v_cvt_pk_bf16_f32 v76, v60, v61
    v_cvt_pk_bf16_f32 v73, v56, v57
    v_lshlrev_b32 v60, 16, v73
    v_and_b32 v61, 0xffff0000, v73
    v_sub_f32 v60, v56, v60
    v_sub_f32 v61, v57, v61
    v_cvt_pk_bf16_f32 v77, v60, v61
    v_lshlrev_b32 v12, 4, v0
    v_add_u32 v12, s21, v12
    v_add_u32 v12, 0x1000, v12
    buffer_store_dwordx4 v[70:73], v12, s[44:47], 0 offen
    v_add_u32 v12, 4608, v12
    buffer_store_dwordx4 v[74:77], v12, s[44:47], 0 offen
prep_kdone:
    s_mov_b64 exec, -1
    s_endpgm
prep_ln:
    s_mov_b32 s24, s4
    s_mov_b32 s25, s5
    s_mov_b32 s26, 0x200000
    s_mov_b32 s27, 0x00020000
    s_mov_b32 s28, s18
    s_mov_b32 s29, s19
    s_mov_b32 s30, 0x220000
    s_mov_b32 s31, 0x00020000
    s_add_u32 s32, s18, 0x1c00000
    s_addc_u32 s33, s19, 0
    s_mov_b32 s34, 0x8000
    s_mov_b32 s35, 0x00020000
    s_lshl_b32 s21, s2, 4
    v_lshrrev_b32 v1, 4, v0
    v_and_b32 v2, 15, v0
    v_add_u32 v3, s21, v1
    v_lshlrev_b32 v3, 10, v3
    v_lshl_add_u32 v3, v2, 4, v3
    buffer_load_dwordx4 v[8:11], v3, s[24:27], 0 offen
    buffer_load_dwordx4 v[12:15], v3, s[24:27], 0 offen offset:256
    buffer_load_dwordx4 v[16:19], v3, s[24:27], 0 offen offset:512
    buffer_load_dwordx4 v[20:23], v3, s[24:27], 0 offen offset:768
    v_mul_u32_u24 v4, 1040, v1
    v_lshl_add_u32 v4, v2, 4, v4
    v_mov_b32 v6, 0
    v_mov_b32 v7, 0
    s_waitcnt vmcnt(0)
    ds_write_b128 v4, v[8:11]
    ds_write_b128 v4, v[12:15] offset:256
    ds_write_b128 v4, v[16:19] offset:512
    ds_write_b128 v4, v[20:23] offset:768
    v_lshlrev_b32 v24, 16, v8
    v_and_b32 v25, 0xffff0000, v8
    v_add_f32 v6, v6, v24
    v_fma_f32 v7, v24, v24, v7
    v_add_f32 v6, v6, v25
    v_fma_f32 v7, v25, v25, v7
    v_lshlrev_b32 v24, 16, v9
    v_and_b32 v25, 0xffff0000, v9
    v_add_f32 v6, v6, v24
    v_fma_f32 v7, v24, v24, v7
    v_add_f32 v6, v6, v25
    v_fma_f32 v7, v25, v25, v7
    v_lshlrev_b32 v24, 16, v10
    v_and_b32 v25, 0xffff0000, v10
    v_add_f32 v6, v6, v24
    v_fma_f32 v7, v24, v24, v7
    v_add_f32 v6, v6, v25
    v_fma_f32 v7, v25, v25, v7
    v_lshlrev_b32 v24, 16, v11
    v_and_b32 v25, 0xffff0000, v11
    v_add_f32 v6, v6, v24
    v_fma_f32 v7, v24, v24, v7
    v_add_f32 v6, v6, v25
    v_fma_f32 v7, v25, v25, v7
    v_lshlrev_b32 v24, 16, v12
    v_and_b32 v25, 0xffff0000, v12
    v_add_f32 v6, v6, v24
    v_fma_f32 v7, v24, v24, v7
    v_add_f32 v6, v6, v25
    v_fma_f32 v7, v25, v25, v7
    v_lshlrev_b32 v24, 16, v13
    v_and_b32 v25, 0xffff0000, v13
    v_add_f32 v6, v6, v24
    v_fma_f32 v7, v24, v24, v7
    v_add_f32 v6, v6, v25
    v_fma_f32 v7, v25, v25, v7
    v_lshlrev_b32 v24, 16, v14
    v_and_b32 v25, 0xffff0000, v14
    v_add_f32 v6, v6, v24
    v_fma_f32 v7, v24, v24, v7
    v_add_f32 v6, v6, v25
    v_fma_f32 v7, v25, v25, v7
    v_lshlrev_b32 v24, 16, v15
    v_and_b32 v25, 0xffff0000, v15
    v_add_f32 v6, v6, v24
    v_fma_f32 v7, v24, v24, v7
    v_add_f32 v6, v6, v25
    v_fma_f32 v7, v25, v25, v7
    v_lshlrev_b32 v24, 16, v16
    v_and_b32 v25, 0xffff0000, v16
    v_add_f32 v6, v6, v24
    v_fma_f32 v7, v24, v24, v7
    v_add_f32 v6, v6, v25
    v_fma_f32 v7, v25, v25, v7
    v_lshlrev_b32 v24, 16, v17
    v_and_b32 v25, 0xffff0000, v17
    v_add_f32 v6, v6, v24
    v_fma_f32 v7, v24, v24, v7
    v_add_f32 v6, v6, v25
    v_fma_f32 v7, v25, v25, v7
    v_lshlrev_b32 v24, 16, v18
    v_and_b32 v25, 0xffff0000, v18
    v_add_f32 v6, v6, v24
    v_fma_f32 v7, v24, v24, v7
    v_add_f32 v6, v6, v25
    v_fma_f32 v7, v25, v25, v7
    v_lshlrev_b32 v24, 16, v19
    v_and_b32 v25, 0xffff0000, v19
    v_add_f32 v6, v6, v24
    v_fma_f32 v7, v24, v24, v7
    v_add_f32 v6, v6, v25
    v_fma_f32 v7, v25, v25, v7
    v_lshlrev_b32 v24, 16, v20
    v_and_b32 v25, 0xffff0000, v20
    v_add_f32 v6, v6, v24
    v_fma_f32 v7, v24, v24, v7
    v_add_f32 v6, v6, v25
    v_fma_f32 v7, v25, v25, v7
    v_lshlrev_b32 v24, 16, v21
    v_and_b32 v25, 0xffff0000, v21
    v_add_f32 v6, v6, v24
    v_fma_f32 v7, v24, v24, v7
    v_add_f32 v6, v6, v25
    v_fma_f32 v7, v25, v25, v7
    v_lshlrev_b32 v24, 16, v22
    v_and_b32 v25, 0xffff0000, v22
    v_add_f32 v6, v6, v24
    v_fma_f32 v7, v24, v24, v7
    v_add_f32 v6, v6, v25
    v_fma_f32 v7, v25, v25, v7
    v_lshlrev_b32 v24, 16, v23
    v_and_b32 v25, 0xffff0000, v23
    v_add_f32 v6, v6, v24
    v_fma_f32 v7, v24, v24, v7
    v_add_f32 v6, v6, v25
    v_fma_f32 v7, v25, v25, v7
    ds_swizzle_b32 v24, v6 offset:0x41f
    ds_swizzle_b32 v25, v7 offset:0x41f
    s_waitcnt lgkmcnt(0)
    v_add_f32 v6, v6, v24
    v_add_f32 v7, v7, v25
    ds_swizzle_b32 v24, v6 offset:0x81f
    ds_swizzle_b32 v25, v7 offset:0x81f
    s_waitcnt lgkmcnt(0)
    v_add_f32 v6, v6, v24
    v_add_f32 v7, v7, v25
    ds_swizzle_b32 v24, v6 offset:0x101f
    ds_swizzle_b32 v25, v7 offset:0x101f
    s_waitcnt lgkmcnt(0)
    v_add_f32 v6, v6, v24
    v_add_f32 v7, v7, v25
    ds_swizzle_b32 v24, v6 offset:0x201f
    ds_swizzle_b32 v25, v7 offset:0x201f
    s_waitcnt lgkmcnt(0)
    v_add_f32 v6, v6, v24
    v_add_f32 v7, v7, v25
    v_add_u32 v3, s21, v1
    v_lshlrev_b32 v3, 3, v3
    v_mov_b32 v24, 0
    v_mov_b32 v25, 0
    v_cmp_eq_u32 vcc, 0, v2
    s_and_saveexec_b64 s[64:65], vcc
    buffer_store_dwordx2 v[6:7], v3, s[32:35], 0 offen
    v_add_u32 v3, 0x4000, v3
    buffer_store_dwordx2 v[24:25], v3, s[32:35], 0 offen
    s_mov_b64 exec, s[64:65]
    s_waitcnt lgkmcnt(0)
    s_barrier
    v_lshlrev_b32 v4, 2, v0
    ds_read_b32 v8, v4 offset:0
    ds_read_b32 v9, v4 offset:1040
    ds_read_b32 v10, v4 offset:2080
    ds_read_b32 v11, v4 offset:3120
    ds_read_b32 v12, v4 offset:4160
    ds_read_b32 v13, v4 offset:5200
    ds_read_b32 v14, v4 offset:6240
    ds_read_b32 v15, v4 offset:7280
    ds_read_b32 v16, v4 offset:8320
    ds_read_b32 v17, v4 offset:9360
    ds_read_b32 v18, v4 offset:10400
    ds_read_b32 v19, v4 offset:11440
    ds_read_b32 v20, v4 offset:12480
    ds_read_b32 v21, v4 offset:13520
    ds_read_b32 v22, v4 offset:14560
    ds_read_b32 v23, v4 offset:15600
    s_mov_b32 s60, 0x05040100
    s_mov_b32 s61, 0x07060302
    s_waitcnt lgkmcnt(0)
    v_perm_b32 v24, v9, v8, s60
    v_perm_b32 v32, v9, v8, s61
    v_perm_b32 v25, v11, v10, s60
    v_perm_b32 v33, v11, v10, s61
    v_perm_b32 v26, v13, v12, s60
    v_perm_b32 v34, v13, v12, s61
    v_perm_b32 v27, v15, v14, s60
    v_perm_b32 v35, v15, v14, s61
    v_perm_b32 v28, v17, v16, s60
    v_perm_b32 v36, v17, v16, s61
    v_perm_b32 v29, v19, v18, s60
    v_perm_b32 v37, v19, v18, s61
    v_perm_b32 v30, v21, v20, s60
    v_perm_b32 v38, v21, v20, s61
    v_perm_b32 v31, v23, v22, s60
    v_perm_b32 v39, v23, v22, s61
    v_mul_u32_u24 v4, 8704, v0
    s_lshl_b32 s21, s2, 5
    v_add_u32 v4, s21, v4
    buffer_store_dwordx4 v[24:27], v4, s[28:31], 0 offen
    buffer_store_dwordx4 v[28:31], v4, s[28:31], 0 offen offset:16
    v_add_u32 v4, 4352, v4
    buffer_store_dwordx4 v[32:35], v4, s[28:31], 0 offen
    buffer_store_dwordx4 v[36:39], v4, s[28:31], 0 offen offset:16
    s_load_dwordx4 s[40:43], s[0:1], 64
    s_load_dwordx2 s[44:45], s[0:1], 80
    s_waitcnt lgkmcnt(0)
    s_mov_b32 s48, s40
    s_mov_b32 s49, s41
    s_mov_b32 s50, 0x158000
    s_mov_b32 s51, 0x00020000
    s_mov_b32 s52, s42
    s_mov_b32 s53, s43
    s_mov_b32 s54, 0x158000
    s_mov_b32 s55, 0x00020000
    s_mov_b32 s56, s44
    s_mov_b32 s57, s45
    s_mov_b32 s58, 0x158000
    s_mov_b32 s59, 0x00020000
    s_mul_i32 s21, s2, 11008
    v_lshl_add_u32 v4, v0, 4, s21
    buffer_load_dwordx4 v[40:43], v4, s[48:51], 0 offen offset:0
    buffer_load_dwordx4 v[52:55], v4, s[52:55], 0 offen offset:0
    buffer_load_dwordx4 v[64:67], v4, s[56:59], 0 offen offset:0
    v_add_u32 v5, 0x1000, v4
    v_add_u32 v6, 0x2000, v4
    buffer_load_dwordx4 v[52:55], v5, s[48:51], 0 offen
    buffer_load_dwordx4 v[56:59], v6, s[48:51], 0 offen
    buffer_load_dwordx4 v[52:55], v5, s[52:55], 0 offen
    buffer_load_dwordx4 v[56:59], v6, s[52:55], 0 offen
    buffer_load_dwordx4 v[52:55], v5, s[56:59], 0 offen
    buffer_load_dwordx4 v[56:59], v6, s[56:59], 0 offen
    s_waitcnt vmcnt(0)
prep_end:
    s_endpgm
.section .rodata,"a"
.p2align 6
.amdhsa_kernel prep_kernel
  .amdhsa_next_free_vgpr 80
  .amdhsa_next_free_sgpr 102
  .amdhsa_accum_offset 80
  .amdhsa_group_segment_fixed_size 0
  .amdhsa_kernarg_size 112
  .amdhsa_user_sgpr_count 2
  .amdhsa_user_sgpr_kernarg_segment_ptr 1
  .amdhsa_system_sgpr_workgroup_id_x 1
.end_amdhsa_kernel
.text
.globl conv1_kernel
.p2align 8
.type conv1_kernel,@function
conv1_kernel:
    s_cmp_ge_u32 s2, 512
    s_cbranch_scc1 conv1_kernel_end
    s_load_dwordx2 s[4:5], s[0:1], 48
    s_load_dwordx2 s[6:7], s[0:1], 104
    s_and_b32 s24, s2, 0x1fe
    s_lshl_b32 s24, s24, 1
    s_waitcnt lgkmcnt(0)
    s_load_dword s25, s[4:5], s24
    s_mov_b32 s8, s6
    s_mov_b32 s9, s7
    s_mov_b32 s10, 0x220000
    s_mov_b32 s11, 0x00020000
    s_add_u32 s12, s6, 0x300000
    s_addc_u32 s13, s7, 0
    s_mov_b32 s14, 0x220000
    s_mov_b32 s15, 0x00020000
    s_add_u32 s16, s6, 0x1400000
    s_addc_u32 s17, s7, 0
    s_mov_b32 s18, 0x480000
    s_mov_b32 s19, 0x00020000
    s_add_u32 s20, s6, 0x1c00000
    s_addc_u32 s21, s7, 0
    s_mov_b32 s22, 0x4000
    s_mov_b32 s23, 0x00020000
    s_mul_i32 s26, s2, 4352
    v_lshl_add_u32 v1, v0, 4, s26
    buffer_load_dwordx4 v[4:7], v1, s[8:11], 0 offen
    v_lshlrev_b32 v2, 6, v0
    buffer_load_dwordx4 v[32:35], v2, s[20:23], 0 offen
    buffer_load_dwordx4 v[36:39], v2, s[20:23], 0 offen offset:16
    buffer_load_dwordx4 v[40:43], v2, s[20:23], 0 offen offset:32
    buffer_load_dwordx4 v[44:47], v2, s[20:23], 0 offen offset:48
    s_mul_i32 s27, s2, 9216
    v_lshl_add_u32 v2, v0, 4, s27
    buffer_load_dwordx4 v[48:51], v2, s[16:19], 0 offen
    v_add_u32 v3, 0x1000, v2
    buffer_load_dwordx4 v[52:55], v3, s[16:19], 0 offen
    v_add_u32 v3, 0x2000, v2
    v_cmp_gt_u32 vcc, 64, v0
    s_and_saveexec_b64 s[28:29], vcc
    buffer_load_dwordx4 v[56:59], v3, s[16:19], 0 offen
    s_mov_b64 exec, s[28:29]
    v_mov_b32 v60, 0
    v_mov_b32 v61, 0
    v_mov_b32 v62, 0
    v_mov_b32 v63, 0
    v_lshrrev_b32 v3, 4, v0
    v_mul_u32_u24 v3, 4384, v3
    v_and_b32 v2, 15, v0
    v_lshl_add_u32 v3, v2, 4, v3
    v_cmp_gt_u32 vcc, 128, v0
    s_and_saveexec_b64 s[28:29], vcc
    ds_write_b128 v3, v[60:63] offset:4112
    s_mov_b64 exec, s[28:29]
    v_mov_b32 v3, 44288
    v_cmp_eq_u32 vcc, 0, v0
    s_and_saveexec_b64 s[28:29], vcc
    ds_write_b128 v3, v[60:63]
    s_mov_b64 exec, s[28:29]
    s_mov_b32 s30, 0x3b000000
    s_mov_b32 s31, 0x3727c5ac
    s_waitcnt vmcnt(3)
    v_lshlrev_b32 v8, 16, v4
    v_and_b32 v9, 0xffff0000, v4
    v_lshlrev_b32 v10, 16, v5
    v_and_b32 v11, 0xffff0000, v5
    v_lshlrev_b32 v12, 16, v6
    v_and_b32 v13, 0xffff0000, v6
    v_lshlrev_b32 v14, 16, v7
    v_and_b32 v15, 0xffff0000, v7
    v_mul_f32 v32, s30, v32
    v_mul_f32 v33, s30, v33
    v_fma_f32 v33, -v32, v32, v33
    v_max_f32 v33, 0, v33
    v_cvt_pk_bf16_f32 v32, v32, v33
    v_and_b32 v33, 0xffff0000, v32
    v_lshlrev_b32 v32, 16, v32
    v_add_f32 v33, s31, v33
    v_sub_f32 v16, v8, v32
    v_cvt_pk_bf16_f32 v33, v33, v16
    v_and_b32 v16, 0xffff0000, v33
    v_lshlrev_b32 v33, 16, v33
    v_sqrt_f32 v33, v33
    s_nop 0
    v_cvt_pk_bf16_f32 v33, v33, v33
    v_lshlrev_b32 v33, 16, v33
    v_rcp_f32 v32, v33
    s_nop 0
    v_mul_f32 v60, v16, v32
    v_fma_f32 v61, -v60, v33, v16
    v_fma_f32 v16, v61, v32, v60
    v_mul_f32 v34, s30, v34
    v_mul_f32 v35, s30, v35
    v_fma_f32 v35, -v34, v34, v35
    v_max_f32 v35, 0, v35
    v_cvt_pk_bf16_f32 v34, v34, v35
    v_and_b32 v35, 0xffff0000, v34
    v_lshlrev_b32 v34, 16, v34
    v_add_f32 v35, s31, v35
    v_sub_f32 v17, v9, v34
    v_cvt_pk_bf16_f32 v35, v35, v17
    v_and_b32 v17, 0xffff0000, v35
    v_lshlrev_b32 v35, 16, v35
    v_sqrt_f32 v35, v35
    s_nop 0
    v_cvt_pk_bf16_f32 v35, v35, v35
    v_lshlrev_b32 v35, 16, v35
    v_rcp_f32 v34, v35
    s_nop 0
    v_mul_f32 v60, v17, v34
    v_fma_f32 v61, -v60, v35, v17
    v_fma_f32 v17, v61, v34, v60
    v_mul_f32 v36, s30, v36
    v_mul_f32 v37, s30, v37
    v_fma_f32 v37, -v36, v36, v37
    v_max_f32 v37, 0, v37
    v_cvt_pk_bf16_f32 v36, v36, v37
    v_and_b32 v37, 0xffff0000, v36
    v_lshlrev_b32 v36, 16, v36
    v_add_f32 v37, s31, v37
    v_sub_f32 v18, v10, v36
    v_cvt_pk_bf16_f32 v37, v37, v18
    v_and_b32 v18, 0xffff0000, v37
    v_lshlrev_b32 v37, 16, v37
    v_sqrt_f32 v37, v37
    s_nop 0
    v_cvt_pk_bf16_f32 v37, v37, v37
    v_lshlrev_b32 v37, 16, v37
    v_rcp_f32 v36, v37
    s_nop 0
    v_mul_f32 v60, v18, v36
    v_fma_f32 v61, -v60, v37, v18
    v_fma_f32 v18, v61, v36, v60
    v_mul_f32 v38, s30, v38
    v_mul_f32 v39, s30, v39
    v_fma_f32 v39, -v38, v38, v39
    v_max_f32 v39, 0, v39
    v_cvt_pk_bf16_f32 v38, v38, v39
    v_and_b32 v39, 0xffff0000, v38
    v_lshlrev_b32 v38, 16, v38
    v_add_f32 v39, s31, v39
    v_sub_f32 v19, v11, v38
    v_cvt_pk_bf16_f32 v39, v39, v19
    v_and_b32 v19, 0xffff0000, v39
    v_lshlrev_b32 v39, 16, v39
    v_sqrt_f32 v39, v39
    s_nop 0
    v_cvt_pk_bf16_f32 v39, v39, v39
    v_lshlrev_b32 v39, 16, v39
    v_rcp_f32 v38, v39
    s_nop 0
    v_mul_f32 v60, v19, v38
    v_fma_f32 v61, -v60, v39, v19
    v_fma_f32 v19, v61, v38, v60
    v_mul_f32 v40, s30, v40
    v_mul_f32 v41, s30, v41
    v_fma_f32 v41, -v40, v40, v41
    v_max_f32 v41, 0, v41
    v_cvt_pk_bf16_f32 v40, v40, v41
    v_and_b32 v41, 0xffff0000, v40
    v_lshlrev_b32 v40, 16, v40
    v_add_f32 v41, s31, v41
    v_sub_f32 v20, v12, v40
    v_cvt_pk_bf16_f32 v41, v41, v20
    v_and_b32 v20, 0xffff0000, v41
    v_lshlrev_b32 v41, 16, v41
    v_sqrt_f32 v41, v41
    s_nop 0
    v_cvt_pk_bf16_f32 v41, v41, v41
    v_lshlrev_b32 v41, 16, v41
    v_rcp_f32 v40, v41
    s_nop 0
    v_mul_f32 v60, v20, v40
    v_fma_f32 v61, -v60, v41, v20
    v_fma_f32 v20, v61, v40, v60
    v_mul_f32 v42, s30, v42
    v_mul_f32 v43, s30, v43
    v_fma_f32 v43, -v42, v42, v43
    v_max_f32 v43, 0, v43
    v_cvt_pk_bf16_f32 v42, v42, v43
    v_and_b32 v43, 0xffff0000, v42
    v_lshlrev_b32 v42, 16, v42
    v_add_f32 v43, s31, v43
    v_sub_f32 v21, v13, v42
    v_cvt_pk_bf16_f32 v43, v43, v21
    v_and_b32 v21, 0xffff0000, v43
    v_lshlrev_b32 v43, 16, v43
    v_sqrt_f32 v43, v43
    s_nop 0
    v_cvt_pk_bf16_f32 v43, v43, v43
    v_lshlrev_b32 v43, 16, v43
    v_rcp_f32 v42, v43
    s_nop 0
    v_mul_f32 v60, v21, v42
    v_fma_f32 v61, -v60, v43, v21
    v_fma_f32 v21, v61, v42, v60
    v_mul_f32 v44, s30, v44
    v_mul_f32 v45, s30, v45
    v_fma_f32 v45, -v44, v44, v45
    v_max_f32 v45, 0, v45
    v_cvt_pk_bf16_f32 v44, v44, v45
    v_and_b32 v45, 0xffff0000, v44
    v_lshlrev_b32 v44, 16, v44
    v_add_f32 v45, s31, v45
    v_sub_f32 v22, v14, v44
    v_cvt_pk_bf16_f32 v45, v45, v22
    v_and_b32 v22, 0xffff0000, v45
    v_lshlrev_b32 v45, 16, v45
    v_sqrt_f32 v45, v45
    s_nop 0
    v_cvt_pk_bf16_f32 v45, v45, v45
    v_lshlrev_b32 v45, 16, v45
    v_rcp_f32 v44, v45
    s_nop 0
    v_mul_f32 v60, v22, v44
    v_fma_f32 v61, -v60, v45, v22
    v_fma_f32 v22, v61, v44, v60
    v_mul_f32 v46, s30, v46
    v_mul_f32 v47, s30, v47
    v_fma_f32 v47, -v46, v46, v47
    v_max_f32 v47, 0, v47
    v_cvt_pk_bf16_f32 v46, v46, v47
    v_and_b32 v47, 0xffff0000, v46
    v_lshlrev_b32 v46, 16, v46
    v_add_f32 v47, s31, v47
    v_sub_f32 v23, v15, v46
    v_cvt_pk_bf16_f32 v47, v47, v23
    v_and_b32 v23, 0xffff0000, v47
    v_lshlrev_b32 v47, 16, v47
    v_sqrt_f32 v47, v47
    s_nop 0
    v_cvt_pk_bf16_f32 v47, v47, v47
    v_lshlrev_b32 v47, 16, v47
    v_rcp_f32 v46, v47
    s_nop 0
    v_mul_f32 v60, v23, v46
    v_fma_f32 v61, -v60, v47, v23
    v_fma_f32 v23, v61, v46, v60
    v_cvt_pk_bf16_f32 v24, v16, v17
    v_cvt_pk_bf16_f32 v25, v18, v19
    v_cvt_pk_bf16_f32 v26, v20, v21
    v_cvt_pk_bf16_f32 v27, v22, v23
    v_lshlrev_b32 v16, 16, v24
    v_and_b32 v17, 0xffff0000, v24
    v_lshlrev_b32 v18, 16, v25
    v_and_b32 v19, 0xffff0000, v25
    v_lshlrev_b32 v20, 16, v26
    v_and_b32 v21, 0xffff0000, v26
    v_lshlrev_b32 v22, 16, v27
    v_and_b32 v23, 0xffff0000, v27
    v_lshlrev_b32 v3, 4, v0
    ds_write_b128 v3, v[24:27] offset:44304
    s_waitcnt vmcnt(0)
    ds_write_b128 v3, v[48:51] offset:35072
    ds_write_b128 v3, v[52:55] offset:39168
    v_cmp_gt_u32 vcc, 64, v0
    s_and_saveexec_b64 s[28:29], vcc
    ds_write_b128 v3, v[56:59] offset:43264
    s_mov_b64 exec, s[28:29]
    s_waitcnt lgkmcnt(0)
    s_barrier
    ds_read_b128 v[32:35], v3 offset:44288
    s_mov_b32 s31, 0xffff
    v_sub_u32 v2, 4096, v3
    s_waitcnt lgkmcnt(0)
    v_bfi_b32 v36, s31, v24, v35
    v_bfi_b32 v37, s31, v35, v34
    v_bfi_b32 v38, s31, v34, v33
    v_bfi_b32 v39, s31, v33, v32
    ds_write_b128 v2, v[36:39] offset:0
    v_alignbit_b32 v40, v24, v24, 16
    v_alignbit_b32 v41, v35, v35, 16
    v_alignbit_b32 v42, v34, v34, 16
    v_alignbit_b32 v43, v33, v33, 16
    ds_write_b128 v2, v[40:43] offset:4384
    v_bfi_b32 v36, s31, v25, v24
    v_bfi_b32 v37, s31, v24, v35
    v_bfi_b32 v38, s31, v35, v34
    v_bfi_b32 v39, s31, v34, v33
    ds_write_b128 v2, v[36:39] offset:8768
    v_alignbit_b32 v40, v25, v25, 16
    v_alignbit_b32 v41, v24, v24, 16
    v_alignbit_b32 v42, v35, v35, 16
    v_alignbit_b32 v43, v34, v34, 16
    ds_write_b128 v2, v[40:43] offset:13152
    v_bfi_b32 v36, s31, v26, v25
    v_bfi_b32 v37, s31, v25, v24
    v_bfi_b32 v38, s31, v24, v35
    v_bfi_b32 v39, s31, v35, v34
    ds_write_b128 v2, v[36:39] offset:17536
    v_alignbit_b32 v40, v26, v26, 16
    v_alignbit_b32 v41, v25, v25, 16
    v_alignbit_b32 v42, v24, v24, 16
    v_alignbit_b32 v43, v35, v35, 16
    ds_write_b128 v2, v[40:43] offset:21920
    v_bfi_b32 v36, s31, v27, v26
    v_bfi_b32 v37, s31, v26, v25
    v_bfi_b32 v38, s31, v25, v24
    v_bfi_b32 v39, s31, v24, v35
    ds_write_b128 v2, v[36:39] offset:26304
    v_alignbit_b32 v40, v27, v27, 16
    v_alignbit_b32 v41, v26, v26, 16
    v_alignbit_b32 v42, v25, v25, 16
    v_alignbit_b32 v43, v24, v24, 16
    ds_write_b128 v2, v[40:43] offset:30688
    v_and_b32 v1, 15, v0
    v_bfe_u32 v2, v0, 4, 2
    v_lshrrev_b32 v3, 6, v0
    v_add_u32 v4, v1, v2
    v_lshlrev_b32 v4, 4, v4
    v_lshl_add_u32 v4, v3, 7, v4
    v_and_b32 v5, 7, v1
    v_lshrrev_b32 v6, 3, v1
    v_lshlrev_b32 v7, 8, v6
    v_mul_u32_u24 v5, 4384, v5
    v_sub_u32 v5, v5, v7
    v_add_u32 v5, 272, v5
    v_lshl_add_u32 v5, v3, 7, v5
    v_lshl_add_u32 v5, v2, 4, v5
    s_waitcnt lgkmcnt(0)
    s_barrier
    v_mov_b32 v224, 0
    v_mov_b32 v225, 0
    v_mov_b32 v226, 0
    v_mov_b32 v227, 0
    v_mov_b32 v228, 0
    v_mov_b32 v229, 0
    v_mov_b32 v230, 0
    v_mov_b32 v231, 0
    v_mov_b32 v232, 0
    v_mov_b32 v233, 0
    v_mov_b32 v234, 0
    v_mov_b32 v235, 0
    v_mov_b32 v236, 0
    v_mov_b32 v237, 0
    v_mov_b32 v238, 0
    v_mov_b32 v239, 0
    v_mov_b32 v240, 0
    v_mov_b32 v241, 0
    v_mov_b32 v242, 0
    v_mov_b32 v243, 0
    v_mov_b32 v244, 0
    v_mov_b32 v245, 0
    v_mov_b32 v246, 0
    v_mov_b32 v247, 0
    v_mov_b32 v248, 0
    v_mov_b32 v249, 0
    v_mov_b32 v250, 0
    v_mov_b32 v251, 0
    v_mov_b32 v252, 0
    v_mov_b32 v253, 0
    v_mov_b32 v254, 0
    v_mov_b32 v255, 0
    ds_read_b128 v[96:99], v5 offset:3584
    ds_read_b128 v[32:35], v4 offset:35072
    ds_read_b128 v[64:67], v4 offset:39680
    ds_read_b128 v[100:103], v5 offset:3072
    ds_read_b128 v[36:39], v4 offset:35584
    ds_read_b128 v[68:71], v4 offset:40192
    ds_read_b128 v[104:107], v5 offset:2560
    ds_read_b128 v[40:43], v4 offset:36096
    ds_read_b128 v[72:75], v4 offset:40704
    ds_read_b128 v[108:111], v5 offset:2048
    ds_read_b128 v[44:47], v4 offset:36608
    ds_read_b128 v[76:79], v4 offset:41216
    s_waitcnt lgkmcnt(9)
    v_mfma_f32_16x16x32_bf16 v[224:227], v[32:35], v[96:99], v[224:227]
    v_mfma_f32_16x16x32_bf16 v[224:227], v[64:67], v[96:99], v[224:227]
    ds_read_b128 v[112:115], v5 offset:1536
    ds_read_b128 v[48:51], v4 offset:37120
    ds_read_b128 v[80:83], v4 offset:41728
    s_waitcnt lgkmcnt(9)
    v_mfma_f32_16x16x32_bf16 v[228:231], v[36:39], v[96:99], v[228:231]
    v_mfma_f32_16x16x32_bf16 v[232:235], v[36:39], v[100:103], v[232:235]
    v_mfma_f32_16x16x32_bf16 v[228:231], v[32:35], v[100:103], v[228:231]
    v_mfma_f32_16x16x32_bf16 v[228:231], v[68:71], v[96:99], v[228:231]
    v_mfma_f32_16x16x32_bf16 v[232:235], v[68:71], v[100:103], v[232:235]
    v_mfma_f32_16x16x32_bf16 v[228:231], v[64:67], v[100:103], v[228:231]
    ds_read_b128 v[116:119], v5 offset:1024
    ds_read_b128 v[52:55], v4 offset:37632
    ds_read_b128 v[84:87], v4 offset:42240
    s_waitcnt lgkmcnt(9)
    v_mfma_f32_16x16x32_bf16 v[232:235], v[40:43], v[96:99], v[232:235]
    v_mfma_f32_16x16x32_bf16 v[236:239], v[40:43], v[100:103], v[236:239]
    v_mfma_f32_16x16x32_bf16 v[240:243], v[40:43], v[104:107], v[240:243]
    v_mfma_f32_16x16x32_bf16 v[232:235], v[32:35], v[104:107], v[232:235]
    v_mfma_f32_16x16x32_bf16 v[236:239], v[36:39], v[104:107], v[236:239]
    v_mfma_f32_16x16x32_bf16 v[232:235], v[72:75], v[96:99], v[232:235]
    v_mfma_f32_16x16x32_bf16 v[236:239], v[72:75], v[100:103], v[236:239]
    v_mfma_f32_16x16x32_bf16 v[240:243], v[72:75], v[104:107], v[240:243]
    v_mfma_f32_16x16x32_bf16 v[232:235], v[64:67], v[104:107], v[232:235]
    v_mfma_f32_16x16x32_bf16 v[236:239], v[68:71], v[104:107], v[236:239]
    ds_read_b128 v[120:123], v5 offset:512
    ds_read_b128 v[56:59], v4 offset:38144
    ds_read_b128 v[88:91], v4 offset:42752
    s_waitcnt lgkmcnt(9)
    v_mfma_f32_16x16x32_bf16 v[236:239], v[44:47], v[96:99], v[236:239]
    v_mfma_f32_16x16x32_bf16 v[240:243], v[44:47], v[100:103], v[240:243]
    v_mfma_f32_16x16x32_bf16 v[244:247], v[44:47], v[104:107], v[244:247]
    v_mfma_f32_16x16x32_bf16 v[248:251], v[44:47], v[108:111], v[248:251]
    v_mfma_f32_16x16x32_bf16 v[236:239], v[32:35], v[108:111], v[236:239]
    v_mfma_f32_16x16x32_bf16 v[240:243], v[36:39], v[108:111], v[240:243]
    v_mfma_f32_16x16x32_bf16 v[244:247], v[40:43], v[108:111], v[244:247]
    v_mfma_f32_16x16x32_bf16 v[236:239], v[76:79], v[96:99], v[236:239]
    v_mfma_f32_16x16x32_bf16 v[240:243], v[76:79], v[100:103], v[240:243]
    v_mfma_f32_16x16x32_bf16 v[244:247], v[76:79], v[104:107], v[244:247]
    v_mfma_f32_16x16x32_bf16 v[248:251], v[76:79], v[108:111], v[248:251]
    v_mfma_f32_16x16x32_bf16 v[236:239], v[64:67], v[108:111], v[236:239]
    v_mfma_f32_16x16x32_bf16 v[240:243], v[68:71], v[108:111], v[240:243]
    v_mfma_f32_16x16x32_bf16 v[244:247], v[72:75], v[108:111], v[244:247]
    ds_read_b128 v[124:127], v5 offset:0
    ds_read_b128 v[60:63], v4 offset:38656
    ds_read_b128 v[92:95], v4 offset:43264
    s_waitcnt lgkmcnt(9)
    v_mfma_f32_16x16x32_bf16 v[240:243], v[48:51], v[96:99], v[240:243]
    v_mfma_f32_16x16x32_bf16 v[244:247], v[48:51], v[100:103], v[244:247]
    v_mfma_f32_16x16x32_bf16 v[248:251], v[48:51], v[104:107], v[248:251]
    v_mfma_f32_16x16x32_bf16 v[252:255], v[48:51], v[108:111], v[252:255]
    v_mfma_f32_16x16x32_bf16 v[240:243], v[32:35], v[112:115], v[240:243]
    v_mfma_f32_16x16x32_bf16 v[244:247], v[36:39], v[112:115], v[244:247]
    v_mfma_f32_16x16x32_bf16 v[248:251], v[40:43], v[112:115], v[248:251]
    v_mfma_f32_16x16x32_bf16 v[252:255], v[44:47], v[112:115], v[252:255]
    v_mfma_f32_16x16x32_bf16 v[240:243], v[80:83], v[96:99], v[240:243]
    v_mfma_f32_16x16x32_bf16 v[244:247], v[80:83], v[100:103], v[244:247]
    v_mfma_f32_16x16x32_bf16 v[248:251], v[80:83], v[104:107], v[248:251]
    v_mfma_f32_16x16x32_bf16 v[252:255], v[80:83], v[108:111], v[252:255]
    v_mfma_f32_16x16x32_bf16 v[240:243], v[64:67], v[112:115], v[240:243]
    v_mfma_f32_16x16x32_bf16 v[244:247], v[68:71], v[112:115], v[244:247]
    v_mfma_f32_16x16x32_bf16 v[248:251], v[72:75], v[112:115], v[248:251]
    v_mfma_f32_16x16x32_bf16 v[252:255], v[76:79], v[112:115], v[252:255]
    ds_read_b128 v[192:195], v5 offset:3648
    ds_read_b128 v[128:131], v4 offset:35136
    ds_read_b128 v[160:163], v4 offset:39744
    s_waitcnt lgkmcnt(9)
    v_mfma_f32_16x16x32_bf16 v[244:247], v[52:55], v[96:99], v[244:247]
    v_mfma_f32_16x16x32_bf16 v[248:251], v[52:55], v[100:103], v[248:251]
    v_mfma_f32_16x16x32_bf16 v[252:255], v[52:55], v[104:107], v[252:255]
    v_mfma_f32_16x16x32_bf16 v[244:247], v[32:35], v[116:119], v[244:247]
    v_mfma_f32_16x16x32_bf16 v[248:251], v[36:39], v[116:119], v[248:251]
    v_mfma_f32_16x16x32_bf16 v[252:255], v[40:43], v[116:119], v[252:255]
    v_mfma_f32_16x16x32_bf16 v[244:247], v[84:87], v[96:99], v[244:247]
    v_mfma_f32_16x16x32_bf16 v[248:251], v[84:87], v[100:103], v[248:251]
    v_mfma_f32_16x16x32_bf16 v[252:255], v[84:87], v[104:107], v[252:255]
    v_mfma_f32_16x16x32_bf16 v[244:247], v[64:67], v[116:119], v[244:247]
    v_mfma_f32_16x16x32_bf16 v[248:251], v[68:71], v[116:119], v[248:251]
    v_mfma_f32_16x16x32_bf16 v[252:255], v[72:75], v[116:119], v[252:255]
    ds_read_b128 v[196:199], v5 offset:3136
    ds_read_b128 v[132:135], v4 offset:35648
    ds_read_b128 v[164:167], v4 offset:40256
    s_waitcnt lgkmcnt(9)
    v_mfma_f32_16x16x32_bf16 v[248:251], v[56:59], v[96:99], v[248:251]
    v_mfma_f32_16x16x32_bf16 v[252:255], v[56:59], v[100:103], v[252:255]
    v_mfma_f32_16x16x32_bf16 v[248:251], v[32:35], v[120:123], v[248:251]
    v_mfma_f32_16x16x32_bf16 v[252:255], v[36:39], v[120:123], v[252:255]
    v_mfma_f32_16x16x32_bf16 v[248:251], v[88:91], v[96:99], v[248:251]
    v_mfma_f32_16x16x32_bf16 v[252:255], v[88:91], v[100:103], v[252:255]
    v_mfma_f32_16x16x32_bf16 v[248:251], v[64:67], v[120:123], v[248:251]
    v_mfma_f32_16x16x32_bf16 v[252:255], v[68:71], v[120:123], v[252:255]
    ds_read_b128 v[200:203], v5 offset:2624
    ds_read_b128 v[136:139], v4 offset:36160
    ds_read_b128 v[168:171], v4 offset:40768
    s_waitcnt lgkmcnt(9)
    v_mfma_f32_16x16x32_bf16 v[252:255], v[60:63], v[96:99], v[252:255]
    v_mfma_f32_16x16x32_bf16 v[252:255], v[32:35], v[124:127], v[252:255]
    v_mfma_f32_16x16x32_bf16 v[252:255], v[92:95], v[96:99], v[252:255]
    v_mfma_f32_16x16x32_bf16 v[252:255], v[64:67], v[124:127], v[252:255]
    ds_read_b128 v[204:207], v5 offset:2112
    ds_read_b128 v[140:143], v4 offset:36672
    ds_read_b128 v[172:175], v4 offset:41280
    s_waitcnt lgkmcnt(9)
    v_mfma_f32_16x16x32_bf16 v[224:227], v[128:131], v[192:195], v[224:227]
    v_mfma_f32_16x16x32_bf16 v[224:227], v[160:163], v[192:195], v[224:227]
    ds_read_b128 v[208:211], v5 offset:1600
    ds_read_b128 v[144:147], v4 offset:37184
    ds_read_b128 v[176:179], v4 offset:41792
    s_waitcnt lgkmcnt(9)
    v_mfma_f32_16x16x32_bf16 v[228:231], v[132:135], v[192:195], v[228:231]
    v_mfma_f32_16x16x32_bf16 v[232:235], v[132:135], v[196:199], v[232:235]
    v_mfma_f32_16x16x32_bf16 v[228:231], v[128:131], v[196:199], v[228:231]
    v_mfma_f32_16x16x32_bf16 v[228:231], v[164:167], v[192:195], v[228:231]
    v_mfma_f32_16x16x32_bf16 v[232:235], v[164:167], v[196:199], v[232:235]
    v_mfma_f32_16x16x32_bf16 v[228:231], v[160:163], v[196:199], v[228:231]
    ds_read_b128 v[212:215], v5 offset:1088
    ds_read_b128 v[148:151], v4 offset:37696
    ds_read_b128 v[180:183], v4 offset:42304
    s_waitcnt lgkmcnt(9)
    v_mfma_f32_16x16x32_bf16 v[232:235], v[136:139], v[192:195], v[232:235]
    v_mfma_f32_16x16x32_bf16 v[236:239], v[136:139], v[196:199], v[236:239]
    v_mfma_f32_16x16x32_bf16 v[240:243], v[136:139], v[200:203], v[240:243]
    v_mfma_f32_16x16x32_bf16 v[232:235], v[128:131], v[200:203], v[232:235]
    v_mfma_f32_16x16x32_bf16 v[236:239], v[132:135], v[200:203], v[236:239]
    v_mfma_f32_16x16x32_bf16 v[232:235], v[168:171], v[192:195], v[232:235]
    v_mfma_f32_16x16x32_bf16 v[236:239], v[168:171], v[196:199], v[236:239]
    v_mfma_f32_16x16x32_bf16 v[240:243], v[168:171], v[200:203], v[240:243]
    v_mfma_f32_16x16x32_bf16 v[232:235], v[160:163], v[200:203], v[232:235]
    v_mfma_f32_16x16x32_bf16 v[236:239], v[164:167], v[200:203], v[236:239]
    ds_read_b128 v[216:219], v5 offset:576
    ds_read_b128 v[152:155], v4 offset:38208
    ds_read_b128 v[184:187], v4 offset:42816
    s_waitcnt lgkmcnt(9)
    v_mfma_f32_16x16x32_bf16 v[236:239], v[140:143], v[192:195], v[236:239]
    v_mfma_f32_16x16x32_bf16 v[240:243], v[140:143], v[196:199], v[240:243]
    v_mfma_f32_16x16x32_bf16 v[244:247], v[140:143], v[200:203], v[244:247]
    v_mfma_f32_16x16x32_bf16 v[248:251], v[140:143], v[204:207], v[248:251]
    v_mfma_f32_16x16x32_bf16 v[236:239], v[128:131], v[204:207], v[236:239]
    v_mfma_f32_16x16x32_bf16 v[240:243], v[132:135], v[204:207], v[240:243]
    v_mfma_f32_16x16x32_bf16 v[244:247], v[136:139], v[204:207], v[244:247]
    v_mfma_f32_16x16x32_bf16 v[236:239], v[172:175], v[192:195], v[236:239]
    v_mfma_f32_16x16x32_bf16 v[240:243], v[172:175], v[196:199], v[240:243]
    v_mfma_f32_16x16x32_bf16 v[244:247], v[172:175], v[200:203], v[244:247]
    v_mfma_f32_16x16x32_bf16 v[248:251], v[172:175], v[204:207], v[248:251]
    v_mfma_f32_16x16x32_bf16 v[236:239], v[160:163], v[204:207], v[236:239]
    v_mfma_f32_16x16x32_bf16 v[240:243], v[164:167], v[204:207], v[240:243]
    v_mfma_f32_16x16x32_bf16 v[244:247], v[168:171], v[204:207], v[244:247]
    ds_read_b128 v[220:223], v5 offset:64
    ds_read_b128 v[156:159], v4 offset:38720
    ds_read_b128 v[188:191], v4 offset:43328
    s_waitcnt lgkmcnt(9)
    v_mfma_f32_16x16x32_bf16 v[240:243], v[144:147], v[192:195], v[240:243]
    v_mfma_f32_16x16x32_bf16 v[244:247], v[144:147], v[196:199], v[244:247]
    v_mfma_f32_16x16x32_bf16 v[248:251], v[144:147], v[200:203], v[248:251]
    v_mfma_f32_16x16x32_bf16 v[252:255], v[144:147], v[204:207], v[252:255]
    v_mfma_f32_16x16x32_bf16 v[240:243], v[128:131], v[208:211], v[240:243]
    v_mfma_f32_16x16x32_bf16 v[244:247], v[132:135], v[208:211], v[244:247]
    v_mfma_f32_16x16x32_bf16 v[248:251], v[136:139], v[208:211], v[248:251]
    v_mfma_f32_16x16x32_bf16 v[252:255], v[140:143], v[208:211], v[252:255]
    v_mfma_f32_16x16x32_bf16 v[240:243], v[176:179], v[192:195], v[240:243]
    v_mfma_f32_16x16x32_bf16 v[244:247], v[176:179], v[196:199], v[244:247]
    v_mfma_f32_16x16x32_bf16 v[248:251], v[176:179], v[200:203], v[248:251]
    v_mfma_f32_16x16x32_bf16 v[252:255], v[176:179], v[204:207], v[252:255]
    v_mfma_f32_16x16x32_bf16 v[240:243], v[160:163], v[208:211], v[240:243]
    v_mfma_f32_16x16x32_bf16 v[244:247], v[164:167], v[208:211], v[244:247]
    v_mfma_f32_16x16x32_bf16 v[248:251], v[168:171], v[208:211], v[248:251]
    v_mfma_f32_16x16x32_bf16 v[252:255], v[172:175], v[208:211], v[252:255]
    s_waitcnt lgkmcnt(6)
    v_mfma_f32_16x16x32_bf16 v[244:247], v[148:151], v[192:195], v[244:247]
    v_mfma_f32_16x16x32_bf16 v[248:251], v[148:151], v[196:199], v[248:251]
    v_mfma_f32_16x16x32_bf16 v[252:255], v[148:151], v[200:203], v[252:255]
    v_mfma_f32_16x16x32_bf16 v[244:247], v[128:131], v[212:215], v[244:247]
    v_mfma_f32_16x16x32_bf16 v[248:251], v[132:135], v[212:215], v[248:251]
    v_mfma_f32_16x16x32_bf16 v[252:255], v[136:139], v[212:215], v[252:255]
    v_mfma_f32_16x16x32_bf16 v[244:247], v[180:183], v[192:195], v[244:247]
    v_mfma_f32_16x16x32_bf16 v[248:251], v[180:183], v[196:199], v[248:251]
    v_mfma_f32_16x16x32_bf16 v[252:255], v[180:183], v[200:203], v[252:255]
    v_mfma_f32_16x16x32_bf16 v[244:247], v[160:163], v[212:215], v[244:247]
    v_mfma_f32_16x16x32_bf16 v[248:251], v[164:167], v[212:215], v[248:251]
    v_mfma_f32_16x16x32_bf16 v[252:255], v[168:171], v[212:215], v[252:255]
    s_waitcnt lgkmcnt(3)
    v_mfma_f32_16x16x32_bf16 v[248:251], v[152:155], v[192:195], v[248:251]
    v_mfma_f32_16x16x32_bf16 v[252:255], v[152:155], v[196:199], v[252:255]
    v_mfma_f32_16x16x32_bf16 v[248:251], v[128:131], v[216:219], v[248:251]
    v_mfma_f32_16x16x32_bf16 v[252:255], v[132:135], v[216:219], v[252:255]
    v_mfma_f32_16x16x32_bf16 v[248:251], v[184:187], v[192:195], v[248:251]
    v_mfma_f32_16x16x32_bf16 v[252:255], v[184:187], v[196:199], v[252:255]
    v_mfma_f32_16x16x32_bf16 v[248:251], v[160:163], v[216:219], v[248:251]
    v_mfma_f32_16x16x32_bf16 v[252:255], v[164:167], v[216:219], v[252:255]
    s_waitcnt lgkmcnt(0)
    v_mfma_f32_16x16x32_bf16 v[252:255], v[156:159], v[192:195], v[252:255]
    v_mfma_f32_16x16x32_bf16 v[252:255], v[128:131], v[220:223], v[252:255]
    v_mfma_f32_16x16x32_bf16 v[252:255], v[188:191], v[192:195], v[252:255]
    v_mfma_f32_16x16x32_bf16 v[252:255], v[160:163], v[220:223], v[252:255]
    s_nop 15
    s_barrier
    v_and_b32 v1, 15, v0
    v_bfe_u32 v2, v0, 4, 2
    v_lshrrev_b32 v3, 6, v0
    v_and_b32 v5, 7, v1
    v_lshrrev_b32 v6, 3, v1
    v_and_b32 v7, 1, v2
    v_lshlrev_b32 v7, 3, v7
    v_lshl_add_u32 v7, v6, 4, v7
    v_lshl_add_u32 v5, v6, 7, v5
    v_lshl_add_u32 v5, v2, 5, v5
    v_lshl_add_u32 v5, v3, 11, v5
    v_xor_b32 v32, 0, v7
    v_add_lshl_u32 v32, v32, v5, 2
    v_xor_b32 v33, 8, v7
    v_add_lshl_u32 v33, v33, v5, 2
    v_xor_b32 v34, 16, v7
    v_add_lshl_u32 v34, v34, v5, 2
    v_xor_b32 v35, 24, v7
    v_add_lshl_u32 v35, v35, v5, 2
    ds_write_b32 v32, v224 offset:0
    ds_write_b32 v33, v225 offset:0
    ds_write_b32 v34, v226 offset:0
    ds_write_b32 v35, v227 offset:0
    ds_write_b32 v32, v228 offset:1024
    ds_write_b32 v33, v229 offset:1024
    ds_write_b32 v34, v230 offset:1024
    ds_write_b32 v35, v231 offset:1024
    ds_write_b32 v32, v232 offset:2048
    ds_write_b32 v33, v233 offset:2048
    ds_write_b32 v34, v234 offset:2048
    ds_write_b32 v35, v235 offset:2048
    ds_write_b32 v32, v236 offset:3072
    ds_write_b32 v33, v237 offset:3072
    ds_write_b32 v34, v238 offset:3072
    ds_write_b32 v35, v239 offset:3072
    ds_write_b32 v32, v240 offset:4096
    ds_write_b32 v33, v241 offset:4096
    ds_write_b32 v34, v242 offset:4096
    ds_write_b32 v35, v243 offset:4096
    ds_write_b32 v32, v244 offset:5120
    ds_write_b32 v33, v245 offset:5120
    ds_write_b32 v34, v246 offset:5120
    ds_write_b32 v35, v247 offset:5120
    ds_write_b32 v32, v248 offset:6144
    ds_write_b32 v33, v249 offset:6144
    ds_write_b32 v34, v250 offset:6144
    ds_write_b32 v35, v251 offset:6144
    ds_write_b32 v32, v252 offset:7168
    ds_write_b32 v33, v253 offset:7168
    ds_write_b32 v34, v254 offset:7168
    ds_write_b32 v35, v255 offset:7168
    v_bfe_u32 v1, v0, 2, 1
    v_bfe_u32 v2, v0, 4, 1
    v_lshlrev_b32 v1, 3, v1
    v_lshl_add_u32 v1, v2, 4, v1
    v_lshlrev_b32 v2, 3, v0
    v_xor_b32 v1, v1, v2
    v_lshlrev_b32 v1, 2, v1
    s_waitcnt lgkmcnt(0)
    s_barrier
    ds_read_b128 v[32:35], v1 offset:0
    ds_read_b128 v[36:39], v1 offset:16
    ds_read_b128 v[40:43], v1 offset:8192
    ds_read_b128 v[44:47], v1 offset:8208
    ds_read_b128 v[48:51], v1 offset:16384
    ds_read_b128 v[52:55], v1 offset:16400
    ds_read_b128 v[56:59], v1 offset:24576
    ds_read_b128 v[60:63], v1 offset:24592
    s_and_b32 s24, s2, 1
    s_lshl_b32 s24, s24, 4
    s_lshr_b32 s25, s25, s24
    s_lshl_b32 s25, s25, 16
    s_waitcnt lgkmcnt(0)
    v_add_f32 v32, v32, v40
    v_add_f32 v48, v48, v56
    v_add_f32 v32, v32, v48
    v_mul_f32 v40, s25, v16
    v_cvt_pk_bf16_f32 v32, v32, v40
    v_and_b32 v40, 0xffff0000, v32
    v_lshlrev_b32 v32, 16, v32
    v_add_f32 v32, v32, v40
    v_cvt_pk_bf16_f32 v32, v32, v32
    v_lshlrev_b32 v32, 16, v32
    v_add_f32 v32, v32, v8
    v_add_f32 v33, v33, v41
    v_add_f32 v49, v49, v57
    v_add_f32 v33, v33, v49
    v_mul_f32 v41, s25, v17
    v_cvt_pk_bf16_f32 v33, v33, v41
    v_and_b32 v41, 0xffff0000, v33
    v_lshlrev_b32 v33, 16, v33
    v_add_f32 v33, v33, v41
    v_cvt_pk_bf16_f32 v33, v33, v33
    v_lshlrev_b32 v33, 16, v33
    v_add_f32 v33, v33, v9
    v_add_f32 v34, v34, v42
    v_add_f32 v50, v50, v58
    v_add_f32 v34, v34, v50
    v_mul_f32 v42, s25, v18
    v_cvt_pk_bf16_f32 v34, v34, v42
    v_and_b32 v42, 0xffff0000, v34
    v_lshlrev_b32 v34, 16, v34
    v_add_f32 v34, v34, v42
    v_cvt_pk_bf16_f32 v34, v34, v34
    v_lshlrev_b32 v34, 16, v34
    v_add_f32 v34, v34, v10
    v_add_f32 v35, v35, v43
    v_add_f32 v51, v51, v59
    v_add_f32 v35, v35, v51
    v_mul_f32 v43, s25, v19
    v_cvt_pk_bf16_f32 v35, v35, v43
    v_and_b32 v43, 0xffff0000, v35
    v_lshlrev_b32 v35, 16, v35
    v_add_f32 v35, v35, v43
    v_cvt_pk_bf16_f32 v35, v35, v35
    v_lshlrev_b32 v35, 16, v35
    v_add_f32 v35, v35, v11
    v_add_f32 v36, v36, v44
    v_add_f32 v52, v52, v60
    v_add_f32 v36, v36, v52
    v_mul_f32 v44, s25, v20
    v_cvt_pk_bf16_f32 v36, v36, v44
    v_and_b32 v44, 0xffff0000, v36
    v_lshlrev_b32 v36, 16, v36
    v_add_f32 v36, v36, v44
    v_cvt_pk_bf16_f32 v36, v36, v36
    v_lshlrev_b32 v36, 16, v36
    v_add_f32 v36, v36, v12
    v_add_f32 v37, v37, v45
    v_add_f32 v53, v53, v61
    v_add_f32 v37, v37, v53
    v_mul_f32 v45, s25, v21
    v_cvt_pk_bf16_f32 v37, v37, v45
    v_and_b32 v45, 0xffff0000, v37
    v_lshlrev_b32 v37, 16, v37
    v_add_f32 v37, v37, v45
    v_cvt_pk_bf16_f32 v37, v37, v37
    v_lshlrev_b32 v37, 16, v37
    v_add_f32 v37, v37, v13
    v_add_f32 v38, v38, v46
    v_add_f32 v54, v54, v62
    v_add_f32 v38, v38, v54
    v_mul_f32 v46, s25, v22
    v_cvt_pk_bf16_f32 v38, v38, v46
    v_and_b32 v46, 0xffff0000, v38
    v_lshlrev_b32 v38, 16, v38
    v_add_f32 v38, v38, v46
    v_cvt_pk_bf16_f32 v38, v38, v38
    v_lshlrev_b32 v38, 16, v38
    v_add_f32 v38, v38, v14
    v_add_f32 v39, v39, v47
    v_add_f32 v55, v55, v63
    v_add_f32 v39, v39, v55
    v_mul_f32 v47, s25, v23
    v_cvt_pk_bf16_f32 v39, v39, v47
    v_and_b32 v47, 0xffff0000, v39
    v_lshlrev_b32 v39, 16, v39
    v_add_f32 v39, v39, v47
    v_cvt_pk_bf16_f32 v39, v39, v39
    v_lshlrev_b32 v39, 16, v39
    v_add_f32 v39, v39, v15
    v_cvt_pk_bf16_f32 v40, v32, v33
    v_cvt_pk_bf16_f32 v41, v34, v35
    v_cvt_pk_bf16_f32 v42, v36, v37
    v_cvt_pk_bf16_f32 v43, v38, v39
    v_lshl_add_u32 v1, v0, 4, s26
    buffer_store_dwordx4 v[40:43], v1, s[12:15], 0 offen
conv1_kernel_end:
    s_endpgm
.section .rodata,"a"
.p2align 6
.amdhsa_kernel conv1_kernel
  .amdhsa_next_free_vgpr 256
  .amdhsa_next_free_sgpr 102
  .amdhsa_accum_offset 256
  .amdhsa_group_segment_fixed_size 0
  .amdhsa_kernarg_size 112
  .amdhsa_user_sgpr_count 2
  .amdhsa_user_sgpr_kernarg_segment_ptr 1
  .amdhsa_system_sgpr_workgroup_id_x 1
.end_amdhsa_kernel
.text
.globl gemm1a_kernel
.p2align 8
.type gemm1a_kernel,@function
gemm1a_kernel:
    s_cmp_ge_u32 s2, 256
    s_cbranch_scc1 gemm1a_kernel_end
    s_load_dwordx4 s[4:7], s[0:1], 64
    s_load_dwordx2 s[8:9], s[0:1], 104
    s_lshr_b32 s28, s2, 5
    s_and_b32 s29, s2, 31
    v_lshrrev_b32 v1, 6, v0
    s_nop 1
    v_readfirstlane_b32 s30, v1
    s_waitcnt lgkmcnt(0)
    s_mov_b32 s12, s4
    s_mov_b32 s13, s5
    s_mov_b32 s14, 0x158000
    s_mov_b32 s15, 0x00020000
    s_mov_b32 s16, s6
    s_mov_b32 s17, s7
    s_mov_b32 s18, 0x158000
    s_mov_b32 s19, 0x00020000
    s_add_u32 s20, s8, 0x300000
    s_addc_u32 s21, s9, 0
    s_mov_b32 s22, 0x220000
    s_mov_b32 s23, 0x00020000
    s_add_u32 s24, s8, 0xc00000
    s_addc_u32 s25, s9, 0
    s_mov_b32 s26, 0x580000
    s_mov_b32 s27, 0x00020000
    v_mul_u32_u24 v2, 2979, v0
    v_lshrrev_b32 v2, 16, v2
    v_mul_u32_u24 v3, 22, v2
    v_sub_u32 v3, v0, v3
    v_mul_u32_u24 v2, 2752, v2
    v_lshl_add_u32 v2, v3, 4, v2
    s_mul_i32 s31, s28, 352
    v_add_u32 v2, s31, v2
    s_lshl_b32 s32, s30, 10
    s_cmp_ge_u32 s30, 8
    s_cbranch_scc1 gemm1a_kernel_ln_dma
    v_and_b32 v4, 7, v0
    v_lshrrev_b32 v5, 3, v0
    s_lshl_b32 s35, s29, 7
    v_mul_u32_u24 v6, 4352, v5
    v_lshl_add_u32 v6, v4, 4, v6
    v_add_u32 v6, s35, v6
    buffer_load_dwordx4 v[32:35], v6, s[20:23], 0 offen
    v_add_u32 v6, 278528, v6
    buffer_load_dwordx4 v[36:39], v6, s[20:23], 0 offen
    v_add_u32 v6, 278528, v6
    buffer_load_dwordx4 v[40:43], v6, s[20:23], 0 offen
    v_add_u32 v6, 278528, v6
    buffer_load_dwordx4 v[44:47], v6, s[20:23], 0 offen
    v_add_u32 v6, 278528, v6
    buffer_load_dwordx4 v[48:51], v6, s[20:23], 0 offen
    v_add_u32 v6, 278528, v6
    buffer_load_dwordx4 v[52:55], v6, s[20:23], 0 offen
    v_add_u32 v6, 278528, v6
    buffer_load_dwordx4 v[56:59], v6, s[20:23], 0 offen
    v_add_u32 v6, 278528, v6
    buffer_load_dwordx4 v[60:63], v6, s[20:23], 0 offen
    v_mov_b32 v64, 0
    v_mov_b32 v65, 0
    v_mov_b32 v66, 0
    v_mov_b32 v67, 0
    v_mov_b32 v68, 0
    v_mov_b32 v69, 0
    v_mov_b32 v70, 0
    v_mov_b32 v71, 0
    v_mov_b32 v72, 0
    v_mov_b32 v73, 0
    v_mov_b32 v74, 0
    v_mov_b32 v75, 0
    v_mov_b32 v76, 0
    v_mov_b32 v77, 0
    v_mov_b32 v78, 0
    v_mov_b32 v79, 0
    s_waitcnt vmcnt(7)
    v_lshlrev_b32 v104, 16, v32
    v_and_b32 v105, 0xffff0000, v32
    v_pk_add_f32 v[64:65], v[64:65], v[104:105]
    v_pk_fma_f32 v[72:73], v[104:105], v[104:105], v[72:73]
    v_lshlrev_b32 v106, 16, v33
    v_and_b32 v107, 0xffff0000, v33
    v_pk_add_f32 v[66:67], v[66:67], v[106:107]
    v_pk_fma_f32 v[74:75], v[106:107], v[106:107], v[74:75]
    v_lshlrev_b32 v108, 16, v34
    v_and_b32 v109, 0xffff0000, v34
    v_pk_add_f32 v[68:69], v[68:69], v[108:109]
    v_pk_fma_f32 v[76:77], v[108:109], v[108:109], v[76:77]
    v_lshlrev_b32 v110, 16, v35
    v_and_b32 v111, 0xffff0000, v35
    v_pk_add_f32 v[70:71], v[70:71], v[110:111]
    v_pk_fma_f32 v[78:79], v[110:111], v[110:111], v[78:79]
    s_waitcnt vmcnt(6)
    v_lshlrev_b32 v112, 16, v36
    v_and_b32 v113, 0xffff0000, v36
    v_pk_add_f32 v[64:65], v[64:65], v[112:113]
    v_pk_fma_f32 v[72:73], v[112:113], v[112:113], v[72:73]
    v_lshlrev_b32 v114, 16, v37
    v_and_b32 v115, 0xffff0000, v37
    v_pk_add_f32 v[66:67], v[66:67], v[114:115]
    v_pk_fma_f32 v[74:75], v[114:115], v[114:115], v[74:75]
    v_lshlrev_b32 v116, 16, v38
    v_and_b32 v117, 0xffff0000, v38
    v_pk_add_f32 v[68:69], v[68:69], v[116:117]
    v_pk_fma_f32 v[76:77], v[116:117], v[116:117], v[76:77]
    v_lshlrev_b32 v118, 16, v39
    v_and_b32 v119, 0xffff0000, v39
    v_pk_add_f32 v[70:71], v[70:71], v[118:119]
    v_pk_fma_f32 v[78:79], v[118:119], v[118:119], v[78:79]
    s_waitcnt vmcnt(5)
    v_lshlrev_b32 v104, 16, v40
    v_and_b32 v105, 0xffff0000, v40
    v_pk_add_f32 v[64:65], v[64:65], v[104:105]
    v_pk_fma_f32 v[72:73], v[104:105], v[104:105], v[72:73]
    v_lshlrev_b32 v106, 16, v41
    v_and_b32 v107, 0xffff0000, v41
    v_pk_add_f32 v[66:67], v[66:67], v[106:107]
    v_pk_fma_f32 v[74:75], v[106:107], v[106:107], v[74:75]
    v_lshlrev_b32 v108, 16, v42
    v_and_b32 v109, 0xffff0000, v42
    v_pk_add_f32 v[68:69], v[68:69], v[108:109]
    v_pk_fma_f32 v[76:77], v[108:109], v[108:109], v[76:77]
    v_lshlrev_b32 v110, 16, v43
    v_and_b32 v111, 0xffff0000, v43
    v_pk_add_f32 v[70:71], v[70:71], v[110:111]
    v_pk_fma_f32 v[78:79], v[110:111], v[110:111], v[78:79]
    s_waitcnt vmcnt(4)
    v_lshlrev_b32 v112, 16, v44
    v_and_b32 v113, 0xffff0000, v44
    v_pk_add_f32 v[64:65], v[64:65], v[112:113]
    v_pk_fma_f32 v[72:73], v[112:113], v[112:113], v[72:73]
    v_lshlrev_b32 v114, 16, v45
    v_and_b32 v115, 0xffff0000, v45
    v_pk_add_f32 v[66:67], v[66:67], v[114:115]
    v_pk_fma_f32 v[74:75], v[114:115], v[114:115], v[74:75]
    v_lshlrev_b32 v116, 16, v46
    v_and_b32 v117, 0xffff0000, v46
    v_pk_add_f32 v[68:69], v[68:69], v[116:117]
    v_pk_fma_f32 v[76:77], v[116:117], v[116:117], v[76:77]
    v_lshlrev_b32 v118, 16, v47
    v_and_b32 v119, 0xffff0000, v47
    v_pk_add_f32 v[70:71], v[70:71], v[118:119]
    v_pk_fma_f32 v[78:79], v[118:119], v[118:119], v[78:79]
    s_waitcnt vmcnt(3)
    v_lshlrev_b32 v104, 16, v48
    v_and_b32 v105, 0xffff0000, v48
    v_pk_add_f32 v[64:65], v[64:65], v[104:105]
    v_pk_fma_f32 v[72:73], v[104:105], v[104:105], v[72:73]
    v_lshlrev_b32 v106, 16, v49
    v_and_b32 v107, 0xffff0000, v49
    v_pk_add_f32 v[66:67], v[66:67], v[106:107]
    v_pk_fma_f32 v[74:75], v[106:107], v[106:107], v[74:75]
    v_lshlrev_b32 v108, 16, v50
    v_and_b32 v109, 0xffff0000, v50
    v_pk_add_f32 v[68:69], v[68:69], v[108:109]
    v_pk_fma_f32 v[76:77], v[108:109], v[108:109], v[76:77]
    v_lshlrev_b32 v110, 16, v51
    v_and_b32 v111, 0xffff0000, v51
    v_pk_add_f32 v[70:71], v[70:71], v[110:111]
    v_pk_fma_f32 v[78:79], v[110:111], v[110:111], v[78:79]
    s_waitcnt vmcnt(2)
    v_lshlrev_b32 v112, 16, v52
    v_and_b32 v113, 0xffff0000, v52
    v_pk_add_f32 v[64:65], v[64:65], v[112:113]
    v_pk_fma_f32 v[72:73], v[112:113], v[112:113], v[72:73]
    v_lshlrev_b32 v114, 16, v53
    v_and_b32 v115, 0xffff0000, v53
    v_pk_add_f32 v[66:67], v[66:67], v[114:115]
    v_pk_fma_f32 v[74:75], v[114:115], v[114:115], v[74:75]
    v_lshlrev_b32 v116, 16, v54
    v_and_b32 v117, 0xffff0000, v54
    v_pk_add_f32 v[68:69], v[68:69], v[116:117]
    v_pk_fma_f32 v[76:77], v[116:117], v[116:117], v[76:77]
    v_lshlrev_b32 v118, 16, v55
    v_and_b32 v119, 0xffff0000, v55
    v_pk_add_f32 v[70:71], v[70:71], v[118:119]
    v_pk_fma_f32 v[78:79], v[118:119], v[118:119], v[78:79]
    s_waitcnt vmcnt(1)
    v_lshlrev_b32 v104, 16, v56
    v_and_b32 v105, 0xffff0000, v56
    v_pk_add_f32 v[64:65], v[64:65], v[104:105]
    v_pk_fma_f32 v[72:73], v[104:105], v[104:105], v[72:73]
    v_lshlrev_b32 v106, 16, v57
    v_and_b32 v107, 0xffff0000, v57
    v_pk_add_f32 v[66:67], v[66:67], v[106:107]
    v_pk_fma_f32 v[74:75], v[106:107], v[106:107], v[74:75]
    v_lshlrev_b32 v108, 16, v58
    v_and_b32 v109, 0xffff0000, v58
    v_pk_add_f32 v[68:69], v[68:69], v[108:109]
    v_pk_fma_f32 v[76:77], v[108:109], v[108:109], v[76:77]
    v_lshlrev_b32 v110, 16, v59
    v_and_b32 v111, 0xffff0000, v59
    v_pk_add_f32 v[70:71], v[70:71], v[110:111]
    v_pk_fma_f32 v[78:79], v[110:111], v[110:111], v[78:79]
    s_waitcnt vmcnt(0)
    v_lshlrev_b32 v112, 16, v60
    v_and_b32 v113, 0xffff0000, v60
    v_pk_add_f32 v[64:65], v[64:65], v[112:113]
    v_pk_fma_f32 v[72:73], v[112:113], v[112:113], v[72:73]
    v_lshlrev_b32 v114, 16, v61
    v_and_b32 v115, 0xffff0000, v61
    v_pk_add_f32 v[66:67], v[66:67], v[114:115]
    v_pk_fma_f32 v[74:75], v[114:115], v[114:115], v[74:75]
    v_lshlrev_b32 v116, 16, v62
    v_and_b32 v117, 0xffff0000, v62
    v_pk_add_f32 v[68:69], v[68:69], v[116:117]
    v_pk_fma_f32 v[76:77], v[116:117], v[116:117], v[76:77]
    v_lshlrev_b32 v118, 16, v63
    v_and_b32 v119, 0xffff0000, v63
    v_pk_add_f32 v[70:71], v[70:71], v[118:119]
    v_pk_fma_f32 v[78:79], v[118:119], v[118:119], v[78:79]
    s_branch gemm1a_kernel_ln_cont
gemm1a_kernel_ln_dma:
    s_sub_u32 s40, s30, 8
    v_and_b32 v17, 63, v0
    s_add_u32 s41, s40, 0
    s_lshl_b32 s44, s41, 10
    s_lshl_b32 s41, s41, 6
    v_add_u32 v18, s41, v17
    v_mul_u32_u24 v19, 2979, v18
    v_lshrrev_b32 v19, 16, v19
    v_mul_u32_u24 v20, 22, v19
    v_sub_u32 v20, v18, v20
    v_mul_u32_u24 v19, 2752, v19
    v_lshl_add_u32 v19, v20, 4, v19
    v_add_u32 v24, s31, v19
    s_add_u32 s41, s40, 3
    s_lshl_b32 s45, s41, 10
    s_lshl_b32 s41, s41, 6
    v_add_u32 v18, s41, v17
    v_mul_u32_u24 v19, 2979, v18
    v_lshrrev_b32 v19, 16, v19
    v_mul_u32_u24 v20, 22, v19
    v_sub_u32 v20, v18, v20
    v_mul_u32_u24 v19, 2752, v19
    v_lshl_add_u32 v19, v20, 4, v19
    v_add_u32 v25, s31, v19
    s_add_u32 s41, s40, 6
    s_lshl_b32 s46, s41, 10
    s_lshl_b32 s41, s41, 6
    v_add_u32 v18, s41, v17
    v_mul_u32_u24 v19, 2979, v18
    v_lshrrev_b32 v19, 16, v19
    v_mul_u32_u24 v20, 22, v19
    v_sub_u32 v20, v18, v20
    v_mul_u32_u24 v19, 2752, v19
    v_lshl_add_u32 v19, v20, 4, v19
    v_add_u32 v26, s31, v19
    s_add_u32 s41, s40, 9
    s_min_u32 s41, s41, 10
    s_lshl_b32 s47, s41, 10
    s_lshl_b32 s41, s41, 6
    v_add_u32 v18, s41, v17
    v_mul_u32_u24 v19, 2979, v18
    v_lshrrev_b32 v19, 16, v19
    v_mul_u32_u24 v20, 22, v19
    v_sub_u32 v20, v18, v20
    v_mul_u32_u24 v19, 2752, v19
    v_lshl_add_u32 v19, v20, 4, v19
    v_add_u32 v27, s31, v19
    s_add_u32 s33, s44, 65536
    s_mov_b32 m0, s33
    s_mov_b32 s34, 0
    buffer_load_dwordx4 v24, s[12:15], s34 offen lds
    s_add_u32 m0, s33, 11392
    s_nop 0
    buffer_load_dwordx4 v24, s[16:19], s34 offen lds
    s_add_u32 s33, s45, 65536
    s_mov_b32 m0, s33
    s_mov_b32 s34, 0
    buffer_load_dwordx4 v25, s[12:15], s34 offen lds
    s_add_u32 m0, s33, 11392
    s_nop 0
    buffer_load_dwordx4 v25, s[16:19], s34 offen lds
    s_add_u32 s33, s46, 65536
    s_mov_b32 m0, s33
    s_mov_b32 s34, 0
    buffer_load_dwordx4 v26, s[12:15], s34 offen lds
    s_add_u32 m0, s33, 11392
    s_nop 0
    buffer_load_dwordx4 v26, s[16:19], s34 offen lds
    s_add_u32 s33, s47, 65536
    s_mov_b32 m0, s33
    s_mov_b32 s34, 0
    buffer_load_dwordx4 v27, s[12:15], s34 offen lds
    s_add_u32 m0, s33, 11392
    s_nop 0
    buffer_load_dwordx4 v27, s[16:19], s34 offen lds
    s_add_u32 s33, s44, 88320
    s_mov_b32 m0, s33
    s_mov_b32 s34, 88064
    buffer_load_dwordx4 v24, s[12:15], s34 offen lds
    s_add_u32 m0, s33, 11392
    s_nop 0
    buffer_load_dwordx4 v24, s[16:19], s34 offen lds
    s_add_u32 s33, s45, 88320
    s_mov_b32 m0, s33
    s_mov_b32 s34, 88064
    buffer_load_dwordx4 v25, s[12:15], s34 offen lds
    s_add_u32 m0, s33, 11392
    s_nop 0
    buffer_load_dwordx4 v25, s[16:19], s34 offen lds
    s_add_u32 s33, s46, 88320
    s_mov_b32 m0, s33
    s_mov_b32 s34, 88064
    buffer_load_dwordx4 v26, s[12:15], s34 offen lds
    s_add_u32 m0, s33, 11392
    s_nop 0
    buffer_load_dwordx4 v26, s[16:19], s34 offen lds
    s_add_u32 s33, s47, 88320
    s_mov_b32 m0, s33
    s_mov_b32 s34, 88064
    buffer_load_dwordx4 v27, s[12:15], s34 offen lds
    s_add_u32 m0, s33, 11392
    s_nop 0
    buffer_load_dwordx4 v27, s[16:19], s34 offen lds
    s_add_u32 s33, s44, 111104
    s_mov_b32 m0, s33
    s_mov_b32 s34, 176128
    buffer_load_dwordx4 v24, s[12:15], s34 offen lds
    s_add_u32 m0, s33, 11392
    s_nop 0
    buffer_load_dwordx4 v24, s[16:19], s34 offen lds
    s_add_u32 s33, s45, 111104
    s_mov_b32 m0, s33
    s_mov_b32 s34, 176128
    buffer_load_dwordx4 v25, s[12:15], s34 offen lds
    s_add_u32 m0, s33, 11392
    s_nop 0
    buffer_load_dwordx4 v25, s[16:19], s34 offen lds
    s_add_u32 s33, s46, 111104
    s_mov_b32 m0, s33
    s_mov_b32 s34, 176128
    buffer_load_dwordx4 v26, s[12:15], s34 offen lds
    s_add_u32 m0, s33, 11392
    s_nop 0
    buffer_load_dwordx4 v26, s[16:19], s34 offen lds
    s_add_u32 s33, s47, 111104
    s_mov_b32 m0, s33
    s_mov_b32 s34, 176128
    buffer_load_dwordx4 v27, s[12:15], s34 offen lds
    s_add_u32 m0, s33, 11392
    s_nop 0
    buffer_load_dwordx4 v27, s[16:19], s34 offen lds
    s_branch gemm1a_kernel_ln_skip1
gemm1a_kernel_ln_cont:
    ds_swizzle_b32 v80, v64 offset:0x201f
    ds_swizzle_b32 v81, v65 offset:0x201f
    ds_swizzle_b32 v82, v66 offset:0x201f
    ds_swizzle_b32 v83, v67 offset:0x201f
    ds_swizzle_b32 v84, v68 offset:0x201f
    ds_swizzle_b32 v85, v69 offset:0x201f
    ds_swizzle_b32 v86, v70 offset:0x201f
    ds_swizzle_b32 v87, v71 offset:0x201f
    ds_swizzle_b32 v88, v72 offset:0x201f
    ds_swizzle_b32 v89, v73 offset:0x201f
    ds_swizzle_b32 v90, v74 offset:0x201f
    ds_swizzle_b32 v91, v75 offset:0x201f
    ds_swizzle_b32 v92, v76 offset:0x201f
    ds_swizzle_b32 v93, v77 offset:0x201f
    ds_swizzle_b32 v94, v78 offset:0x201f
    ds_swizzle_b32 v95, v79 offset:0x201f
    s_waitcnt lgkmcnt(0)
    v_add_f32 v64, v64, v80
    v_add_f32 v65, v65, v81
    v_add_f32 v66, v66, v82
    v_add_f32 v67, v67, v83
    v_add_f32 v68, v68, v84
    v_add_f32 v69, v69, v85
    v_add_f32 v70, v70, v86
    v_add_f32 v71, v71, v87
    v_add_f32 v72, v72, v88
    v_add_f32 v73, v73, v89
    v_add_f32 v74, v74, v90
    v_add_f32 v75, v75, v91
    v_add_f32 v76, v76, v92
    v_add_f32 v77, v77, v93
    v_add_f32 v78, v78, v94
    v_add_f32 v79, v79, v95
    ds_swizzle_b32 v80, v64 offset:0x401f
    ds_swizzle_b32 v81, v65 offset:0x401f
    ds_swizzle_b32 v82, v66 offset:0x401f
    ds_swizzle_b32 v83, v67 offset:0x401f
    ds_swizzle_b32 v84, v68 offset:0x401f
    ds_swizzle_b32 v85, v69 offset:0x401f
    ds_swizzle_b32 v86, v70 offset:0x401f
    ds_swizzle_b32 v87, v71 offset:0x401f
    ds_swizzle_b32 v88, v72 offset:0x401f
    ds_swizzle_b32 v89, v73 offset:0x401f
    ds_swizzle_b32 v90, v74 offset:0x401f
    ds_swizzle_b32 v91, v75 offset:0x401f
    ds_swizzle_b32 v92, v76 offset:0x401f
    ds_swizzle_b32 v93, v77 offset:0x401f
    ds_swizzle_b32 v94, v78 offset:0x401f
    ds_swizzle_b32 v95, v79 offset:0x401f
    s_waitcnt lgkmcnt(0)
    v_add_f32 v64, v64, v80
    v_add_f32 v65, v65, v81
    v_add_f32 v66, v66, v82
    v_add_f32 v67, v67, v83
    v_add_f32 v68, v68, v84
    v_add_f32 v69, v69, v85
    v_add_f32 v70, v70, v86
    v_add_f32 v71, v71, v87
    v_add_f32 v72, v72, v88
    v_add_f32 v73, v73, v89
    v_add_f32 v74, v74, v90
    v_add_f32 v75, v75, v91
    v_add_f32 v76, v76, v92
    v_add_f32 v77, v77, v93
    v_add_f32 v78, v78, v94
    v_add_f32 v79, v79, v95
    v_lshrrev_b32 v8, 5, v0
    v_lshlrev_b32 v8, 9, v8
    v_lshl_add_u32 v8, v4, 6, v8
    v_add_u32 v8, 133888, v8
    v_and_b32 v9, 31, v0
    v_cmp_gt_u32 vcc, 8, v9
    s_and_saveexec_b64 s[36:37], vcc
    ds_write_b128 v8, v[64:67] offset:0
    ds_write_b128 v8, v[68:71] offset:16
    ds_write_b128 v8, v[72:75] offset:32
    ds_write_b128 v8, v[76:79] offset:48
    s_mov_b64 exec, s[36:37]
    s_waitcnt lgkmcnt(0)
gemm1a_kernel_ln_skip1:
    s_barrier
    s_cmp_lg_u32 s30, 0
    s_cbranch_scc1 gemm1a_kernel_ln_skip2
    v_lshrrev_b32 v8, 3, v0
    v_lshlrev_b32 v8, 6, v8
    v_and_b32 v9, 7, v0
    v_lshl_add_u32 v8, v9, 2, v8
    v_add_u32 v8, 133888, v8
    ds_read_b32 v104, v8 offset:0
    ds_read_b32 v120, v8 offset:32
    ds_read_b32 v105, v8 offset:512
    ds_read_b32 v121, v8 offset:544
    ds_read_b32 v106, v8 offset:1024
    ds_read_b32 v122, v8 offset:1056
    ds_read_b32 v107, v8 offset:1536
    ds_read_b32 v123, v8 offset:1568
    ds_read_b32 v108, v8 offset:2048
    ds_read_b32 v124, v8 offset:2080
    ds_read_b32 v109, v8 offset:2560
    ds_read_b32 v125, v8 offset:2592
    ds_read_b32 v110, v8 offset:3072
    ds_read_b32 v126, v8 offset:3104
    ds_read_b32 v111, v8 offset:3584
    ds_read_b32 v127, v8 offset:3616
    ds_read_b32 v112, v8 offset:4096
    ds_read_b32 v128, v8 offset:4128
    ds_read_b32 v113, v8 offset:4608
    ds_read_b32 v129, v8 offset:4640
    ds_read_b32 v114, v8 offset:5120
    ds_read_b32 v130, v8 offset:5152
    ds_read_b32 v115, v8 offset:5632
    ds_read_b32 v131, v8 offset:5664
    ds_read_b32 v116, v8 offset:6144
    ds_read_b32 v132, v8 offset:6176
    ds_read_b32 v117, v8 offset:6656
    ds_read_b32 v133, v8 offset:6688
    ds_read_b32 v118, v8 offset:7168
    ds_read_b32 v134, v8 offset:7200
    ds_read_b32 v119, v8 offset:7680
    ds_read_b32 v135, v8 offset:7712
    s_waitcnt lgkmcnt(0)
    v_add_f32 v104, v104, v112
    v_add_f32 v120, v120, v128
    v_add_f32 v105, v105, v113
    v_add_f32 v121, v121, v129
    v_add_f32 v106, v106, v114
    v_add_f32 v122, v122, v130
    v_add_f32 v107, v107, v115
    v_add_f32 v123, v123, v131
    v_add_f32 v108, v108, v116
    v_add_f32 v124, v124, v132
    v_add_f32 v109, v109, v117
    v_add_f32 v125, v125, v133
    v_add_f32 v110, v110, v118
    v_add_f32 v126, v126, v134
    v_add_f32 v111, v111, v119
    v_add_f32 v127, v127, v135
    v_add_f32 v104, v104, v108
    v_add_f32 v120, v120, v124
    v_add_f32 v105, v105, v109
    v_add_f32 v121, v121, v125
    v_add_f32 v106, v106, v110
    v_add_f32 v122, v122, v126
    v_add_f32 v107, v107, v111
    v_add_f32 v123, v123, v127
    v_add_f32 v104, v104, v106
    v_add_f32 v120, v120, v122
    v_add_f32 v105, v105, v107
    v_add_f32 v121, v121, v123
    v_add_f32 v104, v104, v105
    v_add_f32 v120, v120, v121
    s_mov_b32 s36, 0x3b000000
    s_mov_b32 s37, 0x3727c5ac
    v_mul_f32 v104, s36, v104
    v_mul_f32 v120, s36, v120
    v_fma_f32 v120, -v104, v104, v120
    v_max_f32 v120, 0, v120
    v_cvt_pk_bf16_f32 v104, v104, v120
    v_and_b32 v120, 0xffff0000, v104
    v_lshlrev_b32 v104, 16, v104
    v_add_f32 v120, s37, v120
    v_cvt_pk_bf16_f32 v120, v120, v120
    v_lshlrev_b32 v120, 16, v120
    v_sqrt_f32 v120, v120
    s_nop 0
    v_cvt_pk_bf16_f32 v120, v120, v120
    v_lshlrev_b32 v120, 16, v120
    v_rcp_f32 v120, v120
    v_lshlrev_b32 v8, 2, v0
    v_add_u32 v8, 142080, v8
    ds_write_b32 v8, v104 offset:0
    ds_write_b32 v8, v120 offset:256
    s_waitcnt lgkmcnt(0)
gemm1a_kernel_ln_skip2:
    s_barrier
    s_cmp_ge_u32 s30, 8
    s_cbranch_scc1 gemm1a_kernel_ln_skip3
    v_lshlrev_b32 v8, 5, v4
    v_add_u32 v8, 142080, v8
    ds_read_b128 v[64:67], v8 offset:0
    ds_read_b128 v[68:71], v8 offset:16
    ds_read_b128 v[72:75], v8 offset:256
    ds_read_b128 v[76:79], v8 offset:272
    v_bfe_u32 v8, v5, 1, 1
    v_lshrrev_b32 v9, 2, v4
    v_xor_b32 v8, v8, v9
    v_lshlrev_b32 v8, 6, v8
    v_and_b32 v9, 3, v4
    v_lshl_add_u32 v8, v9, 4, v8
    v_lshl_add_u32 v7, v5, 7, v8
    s_waitcnt lgkmcnt(0)
gemm1a_kernel_ln_skip3:
    v_and_b32 v8, 63, v0
    v_bfe_u32 v9, v8, 4, 1
    v_lshrrev_b32 v10, 5, v8
    v_bfe_u32 v11, v8, 2, 2
    v_and_b32 v12, 3, v8
    v_lshl_add_u32 v13, v10, 3, v11
    v_mul_u32_u24 v14, 352, v13
    v_mul_u32_u24 v15, 11392, v9
    v_add_u32 v14, v14, v15
    v_lshl_add_u32 v14, v12, 3, v14
    s_lshl_b32 s35, s30, 5
    v_add_u32 v4, s35, v14
    v_add_u32 v4, 65536, v4
    v_add_u32 v3, 45568, v4
    v_lshlrev_b32 v14, 7, v13
    v_lshl_add_u32 v14, v9, 5, v14
    v_lshl_add_u32 v14, v12, 3, v14
    v_lshrrev_b32 v15, 1, v11
    v_lshl_add_u32 v5, v15, 6, v14
    v_xor_b32 v15, 1, v15
    v_lshl_add_u32 v6, v15, 6, v14
    s_lshr_b32 s39, s30, 2
    s_cmp_ge_u32 s30, 8
    s_cbranch_scc1 gemm1a_kernel_nskip
    v_lshlrev_b32 v80, 16, v32
    v_lshlrev_b32 v82, 16, v33
    v_lshlrev_b32 v84, 16, v34
    v_lshlrev_b32 v86, 16, v35
    v_and_b32 v81, 0xffff0000, v32
    v_and_b32 v83, 0xffff0000, v33
    v_and_b32 v85, 0xffff0000, v34
    v_and_b32 v87, 0xffff0000, v35
    v_pk_add_f32 v[80:81], v[80:81], v[64:65] neg_lo:[0,1] neg_hi:[0,1]
    v_pk_add_f32 v[82:83], v[82:83], v[66:67] neg_lo:[0,1] neg_hi:[0,1]
    v_pk_add_f32 v[84:85], v[84:85], v[68:69] neg_lo:[0,1] neg_hi:[0,1]
    v_pk_add_f32 v[86:87], v[86:87], v[70:71] neg_lo:[0,1] neg_hi:[0,1]
    v_cvt_pk_bf16_f32 v88, v80, v81
    v_cvt_pk_bf16_f32 v89, v82, v83
    v_cvt_pk_bf16_f32 v90, v84, v85
    v_cvt_pk_bf16_f32 v91, v86, v87
    v_lshlrev_b32 v80, 16, v88
    v_lshlrev_b32 v82, 16, v89
    v_lshlrev_b32 v84, 16, v90
    v_lshlrev_b32 v86, 16, v91
    v_and_b32 v81, 0xffff0000, v88
    v_and_b32 v83, 0xffff0000, v89
    v_and_b32 v85, 0xffff0000, v90
    v_and_b32 v87, 0xffff0000, v91
    v_pk_mul_f32 v[80:81], v[80:81], v[72:73]
    v_pk_mul_f32 v[82:83], v[82:83], v[74:75]
    v_pk_mul_f32 v[84:85], v[84:85], v[76:77]
    v_pk_mul_f32 v[86:87], v[86:87], v[78:79]
    v_cvt_pk_bf16_f32 v92, v80, v81
    v_cvt_pk_bf16_f32 v93, v82, v83
    v_cvt_pk_bf16_f32 v94, v84, v85
    v_cvt_pk_bf16_f32 v95, v86, v87
    ds_write_b128 v7, v[92:95] offset:0
    v_lshlrev_b32 v96, 16, v36
    v_lshlrev_b32 v98, 16, v37
    v_lshlrev_b32 v100, 16, v38
    v_lshlrev_b32 v102, 16, v39
    v_and_b32 v97, 0xffff0000, v36
    v_and_b32 v99, 0xffff0000, v37
    v_and_b32 v101, 0xffff0000, v38
    v_and_b32 v103, 0xffff0000, v39
    v_pk_add_f32 v[96:97], v[96:97], v[64:65] neg_lo:[0,1] neg_hi:[0,1]
    v_pk_add_f32 v[98:99], v[98:99], v[66:67] neg_lo:[0,1] neg_hi:[0,1]
    v_pk_add_f32 v[100:101], v[100:101], v[68:69] neg_lo:[0,1] neg_hi:[0,1]
    v_pk_add_f32 v[102:103], v[102:103], v[70:71] neg_lo:[0,1] neg_hi:[0,1]
    v_cvt_pk_bf16_f32 v104, v96, v97
    v_cvt_pk_bf16_f32 v105, v98, v99
    v_cvt_pk_bf16_f32 v106, v100, v101
    v_cvt_pk_bf16_f32 v107, v102, v103
    v_lshlrev_b32 v96, 16, v104
    v_lshlrev_b32 v98, 16, v105
    v_lshlrev_b32 v100, 16, v106
    v_lshlrev_b32 v102, 16, v107
    v_and_b32 v97, 0xffff0000, v104
    v_and_b32 v99, 0xffff0000, v105
    v_and_b32 v101, 0xffff0000, v106
    v_and_b32 v103, 0xffff0000, v107
    v_pk_mul_f32 v[96:97], v[96:97], v[72:73]
    v_pk_mul_f32 v[98:99], v[98:99], v[74:75]
    v_pk_mul_f32 v[100:101], v[100:101], v[76:77]
    v_pk_mul_f32 v[102:103], v[102:103], v[78:79]
    v_cvt_pk_bf16_f32 v108, v96, v97
    v_cvt_pk_bf16_f32 v109, v98, v99
    v_cvt_pk_bf16_f32 v110, v100, v101
    v_cvt_pk_bf16_f32 v111, v102, v103
    ds_write_b128 v7, v[108:111] offset:8192
    v_lshlrev_b32 v80, 16, v40
    v_lshlrev_b32 v82, 16, v41
    v_lshlrev_b32 v84, 16, v42
    v_lshlrev_b32 v86, 16, v43
    v_and_b32 v81, 0xffff0000, v40
    v_and_b32 v83, 0xffff0000, v41
    v_and_b32 v85, 0xffff0000, v42
    v_and_b32 v87, 0xffff0000, v43
    v_pk_add_f32 v[80:81], v[80:81], v[64:65] neg_lo:[0,1] neg_hi:[0,1]
    v_pk_add_f32 v[82:83], v[82:83], v[66:67] neg_lo:[0,1] neg_hi:[0,1]
    v_pk_add_f32 v[84:85], v[84:85], v[68:69] neg_lo:[0,1] neg_hi:[0,1]
    v_pk_add_f32 v[86:87], v[86:87], v[70:71] neg_lo:[0,1] neg_hi:[0,1]
    v_cvt_pk_bf16_f32 v88, v80, v81
    v_cvt_pk_bf16_f32 v89, v82, v83
    v_cvt_pk_bf16_f32 v90, v84, v85
    v_cvt_pk_bf16_f32 v91, v86, v87
    v_lshlrev_b32 v80, 16, v88
    v_lshlrev_b32 v82, 16, v89
    v_lshlrev_b32 v84, 16, v90
    v_lshlrev_b32 v86, 16, v91
    v_and_b32 v81, 0xffff0000, v88
    v_and_b32 v83, 0xffff0000, v89
    v_and_b32 v85, 0xffff0000, v90
    v_and_b32 v87, 0xffff0000, v91
    v_pk_mul_f32 v[80:81], v[80:81], v[72:73]
    v_pk_mul_f32 v[82:83], v[82:83], v[74:75]
    v_pk_mul_f32 v[84:85], v[84:85], v[76:77]
    v_pk_mul_f32 v[86:87], v[86:87], v[78:79]
    v_cvt_pk_bf16_f32 v92, v80, v81
    v_cvt_pk_bf16_f32 v93, v82, v83
    v_cvt_pk_bf16_f32 v94, v84, v85
    v_cvt_pk_bf16_f32 v95, v86, v87
    ds_write_b128 v7, v[92:95] offset:16384
    v_lshlrev_b32 v96, 16, v44
    v_lshlrev_b32 v98, 16, v45
    v_lshlrev_b32 v100, 16, v46
    v_lshlrev_b32 v102, 16, v47
    v_and_b32 v97, 0xffff0000, v44
    v_and_b32 v99, 0xffff0000, v45
    v_and_b32 v101, 0xffff0000, v46
    v_and_b32 v103, 0xffff0000, v47
    v_pk_add_f32 v[96:97], v[96:97], v[64:65] neg_lo:[0,1] neg_hi:[0,1]
    v_pk_add_f32 v[98:99], v[98:99], v[66:67] neg_lo:[0,1] neg_hi:[0,1]
    v_pk_add_f32 v[100:101], v[100:101], v[68:69] neg_lo:[0,1] neg_hi:[0,1]
    v_pk_add_f32 v[102:103], v[102:103], v[70:71] neg_lo:[0,1] neg_hi:[0,1]
    v_cvt_pk_bf16_f32 v104, v96, v97
    v_cvt_pk_bf16_f32 v105, v98, v99
    v_cvt_pk_bf16_f32 v106, v100, v101
    v_cvt_pk_bf16_f32 v107, v102, v103
    v_lshlrev_b32 v96, 16, v104
    v_lshlrev_b32 v98, 16, v105
    v_lshlrev_b32 v100, 16, v106
    v_lshlrev_b32 v102, 16, v107
    v_and_b32 v97, 0xffff0000, v104
    v_and_b32 v99, 0xffff0000, v105
    v_and_b32 v101, 0xffff0000, v106
    v_and_b32 v103, 0xffff0000, v107
    v_pk_mul_f32 v[96:97], v[96:97], v[72:73]
    v_pk_mul_f32 v[98:99], v[98:99], v[74:75]
    v_pk_mul_f32 v[100:101], v[100:101], v[76:77]
    v_pk_mul_f32 v[102:103], v[102:103], v[78:79]
    v_cvt_pk_bf16_f32 v108, v96, v97
    v_cvt_pk_bf16_f32 v109, v98, v99
    v_cvt_pk_bf16_f32 v110, v100, v101
    v_cvt_pk_bf16_f32 v111, v102, v103
    ds_write_b128 v7, v[108:111] offset:24576
    v_lshlrev_b32 v80, 16, v48
    v_lshlrev_b32 v82, 16, v49
    v_lshlrev_b32 v84, 16, v50
    v_lshlrev_b32 v86, 16, v51
    v_and_b32 v81, 0xffff0000, v48
    v_and_b32 v83, 0xffff0000, v49
    v_and_b32 v85, 0xffff0000, v50
    v_and_b32 v87, 0xffff0000, v51
    v_pk_add_f32 v[80:81], v[80:81], v[64:65] neg_lo:[0,1] neg_hi:[0,1]
    v_pk_add_f32 v[82:83], v[82:83], v[66:67] neg_lo:[0,1] neg_hi:[0,1]
    v_pk_add_f32 v[84:85], v[84:85], v[68:69] neg_lo:[0,1] neg_hi:[0,1]
    v_pk_add_f32 v[86:87], v[86:87], v[70:71] neg_lo:[0,1] neg_hi:[0,1]
    v_cvt_pk_bf16_f32 v88, v80, v81
    v_cvt_pk_bf16_f32 v89, v82, v83
    v_cvt_pk_bf16_f32 v90, v84, v85
    v_cvt_pk_bf16_f32 v91, v86, v87
    v_lshlrev_b32 v80, 16, v88
    v_lshlrev_b32 v82, 16, v89
    v_lshlrev_b32 v84, 16, v90
    v_lshlrev_b32 v86, 16, v91
    v_and_b32 v81, 0xffff0000, v88
    v_and_b32 v83, 0xffff0000, v89
    v_and_b32 v85, 0xffff0000, v90
    v_and_b32 v87, 0xffff0000, v91
    v_pk_mul_f32 v[80:81], v[80:81], v[72:73]
    v_pk_mul_f32 v[82:83], v[82:83], v[74:75]
    v_pk_mul_f32 v[84:85], v[84:85], v[76:77]
    v_pk_mul_f32 v[86:87], v[86:87], v[78:79]
    v_cvt_pk_bf16_f32 v92, v80, v81
    v_cvt_pk_bf16_f32 v93, v82, v83
    v_cvt_pk_bf16_f32 v94, v84, v85
    v_cvt_pk_bf16_f32 v95, v86, v87
    ds_write_b128 v7, v[92:95] offset:32768
    v_lshlrev_b32 v96, 16, v52
    v_lshlrev_b32 v98, 16, v53
    v_lshlrev_b32 v100, 16, v54
    v_lshlrev_b32 v102, 16, v55
    v_and_b32 v97, 0xffff0000, v52
    v_and_b32 v99, 0xffff0000, v53
    v_and_b32 v101, 0xffff0000, v54
    v_and_b32 v103, 0xffff0000, v55
    v_pk_add_f32 v[96:97], v[96:97], v[64:65] neg_lo:[0,1] neg_hi:[0,1]
    v_pk_add_f32 v[98:99], v[98:99], v[66:67] neg_lo:[0,1] neg_hi:[0,1]
    v_pk_add_f32 v[100:101], v[100:101], v[68:69] neg_lo:[0,1] neg_hi:[0,1]
    v_pk_add_f32 v[102:103], v[102:103], v[70:71] neg_lo:[0,1] neg_hi:[0,1]
    v_cvt_pk_bf16_f32 v104, v96, v97
    v_cvt_pk_bf16_f32 v105, v98, v99
    v_cvt_pk_bf16_f32 v106, v100, v101
    v_cvt_pk_bf16_f32 v107, v102, v103
    v_lshlrev_b32 v96, 16, v104
    v_lshlrev_b32 v98, 16, v105
    v_lshlrev_b32 v100, 16, v106
    v_lshlrev_b32 v102, 16, v107
    v_and_b32 v97, 0xffff0000, v104
    v_and_b32 v99, 0xffff0000, v105
    v_and_b32 v101, 0xffff0000, v106
    v_and_b32 v103, 0xffff0000, v107
    v_pk_mul_f32 v[96:97], v[96:97], v[72:73]
    v_pk_mul_f32 v[98:99], v[98:99], v[74:75]
    v_pk_mul_f32 v[100:101], v[100:101], v[76:77]
    v_pk_mul_f32 v[102:103], v[102:103], v[78:79]
    v_cvt_pk_bf16_f32 v108, v96, v97
    v_cvt_pk_bf16_f32 v109, v98, v99
    v_cvt_pk_bf16_f32 v110, v100, v101
    v_cvt_pk_bf16_f32 v111, v102, v103
    ds_write_b128 v7, v[108:111] offset:40960
    v_lshlrev_b32 v80, 16, v56
    v_lshlrev_b32 v82, 16, v57
    v_lshlrev_b32 v84, 16, v58
    v_lshlrev_b32 v86, 16, v59
    v_and_b32 v81, 0xffff0000, v56
    v_and_b32 v83, 0xffff0000, v57
    v_and_b32 v85, 0xffff0000, v58
    v_and_b32 v87, 0xffff0000, v59
    v_pk_add_f32 v[80:81], v[80:81], v[64:65] neg_lo:[0,1] neg_hi:[0,1]
    v_pk_add_f32 v[82:83], v[82:83], v[66:67] neg_lo:[0,1] neg_hi:[0,1]
    v_pk_add_f32 v[84:85], v[84:85], v[68:69] neg_lo:[0,1] neg_hi:[0,1]
    v_pk_add_f32 v[86:87], v[86:87], v[70:71] neg_lo:[0,1] neg_hi:[0,1]
    v_cvt_pk_bf16_f32 v88, v80, v81
    v_cvt_pk_bf16_f32 v89, v82, v83
    v_cvt_pk_bf16_f32 v90, v84, v85
    v_cvt_pk_bf16_f32 v91, v86, v87
    v_lshlrev_b32 v80, 16, v88
    v_lshlrev_b32 v82, 16, v89
    v_lshlrev_b32 v84, 16, v90
    v_lshlrev_b32 v86, 16, v91
    v_and_b32 v81, 0xffff0000, v88
    v_and_b32 v83, 0xffff0000, v89
    v_and_b32 v85, 0xffff0000, v90
    v_and_b32 v87, 0xffff0000, v91
    v_pk_mul_f32 v[80:81], v[80:81], v[72:73]
    v_pk_mul_f32 v[82:83], v[82:83], v[74:75]
    v_pk_mul_f32 v[84:85], v[84:85], v[76:77]
    v_pk_mul_f32 v[86:87], v[86:87], v[78:79]
    v_cvt_pk_bf16_f32 v92, v80, v81
    v_cvt_pk_bf16_f32 v93, v82, v83
    v_cvt_pk_bf16_f32 v94, v84, v85
    v_cvt_pk_bf16_f32 v95, v86, v87
    ds_write_b128 v7, v[92:95] offset:49152
    v_lshlrev_b32 v96, 16, v60
    v_lshlrev_b32 v98, 16, v61
    v_lshlrev_b32 v100, 16, v62
    v_lshlrev_b32 v102, 16, v63
    v_and_b32 v97, 0xffff0000, v60
    v_and_b32 v99, 0xffff0000, v61
    v_and_b32 v101, 0xffff0000, v62
    v_and_b32 v103, 0xffff0000, v63
    v_pk_add_f32 v[96:97], v[96:97], v[64:65] neg_lo:[0,1] neg_hi:[0,1]
    v_pk_add_f32 v[98:99], v[98:99], v[66:67] neg_lo:[0,1] neg_hi:[0,1]
    v_pk_add_f32 v[100:101], v[100:101], v[68:69] neg_lo:[0,1] neg_hi:[0,1]
    v_pk_add_f32 v[102:103], v[102:103], v[70:71] neg_lo:[0,1] neg_hi:[0,1]
    v_cvt_pk_bf16_f32 v104, v96, v97
    v_cvt_pk_bf16_f32 v105, v98, v99
    v_cvt_pk_bf16_f32 v106, v100, v101
    v_cvt_pk_bf16_f32 v107, v102, v103
    v_lshlrev_b32 v96, 16, v104
    v_lshlrev_b32 v98, 16, v105
    v_lshlrev_b32 v100, 16, v106
    v_lshlrev_b32 v102, 16, v107
    v_and_b32 v97, 0xffff0000, v104
    v_and_b32 v99, 0xffff0000, v105
    v_and_b32 v101, 0xffff0000, v106
    v_and_b32 v103, 0xffff0000, v107
    v_pk_mul_f32 v[96:97], v[96:97], v[72:73]
    v_pk_mul_f32 v[98:99], v[98:99], v[74:75]
    v_pk_mul_f32 v[100:101], v[100:101], v[76:77]
    v_pk_mul_f32 v[102:103], v[102:103], v[78:79]
    v_cvt_pk_bf16_f32 v108, v96, v97
    v_cvt_pk_bf16_f32 v109, v98, v99
    v_cvt_pk_bf16_f32 v110, v100, v101
    v_cvt_pk_bf16_f32 v111, v102, v103
    ds_write_b128 v7, v[108:111] offset:57344
gemm1a_kernel_nskip:
    s_waitcnt lgkmcnt(0)
    v_mov_b32 v128, 0
    v_mov_b32 v129, 0
    v_mov_b32 v130, 0
    v_mov_b32 v131, 0
    v_mov_b32 v132, 0
    v_mov_b32 v133, 0
    v_mov_b32 v134, 0
    v_mov_b32 v135, 0
    v_mov_b32 v136, 0
    v_mov_b32 v137, 0
    v_mov_b32 v138, 0
    v_mov_b32 v139, 0
    v_mov_b32 v140, 0
    v_mov_b32 v141, 0
    v_mov_b32 v142, 0
    v_mov_b32 v143, 0
    v_mov_b32 v144, 0
    v_mov_b32 v145, 0
    v_mov_b32 v146, 0
    v_mov_b32 v147, 0
    v_mov_b32 v148, 0
    v_mov_b32 v149, 0
    v_mov_b32 v150, 0
    v_mov_b32 v151, 0
    v_mov_b32 v152, 0
    v_mov_b32 v153, 0
    v_mov_b32 v154, 0
    v_mov_b32 v155, 0
    v_mov_b32 v156, 0
    v_mov_b32 v157, 0
    v_mov_b32 v158, 0
    v_mov_b32 v159, 0
    s_cmp_lt_u32 s30, 8
    s_cbranch_scc1 gemm1a_kernel_w_1
    s_waitcnt vmcnt(16)
gemm1a_kernel_w_1:
    s_waitcnt lgkmcnt(0)
    s_barrier
    ds_read_b64_tr_b16 v[80:81], v4 offset:0
    ds_read_b64_tr_b16 v[82:83], v4 offset:1408
    ds_read_b64_tr_b16 v[88:89], v5 offset:0
    ds_read_b64_tr_b16 v[90:91], v5 offset:512
    ds_read_b64_tr_b16 v[96:97], v6 offset:0
    ds_read_b64_tr_b16 v[98:99], v6 offset:512
    ds_read_b64_tr_b16 v[84:85], v4 offset:5632
    ds_read_b64_tr_b16 v[86:87], v4 offset:7040
    ds_read_b64_tr_b16 v[92:93], v5 offset:2048
    ds_read_b64_tr_b16 v[94:95], v5 offset:2560
    ds_read_b64_tr_b16 v[100:101], v6 offset:2048
    ds_read_b64_tr_b16 v[102:103], v6 offset:2560
    s_cmp_lt_u32 s30, 8
    s_cbranch_scc1 gemm1a_kernel_w_2
    s_waitcnt vmcnt(8)
gemm1a_kernel_w_2:
    s_waitcnt lgkmcnt(0)
    s_barrier
    v_mfma_f32_32x32x16_bf16 v[128:143], v[80:83], v[88:91], v[128:143]
    ds_read_b64_tr_b16 v[104:105], v4 offset:22784
    ds_read_b64_tr_b16 v[106:107], v4 offset:24192
    ds_read_b64_tr_b16 v[112:113], v5 offset:4096
    ds_read_b64_tr_b16 v[114:115], v5 offset:4608
    ds_read_b64_tr_b16 v[120:121], v6 offset:4096
    ds_read_b64_tr_b16 v[122:123], v6 offset:4608
    ds_read_b64_tr_b16 v[108:109], v4 offset:28416
    ds_read_b64_tr_b16 v[110:111], v4 offset:29824
    ds_read_b64_tr_b16 v[116:117], v5 offset:6144
    ds_read_b64_tr_b16 v[118:119], v5 offset:6656
    ds_read_b64_tr_b16 v[124:125], v6 offset:6144
    ds_read_b64_tr_b16 v[126:127], v6 offset:6656
    s_add_u32 s33, s32, 133888
    s_mov_b32 m0, s33
    s_mov_b32 s34, 264192
    buffer_load_dwordx4 v2, s[12:15], s34 offen lds
    s_add_u32 m0, s33, 11392
    s_nop 0
    buffer_load_dwordx4 v2, s[16:19], s34 offen lds
    v_mfma_f32_32x32x16_bf16 v[144:159], v[80:83], v[96:99], v[144:159]
    v_mfma_f32_32x32x16_bf16 v[128:143], v[84:87], v[92:95], v[128:143]
    v_mfma_f32_32x32x16_bf16 v[144:159], v[84:87], v[100:103], v[144:159]
    s_cmp_lt_u32 s30, 8
    s_cbranch_scc1 gemm1a_kernel_w_3
    s_waitcnt vmcnt(2)
gemm1a_kernel_w_3:
    s_waitcnt lgkmcnt(0)
    s_barrier
    v_mfma_f32_32x32x16_bf16 v[128:143], v[104:107], v[112:115], v[128:143]
    ds_read_b64_tr_b16 v[80:81], v3 offset:0
    ds_read_b64_tr_b16 v[82:83], v3 offset:1408
    ds_read_b64_tr_b16 v[88:89], v5 offset:8192
    ds_read_b64_tr_b16 v[90:91], v5 offset:8704
    ds_read_b64_tr_b16 v[96:97], v6 offset:8192
    ds_read_b64_tr_b16 v[98:99], v6 offset:8704
    ds_read_b64_tr_b16 v[84:85], v3 offset:5632
    ds_read_b64_tr_b16 v[86:87], v3 offset:7040
    ds_read_b64_tr_b16 v[92:93], v5 offset:10240
    ds_read_b64_tr_b16 v[94:95], v5 offset:10752
    ds_read_b64_tr_b16 v[100:101], v6 offset:10240
    ds_read_b64_tr_b16 v[102:103], v6 offset:10752
    s_add_u32 s33, s32, 65536
    s_mov_b32 m0, s33
    s_mov_b32 s34, 352256
    buffer_load_dwordx4 v2, s[12:15], s34 offen lds
    s_add_u32 m0, s33, 11392
    s_nop 0
    buffer_load_dwordx4 v2, s[16:19], s34 offen lds
    v_mfma_f32_32x32x16_bf16 v[144:159], v[104:107], v[120:123], v[144:159]
    v_mfma_f32_32x32x16_bf16 v[128:143], v[108:111], v[116:119], v[128:143]
    v_mfma_f32_32x32x16_bf16 v[144:159], v[108:111], v[124:127], v[144:159]
    s_cmp_lt_u32 s30, 8
    s_cbranch_scc1 gemm1a_kernel_w_4
    s_waitcnt vmcnt(2)
gemm1a_kernel_w_4:
    s_waitcnt vmcnt(2) lgkmcnt(0)
    s_barrier
    v_mfma_f32_32x32x16_bf16 v[128:143], v[80:83], v[88:91], v[128:143]
    ds_read_b64_tr_b16 v[104:105], v3 offset:22784
    ds_read_b64_tr_b16 v[106:107], v3 offset:24192
    ds_read_b64_tr_b16 v[112:113], v5 offset:12288
    ds_read_b64_tr_b16 v[114:115], v5 offset:12800
    ds_read_b64_tr_b16 v[120:121], v6 offset:12288
    ds_read_b64_tr_b16 v[122:123], v6 offset:12800
    ds_read_b64_tr_b16 v[108:109], v3 offset:28416
    ds_read_b64_tr_b16 v[110:111], v3 offset:29824
    ds_read_b64_tr_b16 v[116:117], v5 offset:14336
    ds_read_b64_tr_b16 v[118:119], v5 offset:14848
    ds_read_b64_tr_b16 v[124:125], v6 offset:14336
    ds_read_b64_tr_b16 v[126:127], v6 offset:14848
    s_add_u32 s33, s32, 88320
    s_mov_b32 m0, s33
    s_mov_b32 s34, 440320
    buffer_load_dwordx4 v2, s[12:15], s34 offen lds
    s_add_u32 m0, s33, 11392
    s_nop 0
    buffer_load_dwordx4 v2, s[16:19], s34 offen lds
    v_mfma_f32_32x32x16_bf16 v[144:159], v[80:83], v[96:99], v[144:159]
    v_mfma_f32_32x32x16_bf16 v[128:143], v[84:87], v[92:95], v[128:143]
    v_mfma_f32_32x32x16_bf16 v[144:159], v[84:87], v[100:103], v[144:159]
    s_cmp_lt_u32 s30, 8
    s_cbranch_scc1 gemm1a_kernel_w_5
    s_waitcnt vmcnt(2)
gemm1a_kernel_w_5:
    s_waitcnt vmcnt(2) lgkmcnt(0)
    s_barrier
    v_mfma_f32_32x32x16_bf16 v[128:143], v[104:107], v[112:115], v[128:143]
    ds_read_b64_tr_b16 v[80:81], v4 offset:0
    ds_read_b64_tr_b16 v[82:83], v4 offset:1408
    ds_read_b64_tr_b16 v[88:89], v5 offset:16384
    ds_read_b64_tr_b16 v[90:91], v5 offset:16896
    ds_read_b64_tr_b16 v[96:97], v6 offset:16384
    ds_read_b64_tr_b16 v[98:99], v6 offset:16896
    ds_read_b64_tr_b16 v[84:85], v4 offset:5632
    ds_read_b64_tr_b16 v[86:87], v4 offset:7040
    ds_read_b64_tr_b16 v[92:93], v5 offset:18432
    ds_read_b64_tr_b16 v[94:95], v5 offset:18944
    ds_read_b64_tr_b16 v[100:101], v6 offset:18432
    ds_read_b64_tr_b16 v[102:103], v6 offset:18944
    s_add_u32 s33, s32, 111104
    s_mov_b32 m0, s33
    s_mov_b32 s34, 528384
    buffer_load_dwordx4 v2, s[12:15], s34 offen lds
    s_add_u32 m0, s33, 11392
    s_nop 0
    buffer_load_dwordx4 v2, s[16:19], s34 offen lds
    v_mfma_f32_32x32x16_bf16 v[144:159], v[104:107], v[120:123], v[144:159]
    v_mfma_f32_32x32x16_bf16 v[128:143], v[108:111], v[116:119], v[128:143]
    v_mfma_f32_32x32x16_bf16 v[144:159], v[108:111], v[124:127], v[144:159]
    s_cmp_lt_u32 s30, 8
    s_cbranch_scc1 gemm1a_kernel_w_6
    s_waitcnt vmcnt(2)
gemm1a_kernel_w_6:
    s_waitcnt vmcnt(2) lgkmcnt(0)
    s_barrier
    v_mfma_f32_32x32x16_bf16 v[128:143], v[80:83], v[88:91], v[128:143]
    ds_read_b64_tr_b16 v[104:105], v4 offset:22784
    ds_read_b64_tr_b16 v[106:107], v4 offset:24192
    ds_read_b64_tr_b16 v[112:113], v5 offset:20480
    ds_read_b64_tr_b16 v[114:115], v5 offset:20992
    ds_read_b64_tr_b16 v[120:121], v6 offset:20480
    ds_read_b64_tr_b16 v[122:123], v6 offset:20992
    ds_read_b64_tr_b16 v[108:109], v4 offset:28416
    ds_read_b64_tr_b16 v[110:111], v4 offset:29824
    ds_read_b64_tr_b16 v[116:117], v5 offset:22528
    ds_read_b64_tr_b16 v[118:119], v5 offset:23040
    ds_read_b64_tr_b16 v[124:125], v6 offset:22528
    ds_read_b64_tr_b16 v[126:127], v6 offset:23040
    s_add_u32 s33, s32, 133888
    s_mov_b32 m0, s33
    s_mov_b32 s34, 616448
    buffer_load_dwordx4 v2, s[12:15], s34 offen lds
    s_add_u32 m0, s33, 11392
    s_nop 0
    buffer_load_dwordx4 v2, s[16:19], s34 offen lds
    v_mfma_f32_32x32x16_bf16 v[144:159], v[80:83], v[96:99], v[144:159]
    v_mfma_f32_32x32x16_bf16 v[128:143], v[84:87], v[92:95], v[128:143]
    v_mfma_f32_32x32x16_bf16 v[144:159], v[84:87], v[100:103], v[144:159]
    s_cmp_lt_u32 s30, 8
    s_cbranch_scc1 gemm1a_kernel_w_7
    s_waitcnt vmcnt(2)
gemm1a_kernel_w_7:
    s_waitcnt vmcnt(2) lgkmcnt(0)
    s_barrier
    v_mfma_f32_32x32x16_bf16 v[128:143], v[104:107], v[112:115], v[128:143]
    ds_read_b64_tr_b16 v[80:81], v3 offset:0
    ds_read_b64_tr_b16 v[82:83], v3 offset:1408
    ds_read_b64_tr_b16 v[88:89], v5 offset:24576
    ds_read_b64_tr_b16 v[90:91], v5 offset:25088
    ds_read_b64_tr_b16 v[96:97], v6 offset:24576
    ds_read_b64_tr_b16 v[98:99], v6 offset:25088
    ds_read_b64_tr_b16 v[84:85], v3 offset:5632
    ds_read_b64_tr_b16 v[86:87], v3 offset:7040
    ds_read_b64_tr_b16 v[92:93], v5 offset:26624
    ds_read_b64_tr_b16 v[94:95], v5 offset:27136
    ds_read_b64_tr_b16 v[100:101], v6 offset:26624
    ds_read_b64_tr_b16 v[102:103], v6 offset:27136
    s_add_u32 s33, s32, 65536
    s_mov_b32 m0, s33
    s_mov_b32 s34, 704512
    buffer_load_dwordx4 v2, s[12:15], s34 offen lds
    s_add_u32 m0, s33, 11392
    s_nop 0
    buffer_load_dwordx4 v2, s[16:19], s34 offen lds
    v_mfma_f32_32x32x16_bf16 v[144:159], v[104:107], v[120:123], v[144:159]
    v_mfma_f32_32x32x16_bf16 v[128:143], v[108:111], v[116:119], v[128:143]
    v_mfma_f32_32x32x16_bf16 v[144:159], v[108:111], v[124:127], v[144:159]
    s_cmp_lt_u32 s30, 8
    s_cbranch_scc1 gemm1a_kernel_w_8
    s_waitcnt vmcnt(2)
gemm1a_kernel_w_8:
    s_waitcnt vmcnt(2) lgkmcnt(0)
    s_barrier
    v_mfma_f32_32x32x16_bf16 v[128:143], v[80:83], v[88:91], v[128:143]
    ds_read_b64_tr_b16 v[104:105], v3 offset:22784
    ds_read_b64_tr_b16 v[106:107], v3 offset:24192
    ds_read_b64_tr_b16 v[112:113], v5 offset:28672
    ds_read_b64_tr_b16 v[114:115], v5 offset:29184
    ds_read_b64_tr_b16 v[120:121], v6 offset:28672
    ds_read_b64_tr_b16 v[122:123], v6 offset:29184
    ds_read_b64_tr_b16 v[108:109], v3 offset:28416
    ds_read_b64_tr_b16 v[110:111], v3 offset:29824
    ds_read_b64_tr_b16 v[116:117], v5 offset:30720
    ds_read_b64_tr_b16 v[118:119], v5 offset:31232
    ds_read_b64_tr_b16 v[124:125], v6 offset:30720
    ds_read_b64_tr_b16 v[126:127], v6 offset:31232
    s_add_u32 s33, s32, 88320
    s_mov_b32 m0, s33
    s_mov_b32 s34, 792576
    buffer_load_dwordx4 v2, s[12:15], s34 offen lds
    s_add_u32 m0, s33, 11392
    s_nop 0
    buffer_load_dwordx4 v2, s[16:19], s34 offen lds
    v_mfma_f32_32x32x16_bf16 v[144:159], v[80:83], v[96:99], v[144:159]
    v_mfma_f32_32x32x16_bf16 v[128:143], v[84:87], v[92:95], v[128:143]
    v_mfma_f32_32x32x16_bf16 v[144:159], v[84:87], v[100:103], v[144:159]
    s_cmp_lt_u32 s30, 8
    s_cbranch_scc1 gemm1a_kernel_w_9
    s_waitcnt vmcnt(2)
gemm1a_kernel_w_9:
    s_waitcnt vmcnt(2) lgkmcnt(0)
    s_barrier
    v_mfma_f32_32x32x16_bf16 v[128:143], v[104:107], v[112:115], v[128:143]
    ds_read_b64_tr_b16 v[80:81], v4 offset:0
    ds_read_b64_tr_b16 v[82:83], v4 offset:1408
    ds_read_b64_tr_b16 v[88:89], v5 offset:32768
    ds_read_b64_tr_b16 v[90:91], v5 offset:33280
    ds_read_b64_tr_b16 v[96:97], v6 offset:32768
    ds_read_b64_tr_b16 v[98:99], v6 offset:33280
    ds_read_b64_tr_b16 v[84:85], v4 offset:5632
    ds_read_b64_tr_b16 v[86:87], v4 offset:7040
    ds_read_b64_tr_b16 v[92:93], v5 offset:34816
    ds_read_b64_tr_b16 v[94:95], v5 offset:35328
    ds_read_b64_tr_b16 v[100:101], v6 offset:34816
    ds_read_b64_tr_b16 v[102:103], v6 offset:35328
    s_add_u32 s33, s32, 111104
    s_mov_b32 m0, s33
    s_mov_b32 s34, 880640
    buffer_load_dwordx4 v2, s[12:15], s34 offen lds
    s_add_u32 m0, s33, 11392
    s_nop 0
    buffer_load_dwordx4 v2, s[16:19], s34 offen lds
    v_mfma_f32_32x32x16_bf16 v[144:159], v[104:107], v[120:123], v[144:159]
    v_mfma_f32_32x32x16_bf16 v[128:143], v[108:111], v[116:119], v[128:143]
    v_mfma_f32_32x32x16_bf16 v[144:159], v[108:111], v[124:127], v[144:159]
    s_cmp_lt_u32 s30, 8
    s_cbranch_scc1 gemm1a_kernel_w_10
    s_waitcnt vmcnt(2)
gemm1a_kernel_w_10:
    s_waitcnt vmcnt(2) lgkmcnt(0)
    s_barrier
    v_mfma_f32_32x32x16_bf16 v[128:143], v[80:83], v[88:91], v[128:143]
    ds_read_b64_tr_b16 v[104:105], v4 offset:22784
    ds_read_b64_tr_b16 v[106:107], v4 offset:24192
    ds_read_b64_tr_b16 v[112:113], v5 offset:36864
    ds_read_b64_tr_b16 v[114:115], v5 offset:37376
    ds_read_b64_tr_b16 v[120:121], v6 offset:36864
    ds_read_b64_tr_b16 v[122:123], v6 offset:37376
    ds_read_b64_tr_b16 v[108:109], v4 offset:28416
    ds_read_b64_tr_b16 v[110:111], v4 offset:29824
    ds_read_b64_tr_b16 v[116:117], v5 offset:38912
    ds_read_b64_tr_b16 v[118:119], v5 offset:39424
    ds_read_b64_tr_b16 v[124:125], v6 offset:38912
    ds_read_b64_tr_b16 v[126:127], v6 offset:39424
    s_add_u32 s33, s32, 133888
    s_mov_b32 m0, s33
    s_mov_b32 s34, 968704
    buffer_load_dwordx4 v2, s[12:15], s34 offen lds
    s_add_u32 m0, s33, 11392
    s_nop 0
    buffer_load_dwordx4 v2, s[16:19], s34 offen lds
    v_mfma_f32_32x32x16_bf16 v[144:159], v[80:83], v[96:99], v[144:159]
    v_mfma_f32_32x32x16_bf16 v[128:143], v[84:87], v[92:95], v[128:143]
    v_mfma_f32_32x32x16_bf16 v[144:159], v[84:87], v[100:103], v[144:159]
    s_cmp_lt_u32 s30, 8
    s_cbranch_scc1 gemm1a_kernel_w_11
    s_waitcnt vmcnt(2)
gemm1a_kernel_w_11:
    s_waitcnt vmcnt(2) lgkmcnt(0)
    s_barrier
    v_mfma_f32_32x32x16_bf16 v[128:143], v[104:107], v[112:115], v[128:143]
    ds_read_b64_tr_b16 v[80:81], v3 offset:0
    ds_read_b64_tr_b16 v[82:83], v3 offset:1408
    ds_read_b64_tr_b16 v[88:89], v5 offset:40960
    ds_read_b64_tr_b16 v[90:91], v5 offset:41472
    ds_read_b64_tr_b16 v[96:97], v6 offset:40960
    ds_read_b64_tr_b16 v[98:99], v6 offset:41472
    ds_read_b64_tr_b16 v[84:85], v3 offset:5632
    ds_read_b64_tr_b16 v[86:87], v3 offset:7040
    ds_read_b64_tr_b16 v[92:93], v5 offset:43008
    ds_read_b64_tr_b16 v[94:95], v5 offset:43520
    ds_read_b64_tr_b16 v[100:101], v6 offset:43008
    ds_read_b64_tr_b16 v[102:103], v6 offset:43520
    s_add_u32 s33, s32, 65536
    s_mov_b32 m0, s33
    s_mov_b32 s34, 1056768
    buffer_load_dwordx4 v2, s[12:15], s34 offen lds
    s_add_u32 m0, s33, 11392
    s_nop 0
    buffer_load_dwordx4 v2, s[16:19], s34 offen lds
    v_mfma_f32_32x32x16_bf16 v[144:159], v[104:107], v[120:123], v[144:159]
    v_mfma_f32_32x32x16_bf16 v[128:143], v[108:111], v[116:119], v[128:143]
    v_mfma_f32_32x32x16_bf16 v[144:159], v[108:111], v[124:127], v[144:159]
    s_cmp_lt_u32 s30, 8
    s_cbranch_scc1 gemm1a_kernel_w_12
    s_waitcnt vmcnt(2)
gemm1a_kernel_w_12:
    s_waitcnt vmcnt(2) lgkmcnt(0)
    s_barrier
    v_mfma_f32_32x32x16_bf16 v[128:143], v[80:83], v[88:91], v[128:143]
    ds_read_b64_tr_b16 v[104:105], v3 offset:22784
    ds_read_b64_tr_b16 v[106:107], v3 offset:24192
    ds_read_b64_tr_b16 v[112:113], v5 offset:45056
    ds_read_b64_tr_b16 v[114:115], v5 offset:45568
    ds_read_b64_tr_b16 v[120:121], v6 offset:45056
    ds_read_b64_tr_b16 v[122:123], v6 offset:45568
    ds_read_b64_tr_b16 v[108:109], v3 offset:28416
    ds_read_b64_tr_b16 v[110:111], v3 offset:29824
    ds_read_b64_tr_b16 v[116:117], v5 offset:47104
    ds_read_b64_tr_b16 v[118:119], v5 offset:47616
    ds_read_b64_tr_b16 v[124:125], v6 offset:47104
    ds_read_b64_tr_b16 v[126:127], v6 offset:47616
    s_add_u32 s33, s32, 88320
    s_mov_b32 m0, s33
    s_mov_b32 s34, 1144832
    buffer_load_dwordx4 v2, s[12:15], s34 offen lds
    s_add_u32 m0, s33, 11392
    s_nop 0
    buffer_load_dwordx4 v2, s[16:19], s34 offen lds
    v_mfma_f32_32x32x16_bf16 v[144:159], v[80:83], v[96:99], v[144:159]
    v_mfma_f32_32x32x16_bf16 v[128:143], v[84:87], v[92:95], v[128:143]
    v_mfma_f32_32x32x16_bf16 v[144:159], v[84:87], v[100:103], v[144:159]
    s_cmp_lt_u32 s30, 8
    s_cbranch_scc1 gemm1a_kernel_w_13
    s_waitcnt vmcnt(2)
gemm1a_kernel_w_13:
    s_waitcnt vmcnt(2) lgkmcnt(0)
    s_barrier
    v_mfma_f32_32x32x16_bf16 v[128:143], v[104:107], v[112:115], v[128:143]
    ds_read_b64_tr_b16 v[80:81], v4 offset:0
    ds_read_b64_tr_b16 v[82:83], v4 offset:1408
    ds_read_b64_tr_b16 v[88:89], v5 offset:49152
    ds_read_b64_tr_b16 v[90:91], v5 offset:49664
    ds_read_b64_tr_b16 v[96:97], v6 offset:49152
    ds_read_b64_tr_b16 v[98:99], v6 offset:49664
    ds_read_b64_tr_b16 v[84:85], v4 offset:5632
    ds_read_b64_tr_b16 v[86:87], v4 offset:7040
    ds_read_b64_tr_b16 v[92:93], v5 offset:51200
    ds_read_b64_tr_b16 v[94:95], v5 offset:51712
    ds_read_b64_tr_b16 v[100:101], v6 offset:51200
    ds_read_b64_tr_b16 v[102:103], v6 offset:51712
    s_add_u32 s33, s32, 111104
    s_mov_b32 m0, s33
    s_mov_b32 s34, 1232896
    buffer_load_dwordx4 v2, s[12:15], s34 offen lds
    s_add_u32 m0, s33, 11392
    s_nop 0
    buffer_load_dwordx4 v2, s[16:19], s34 offen lds
    v_mfma_f32_32x32x16_bf16 v[144:159], v[104:107], v[120:123], v[144:159]
    v_mfma_f32_32x32x16_bf16 v[128:143], v[108:111], v[116:119], v[128:143]
    v_mfma_f32_32x32x16_bf16 v[144:159], v[108:111], v[124:127], v[144:159]
    s_cmp_lt_u32 s30, 8
    s_cbranch_scc1 gemm1a_kernel_w_14
    s_waitcnt vmcnt(2)
gemm1a_kernel_w_14:
    s_waitcnt vmcnt(2) lgkmcnt(0)
    s_barrier
    v_mfma_f32_32x32x16_bf16 v[128:143], v[80:83], v[88:91], v[128:143]
    ds_read_b64_tr_b16 v[104:105], v4 offset:22784
    ds_read_b64_tr_b16 v[106:107], v4 offset:24192
    ds_read_b64_tr_b16 v[112:113], v5 offset:53248
    ds_read_b64_tr_b16 v[114:115], v5 offset:53760
    ds_read_b64_tr_b16 v[120:121], v6 offset:53248
    ds_read_b64_tr_b16 v[122:123], v6 offset:53760
    ds_read_b64_tr_b16 v[108:109], v4 offset:28416
    ds_read_b64_tr_b16 v[110:111], v4 offset:29824
    ds_read_b64_tr_b16 v[116:117], v5 offset:55296
    ds_read_b64_tr_b16 v[118:119], v5 offset:55808
    ds_read_b64_tr_b16 v[124:125], v6 offset:55296
    ds_read_b64_tr_b16 v[126:127], v6 offset:55808
    s_add_u32 s33, s32, 133888
    s_mov_b32 m0, s33
    s_mov_b32 s34, 1320960
    buffer_load_dwordx4 v2, s[12:15], s34 offen lds
    s_add_u32 m0, s33, 11392
    s_nop 0
    buffer_load_dwordx4 v2, s[16:19], s34 offen lds
    v_mfma_f32_32x32x16_bf16 v[144:159], v[80:83], v[96:99], v[144:159]
    v_mfma_f32_32x32x16_bf16 v[128:143], v[84:87], v[92:95], v[128:143]
    v_mfma_f32_32x32x16_bf16 v[144:159], v[84:87], v[100:103], v[144:159]
    s_cmp_lt_u32 s30, 8
    s_cbranch_scc1 gemm1a_kernel_w_15
    s_waitcnt vmcnt(2)
gemm1a_kernel_w_15:
    s_waitcnt vmcnt(2) lgkmcnt(0)
    s_barrier
    v_mfma_f32_32x32x16_bf16 v[128:143], v[104:107], v[112:115], v[128:143]
    ds_read_b64_tr_b16 v[80:81], v3 offset:0
    ds_read_b64_tr_b16 v[82:83], v3 offset:1408
    ds_read_b64_tr_b16 v[88:89], v5 offset:57344
    ds_read_b64_tr_b16 v[90:91], v5 offset:57856
    ds_read_b64_tr_b16 v[96:97], v6 offset:57344
    ds_read_b64_tr_b16 v[98:99], v6 offset:57856
    ds_read_b64_tr_b16 v[84:85], v3 offset:5632
    ds_read_b64_tr_b16 v[86:87], v3 offset:7040
    ds_read_b64_tr_b16 v[92:93], v5 offset:59392
    ds_read_b64_tr_b16 v[94:95], v5 offset:59904
    ds_read_b64_tr_b16 v[100:101], v6 offset:59392
    ds_read_b64_tr_b16 v[102:103], v6 offset:59904
    v_mfma_f32_32x32x16_bf16 v[144:159], v[104:107], v[120:123], v[144:159]
    v_mfma_f32_32x32x16_bf16 v[128:143], v[108:111], v[116:119], v[128:143]
    v_mfma_f32_32x32x16_bf16 v[144:159], v[108:111], v[124:127], v[144:159]
    s_cmp_lt_u32 s30, 8
    s_cbranch_scc1 gemm1a_kernel_w_16
    s_waitcnt vmcnt(0)
gemm1a_kernel_w_16:
    s_waitcnt vmcnt(0) lgkmcnt(0)
    s_barrier
    v_mfma_f32_32x32x16_bf16 v[128:143], v[80:83], v[88:91], v[128:143]
    ds_read_b64_tr_b16 v[104:105], v3 offset:22784
    ds_read_b64_tr_b16 v[106:107], v3 offset:24192
    ds_read_b64_tr_b16 v[112:113], v5 offset:61440
    ds_read_b64_tr_b16 v[114:115], v5 offset:61952
    ds_read_b64_tr_b16 v[120:121], v6 offset:61440
    ds_read_b64_tr_b16 v[122:123], v6 offset:61952
    ds_read_b64_tr_b16 v[108:109], v3 offset:28416
    ds_read_b64_tr_b16 v[110:111], v3 offset:29824
    ds_read_b64_tr_b16 v[116:117], v5 offset:63488
    ds_read_b64_tr_b16 v[118:119], v5 offset:64000
    ds_read_b64_tr_b16 v[124:125], v6 offset:63488
    ds_read_b64_tr_b16 v[126:127], v6 offset:64000
    v_mfma_f32_32x32x16_bf16 v[144:159], v[80:83], v[96:99], v[144:159]
    v_mfma_f32_32x32x16_bf16 v[128:143], v[84:87], v[92:95], v[128:143]
    v_mfma_f32_32x32x16_bf16 v[144:159], v[84:87], v[100:103], v[144:159]
    s_waitcnt lgkmcnt(0)
    s_barrier
    v_mfma_f32_32x32x16_bf16 v[128:143], v[104:107], v[112:115], v[128:143]
    v_mfma_f32_32x32x16_bf16 v[144:159], v[104:107], v[120:123], v[144:159]
    v_mfma_f32_32x32x16_bf16 v[128:143], v[108:111], v[116:119], v[128:143]
    v_mfma_f32_32x32x16_bf16 v[144:159], v[108:111], v[124:127], v[144:159]
    s_nop 15
    s_mov_b32 s36, 0xbfb8aa3b
    v_and_b32 v8, 31, v0
    v_bfe_u32 v9, v0, 5, 1
    s_lshl_b32 s35, s29, 6
    v_add_u32 v8, s35, v8
    v_mul_u32_u24 v8, 2816, v8
    v_lshl_add_u32 v8, v9, 3, v8
    s_lshl_b32 s35, s30, 5
    s_add_u32 s35, s35, s31
    v_add_u32 v8, s35, v8
    s_cmp_eq_u32 s28, 7
    s_cselect_b32 s37, 1, 0
    s_cmp_ge_u32 s30, 9
    s_cselect_b32 s38, 1, 0
    s_and_b32 s37, s37, s38
    v_cvt_pk_bf16_f32 v10, v128, v129
    v_cvt_pk_bf16_f32 v11, v136, v137
    v_lshlrev_b32 v12, 16, v10
    v_and_b32 v13, 0xffff0000, v10
    v_mul_f32 v14, s36, v12
    v_mul_f32 v15, s36, v13
    v_exp_f32 v14, v14
    v_exp_f32 v15, v15
    v_lshlrev_b32 v128, 16, v11
    v_add_f32 v14, 1.0, v14
    v_add_f32 v15, 1.0, v15
    v_rcp_f32 v14, v14
    v_rcp_f32 v15, v15
    v_and_b32 v129, 0xffff0000, v11
    v_pk_mul_f32 v[12:13], v[12:13], v[14:15]
    v_cvt_pk_bf16_f32 v10, v12, v13
    v_lshlrev_b32 v12, 16, v10
    v_and_b32 v13, 0xffff0000, v10
    v_pk_mul_f32 v[12:13], v[12:13], v[128:129]
    v_cvt_pk_bf16_f32 v16, v12, v13
    v_cvt_pk_bf16_f32 v10, v130, v131
    v_cvt_pk_bf16_f32 v11, v138, v139
    v_lshlrev_b32 v12, 16, v10
    v_and_b32 v13, 0xffff0000, v10
    v_mul_f32 v14, s36, v12
    v_mul_f32 v15, s36, v13
    v_exp_f32 v14, v14
    v_exp_f32 v15, v15
    v_lshlrev_b32 v130, 16, v11
    v_add_f32 v14, 1.0, v14
    v_add_f32 v15, 1.0, v15
    v_rcp_f32 v14, v14
    v_rcp_f32 v15, v15
    v_and_b32 v131, 0xffff0000, v11
    v_pk_mul_f32 v[12:13], v[12:13], v[14:15]
    v_cvt_pk_bf16_f32 v10, v12, v13
    v_lshlrev_b32 v12, 16, v10
    v_and_b32 v13, 0xffff0000, v10
    v_pk_mul_f32 v[12:13], v[12:13], v[130:131]
    v_cvt_pk_bf16_f32 v17, v12, v13
    s_cmp_eq_u32 s37, 0
    s_cbranch_scc1 gemm1a_kernel_nz_17
    v_mov_b32 v16, 0
    v_mov_b32 v17, 0
gemm1a_kernel_nz_17:
    buffer_store_dwordx2 v[16:17], v8, s[24:27], 0 offen offset:0
    v_cvt_pk_bf16_f32 v10, v132, v133
    v_cvt_pk_bf16_f32 v11, v140, v141
    v_lshlrev_b32 v12, 16, v10
    v_and_b32 v13, 0xffff0000, v10
    v_mul_f32 v14, s36, v12
    v_mul_f32 v15, s36, v13
    v_exp_f32 v14, v14
    v_exp_f32 v15, v15
    v_lshlrev_b32 v132, 16, v11
    v_add_f32 v14, 1.0, v14
    v_add_f32 v15, 1.0, v15
    v_rcp_f32 v14, v14
    v_rcp_f32 v15, v15
    v_and_b32 v133, 0xffff0000, v11
    v_pk_mul_f32 v[12:13], v[12:13], v[14:15]
    v_cvt_pk_bf16_f32 v10, v12, v13
    v_lshlrev_b32 v12, 16, v10
    v_and_b32 v13, 0xffff0000, v10
    v_pk_mul_f32 v[12:13], v[12:13], v[132:133]
    v_cvt_pk_bf16_f32 v18, v12, v13
    v_cvt_pk_bf16_f32 v10, v134, v135
    v_cvt_pk_bf16_f32 v11, v142, v143
    v_lshlrev_b32 v12, 16, v10
    v_and_b32 v13, 0xffff0000, v10
    v_mul_f32 v14, s36, v12
    v_mul_f32 v15, s36, v13
    v_exp_f32 v14, v14
    v_exp_f32 v15, v15
    v_lshlrev_b32 v134, 16, v11
    v_add_f32 v14, 1.0, v14
    v_add_f32 v15, 1.0, v15
    v_rcp_f32 v14, v14
    v_rcp_f32 v15, v15
    v_and_b32 v135, 0xffff0000, v11
    v_pk_mul_f32 v[12:13], v[12:13], v[14:15]
    v_cvt_pk_bf16_f32 v10, v12, v13
    v_lshlrev_b32 v12, 16, v10
    v_and_b32 v13, 0xffff0000, v10
    v_pk_mul_f32 v[12:13], v[12:13], v[134:135]
    v_cvt_pk_bf16_f32 v19, v12, v13
    s_cmp_eq_u32 s37, 0
    s_cbranch_scc1 gemm1a_kernel_nz_18
    v_mov_b32 v18, 0
    v_mov_b32 v19, 0
gemm1a_kernel_nz_18:
    buffer_store_dwordx2 v[18:19], v8, s[24:27], 0 offen offset:16
    v_cvt_pk_bf16_f32 v10, v144, v145
    v_cvt_pk_bf16_f32 v11, v152, v153
    v_lshlrev_b32 v12, 16, v10
    v_and_b32 v13, 0xffff0000, v10
    v_mul_f32 v14, s36, v12
    v_mul_f32 v15, s36, v13
    v_exp_f32 v14, v14
    v_exp_f32 v15, v15
    v_lshlrev_b32 v144, 16, v11
    v_add_f32 v14, 1.0, v14
    v_add_f32 v15, 1.0, v15
    v_rcp_f32 v14, v14
    v_rcp_f32 v15, v15
    v_and_b32 v145, 0xffff0000, v11
    v_pk_mul_f32 v[12:13], v[12:13], v[14:15]
    v_cvt_pk_bf16_f32 v10, v12, v13
    v_lshlrev_b32 v12, 16, v10
    v_and_b32 v13, 0xffff0000, v10
    v_pk_mul_f32 v[12:13], v[12:13], v[144:145]
    v_cvt_pk_bf16_f32 v20, v12, v13
    v_cvt_pk_bf16_f32 v10, v146, v147
    v_cvt_pk_bf16_f32 v11, v154, v155
    v_lshlrev_b32 v12, 16, v10
    v_and_b32 v13, 0xffff0000, v10
    v_mul_f32 v14, s36, v12
    v_mul_f32 v15, s36, v13
    v_exp_f32 v14, v14
    v_exp_f32 v15, v15
    v_lshlrev_b32 v146, 16, v11
    v_add_f32 v14, 1.0, v14
    v_add_f32 v15, 1.0, v15
    v_rcp_f32 v14, v14
    v_rcp_f32 v15, v15
    v_and_b32 v147, 0xffff0000, v11
    v_pk_mul_f32 v[12:13], v[12:13], v[14:15]
    v_cvt_pk_bf16_f32 v10, v12, v13
    v_lshlrev_b32 v12, 16, v10
    v_and_b32 v13, 0xffff0000, v10
    v_pk_mul_f32 v[12:13], v[12:13], v[146:147]
    v_cvt_pk_bf16_f32 v21, v12, v13
    s_cmp_eq_u32 s37, 0
    s_cbranch_scc1 gemm1a_kernel_nz_19
    v_mov_b32 v20, 0
    v_mov_b32 v21, 0
gemm1a_kernel_nz_19:
    v_add_u32 v8, 90112, v8
    buffer_store_dwordx2 v[20:21], v8, s[24:27], 0 offen offset:0
    v_cvt_pk_bf16_f32 v10, v148, v149
    v_cvt_pk_bf16_f32 v11, v156, v157
    v_lshlrev_b32 v12, 16, v10
    v_and_b32 v13, 0xffff0000, v10
    v_mul_f32 v14, s36, v12
    v_mul_f32 v15, s36, v13
    v_exp_f32 v14, v14
    v_exp_f32 v15, v15
    v_lshlrev_b32 v148, 16, v11
    v_add_f32 v14, 1.0, v14
    v_add_f32 v15, 1.0, v15
    v_rcp_f32 v14, v14
    v_rcp_f32 v15, v15
    v_and_b32 v149, 0xffff0000, v11
    v_pk_mul_f32 v[12:13], v[12:13], v[14:15]
    v_cvt_pk_bf16_f32 v10, v12, v13
    v_lshlrev_b32 v12, 16, v10
    v_and_b32 v13, 0xffff0000, v10
    v_pk_mul_f32 v[12:13], v[12:13], v[148:149]
    v_cvt_pk_bf16_f32 v22, v12, v13
    v_cvt_pk_bf16_f32 v10, v150, v151
    v_cvt_pk_bf16_f32 v11, v158, v159
    v_lshlrev_b32 v12, 16, v10
    v_and_b32 v13, 0xffff0000, v10
    v_mul_f32 v14, s36, v12
    v_mul_f32 v15, s36, v13
    v_exp_f32 v14, v14
    v_exp_f32 v15, v15
    v_lshlrev_b32 v150, 16, v11
    v_add_f32 v14, 1.0, v14
    v_add_f32 v15, 1.0, v15
    v_rcp_f32 v14, v14
    v_rcp_f32 v15, v15
    v_and_b32 v151, 0xffff0000, v11
    v_pk_mul_f32 v[12:13], v[12:13], v[14:15]
    v_cvt_pk_bf16_f32 v10, v12, v13
    v_lshlrev_b32 v12, 16, v10
    v_and_b32 v13, 0xffff0000, v10
    v_pk_mul_f32 v[12:13], v[12:13], v[150:151]
    v_cvt_pk_bf16_f32 v23, v12, v13
    s_cmp_eq_u32 s37, 0
    s_cbranch_scc1 gemm1a_kernel_nz_20
    v_mov_b32 v22, 0
    v_mov_b32 v23, 0
gemm1a_kernel_nz_20:
    buffer_store_dwordx2 v[22:23], v8, s[24:27], 0 offen offset:16
gemm1a_kernel_end:
    s_endpgm
.section .rodata,"a"
.p2align 6
.amdhsa_kernel gemm1a_kernel
  .amdhsa_next_free_vgpr 160
  .amdhsa_next_free_sgpr 102
  .amdhsa_accum_offset 160
  .amdhsa_group_segment_fixed_size 0
  .amdhsa_kernarg_size 112
  .amdhsa_user_sgpr_count 2
  .amdhsa_user_sgpr_kernarg_segment_ptr 1
  .amdhsa_system_sgpr_workgroup_id_x 1
.end_amdhsa_kernel
.text
.globl gemm2a_kernel
.p2align 8
.type gemm2a_kernel,@function
gemm2a_kernel:
    s_cmp_ge_u32 s2, 256
    s_cbranch_scc1 gemm2a_kernel_end
    s_load_dwordx4 s[4:7], s[0:1], 80
    s_load_dwordx2 s[8:9], s[0:1], 104
    s_lshr_b32 s28, s2, 5
    s_and_b32 s29, s2, 31
    v_lshrrev_b32 v1, 6, v0
    s_nop 1
    v_readfirstlane_b32 s30, v1
    s_waitcnt lgkmcnt(0)
    s_mov_b32 s12, s4
    s_mov_b32 s13, s5
    s_mov_b32 s14, 0x158000
    s_mov_b32 s15, 0x00020000
    s_add_u32 s16, s8, 0xc00000
    s_addc_u32 s17, s9, 0
    s_mov_b32 s18, 0x580000
    s_mov_b32 s19, 0x00020000
    s_add_u32 s20, s8, 0x300000
    s_addc_u32 s21, s9, 0
    s_mov_b32 s22, 0x220000
    s_mov_b32 s23, 0x00020000
    s_add_u32 s24, s8, 0x600000
    s_addc_u32 s25, s9, 0
    s_mov_b32 s26, 0x220000
    s_mov_b32 s27, 0x00020000
    s_add_u32 s40, s8, 0x1c04000
    s_addc_u32 s41, s9, 0
    s_mov_b32 s42, 0x4000
    s_mov_b32 s43, 0x00020000
    s_and_b32 s31, s30, 1
    s_lshr_b32 s32, s30, 1
    v_and_b32 v2, 31, v0
    v_bfe_u32 v3, v0, 5, 1
    s_lshl_b32 s33, s28, 6
    s_lshl_b32 s34, s32, 5
    s_add_u32 s33, s33, s34
    v_add_u32 v4, s33, v2
    v_mul_u32_u24 v4, 4352, v4
    s_lshl_b32 s33, s29, 6
    s_lshl_b32 s34, s31, 5
    s_add_u32 s33, s33, s34
    s_lshl_b32 s33, s33, 1
    v_lshl_add_u32 v4, v3, 3, v4
    v_add_u32 v4, s33, v4
    buffer_load_dwordx2 v[40:41], v4, s[20:23], 0 offen
    buffer_load_dwordx2 v[42:43], v4, s[20:23], 0 offen offset:16
    buffer_load_dwordx2 v[44:45], v4, s[20:23], 0 offen offset:32
    buffer_load_dwordx2 v[46:47], v4, s[20:23], 0 offen offset:48
    v_lshrrev_b32 v5, 3, v0
    v_and_b32 v6, 7, v0
    v_bfe_u32 v7, v5, 1, 3
    v_xor_b32 v7, v7, v6
    s_lshl_b32 s33, s29, 6
    v_add_u32 v8, s33, v5
    v_mul_u32_u24 v8, 2816, v8
    v_lshl_add_u32 v8, v7, 4, v8
    v_add_u32 v9, 90112, v8
    v_bfe_u32 v7, v5, 1, 1
    v_lshlrev_b32 v7, 2, v7
    v_xor_b32 v7, v7, v6
    v_lshlrev_b32 v10, 10, v5
    v_lshl_add_u32 v10, v7, 4, v10
    s_lshl_b32 s33, s28, 7
    v_add_u32 v10, s33, v10
    v_add_u32 v11, 0x8000, v10
    s_lshl_b32 s35, s30, 10
    s_lshr_b32 s47, s2, 3
    s_sub_u32 s48, s47, 22
    s_cmp_ge_u32 s47, 22
    s_cselect_b32 s47, s48, s47
    s_add_u32 s36, s35, 0
    s_mov_b32 m0, s36
    s_mov_b32 s37, 0
    buffer_load_dwordx4 v8, s[16:19], s37 offen lds
    s_add_u32 m0, s36, 4096
    s_mov_b32 s38, 0
    buffer_load_dwordx4 v9, s[16:19], s37 offen lds
    s_add_u32 m0, s36, 8192
    s_nop 0
    buffer_load_dwordx4 v10, s[12:15], s38 offen lds
    s_add_u32 m0, s36, 12288
    s_nop 0
    buffer_load_dwordx4 v11, s[12:15], s38 offen lds
    s_add_u32 s36, s35, 16384
    s_mov_b32 m0, s36
    s_mov_b32 s37, 128
    buffer_load_dwordx4 v8, s[16:19], s37 offen lds
    s_add_u32 m0, s36, 4096
    s_mov_b32 s38, 65536
    buffer_load_dwordx4 v9, s[16:19], s37 offen lds
    s_add_u32 m0, s36, 8192
    s_nop 0
    buffer_load_dwordx4 v10, s[12:15], s38 offen lds
    s_add_u32 m0, s36, 12288
    s_nop 0
    buffer_load_dwordx4 v11, s[12:15], s38 offen lds
    s_add_u32 s36, s35, 32768
    s_mov_b32 m0, s36
    s_mov_b32 s37, 256
    buffer_load_dwordx4 v8, s[16:19], s37 offen lds
    s_add_u32 m0, s36, 4096
    s_mov_b32 s38, 131072
    buffer_load_dwordx4 v9, s[16:19], s37 offen lds
    s_add_u32 m0, s36, 8192
    s_nop 0
    buffer_load_dwordx4 v10, s[12:15], s38 offen lds
    s_add_u32 m0, s36, 12288
    s_nop 0
    buffer_load_dwordx4 v11, s[12:15], s38 offen lds
    s_add_u32 s36, s35, 49152
    s_mov_b32 m0, s36
    s_mov_b32 s37, 384
    buffer_load_dwordx4 v8, s[16:19], s37 offen lds
    s_add_u32 m0, s36, 4096
    s_mov_b32 s38, 196608
    buffer_load_dwordx4 v9, s[16:19], s37 offen lds
    s_add_u32 m0, s36, 8192
    s_nop 0
    buffer_load_dwordx4 v10, s[12:15], s38 offen lds
    s_add_u32 m0, s36, 12288
    s_nop 0
    buffer_load_dwordx4 v11, s[12:15], s38 offen lds
    s_add_u32 s36, s35, 65536
    s_mov_b32 m0, s36
    s_mov_b32 s37, 512
    buffer_load_dwordx4 v8, s[16:19], s37 offen lds
    s_add_u32 m0, s36, 4096
    s_mov_b32 s38, 262144
    buffer_load_dwordx4 v9, s[16:19], s37 offen lds
    s_add_u32 m0, s36, 8192
    s_nop 0
    buffer_load_dwordx4 v10, s[12:15], s38 offen lds
    s_add_u32 m0, s36, 12288
    s_nop 0
    buffer_load_dwordx4 v11, s[12:15], s38 offen lds
    s_add_u32 s36, s35, 81920
    s_mov_b32 m0, s36
    s_mov_b32 s37, 640
    buffer_load_dwordx4 v8, s[16:19], s37 offen lds
    s_add_u32 m0, s36, 4096
    s_mov_b32 s38, 327680
    buffer_load_dwordx4 v9, s[16:19], s37 offen lds
    s_add_u32 m0, s36, 8192
    s_nop 0
    buffer_load_dwordx4 v10, s[12:15], s38 offen lds
    s_add_u32 m0, s36, 12288
    s_nop 0
    buffer_load_dwordx4 v11, s[12:15], s38 offen lds
    s_add_u32 s36, s35, 98304
    s_mov_b32 m0, s36
    s_mov_b32 s37, 768
    buffer_load_dwordx4 v8, s[16:19], s37 offen lds
    s_add_u32 m0, s36, 4096
    s_mov_b32 s38, 393216
    buffer_load_dwordx4 v9, s[16:19], s37 offen lds
    s_add_u32 m0, s36, 8192
    s_nop 0
    buffer_load_dwordx4 v10, s[12:15], s38 offen lds
    s_add_u32 m0, s36, 12288
    s_nop 0
    buffer_load_dwordx4 v11, s[12:15], s38 offen lds
    s_add_u32 s36, s35, 114688
    s_mov_b32 m0, s36
    s_mov_b32 s37, 896
    buffer_load_dwordx4 v8, s[16:19], s37 offen lds
    s_add_u32 m0, s36, 4096
    s_mov_b32 s38, 458752
    buffer_load_dwordx4 v9, s[16:19], s37 offen lds
    s_add_u32 m0, s36, 8192
    s_nop 0
    buffer_load_dwordx4 v10, s[12:15], s38 offen lds
    s_add_u32 m0, s36, 12288
    s_nop 0
    buffer_load_dwordx4 v11, s[12:15], s38 offen lds
    v_and_b32 v12, 63, v0
    v_and_b32 v13, 31, v12
    v_lshrrev_b32 v14, 5, v12
    s_lshl_b32 s33, s31, 5
    v_add_u32 v13, s33, v13
    v_bfe_u32 v15, v13, 1, 3
    v_lshlrev_b32 v13, 7, v13
    v_add_u32 v16, 0, v14
    v_xor_b32 v16, v16, v15
    v_lshl_add_u32 v20, v16, 4, v13
    v_add_u32 v16, 2, v14
    v_xor_b32 v16, v16, v15
    v_lshl_add_u32 v21, v16, 4, v13
    v_add_u32 v16, 4, v14
    v_xor_b32 v16, v16, v15
    v_lshl_add_u32 v22, v16, 4, v13
    v_add_u32 v16, 6, v14
    v_xor_b32 v16, v16, v15
    v_lshl_add_u32 v23, v16, 4, v13
    v_bfe_u32 v13, v12, 4, 1
    v_bfe_u32 v15, v12, 2, 2
    v_and_b32 v16, 3, v12
    v_lshl_add_u32 v17, v14, 3, v15
    v_lshlrev_b32 v17, 7, v17
    v_lshl_add_u32 v17, v13, 5, v17
    v_lshl_add_u32 v17, v16, 3, v17
    v_lshrrev_b32 v15, 1, v15
    v_xor_b32 v15, s32, v15
    v_lshl_add_u32 v24, v15, 6, v17
    v_add_u32 v24, 0x2000, v24
    v_add_u32 v26, 49152, v20
    v_add_u32 v32, 98304, v20
    v_add_u32 v27, 49152, v21
    v_add_u32 v33, 98304, v21
    v_add_u32 v28, 49152, v22
    v_add_u32 v34, 98304, v22
    v_add_u32 v29, 49152, v23
    v_add_u32 v35, 98304, v23
    v_add_u32 v30, 49152, v24
    v_add_u32 v36, 98304, v24
    v_mov_b32 v64, 0
    v_mov_b32 v65, 0
    v_mov_b32 v66, 0
    v_mov_b32 v67, 0
    v_mov_b32 v68, 0
    v_mov_b32 v69, 0
    v_mov_b32 v70, 0
    v_mov_b32 v71, 0
    v_mov_b32 v72, 0
    v_mov_b32 v73, 0
    v_mov_b32 v74, 0
    v_mov_b32 v75, 0
    v_mov_b32 v76, 0
    v_mov_b32 v77, 0
    v_mov_b32 v78, 0
    v_mov_b32 v79, 0
    s_waitcnt vmcnt(28)
    s_barrier
    s_add_u32 s36, s35, 131072
    s_mov_b32 m0, s36
    s_mov_b32 s37, 1024
    buffer_load_dwordx4 v8, s[16:19], s37 offen lds
    s_add_u32 m0, s36, 4096
    s_mov_b32 s38, 524288
    buffer_load_dwordx4 v9, s[16:19], s37 offen lds
    s_add_u32 m0, s36, 8192
    s_nop 0
    buffer_load_dwordx4 v10, s[12:15], s38 offen lds
    s_add_u32 m0, s36, 12288
    s_nop 0
    buffer_load_dwordx4 v11, s[12:15], s38 offen lds
    ds_read_b128 v[80:83], v20 offset:0
    ds_read_b64_tr_b16 v[96:97], v24 offset:0
    ds_read_b64_tr_b16 v[98:99], v24 offset:512
    ds_read_b128 v[84:87], v21 offset:0
    ds_read_b64_tr_b16 v[100:101], v24 offset:2048
    ds_read_b64_tr_b16 v[102:103], v24 offset:2560
    ds_read_b128 v[88:91], v22 offset:0
    ds_read_b64_tr_b16 v[104:105], v24 offset:4096
    ds_read_b64_tr_b16 v[106:107], v24 offset:4608
    ds_read_b128 v[92:95], v23 offset:0
    ds_read_b64_tr_b16 v[108:109], v24 offset:6144
    ds_read_b64_tr_b16 v[110:111], v24 offset:6656
    s_waitcnt lgkmcnt(9)
    v_mfma_f32_32x32x16_bf16 v[64:79], v[80:83], v[96:99], v[64:79]
    s_waitcnt lgkmcnt(6)
    v_mfma_f32_32x32x16_bf16 v[64:79], v[84:87], v[100:103], v[64:79]
    s_waitcnt lgkmcnt(3)
    v_mfma_f32_32x32x16_bf16 v[64:79], v[88:91], v[104:107], v[64:79]
    s_waitcnt lgkmcnt(0)
    v_mfma_f32_32x32x16_bf16 v[64:79], v[92:95], v[108:111], v[64:79]
    s_waitcnt vmcnt(28)
    s_barrier
    s_add_u32 s36, s35, 0
    s_mov_b32 m0, s36
    s_mov_b32 s37, 1152
    buffer_load_dwordx4 v8, s[16:19], s37 offen lds
    s_add_u32 m0, s36, 4096
    s_mov_b32 s38, 589824
    buffer_load_dwordx4 v9, s[16:19], s37 offen lds
    s_add_u32 m0, s36, 8192
    s_nop 0
    buffer_load_dwordx4 v10, s[12:15], s38 offen lds
    s_add_u32 m0, s36, 12288
    s_nop 0
    buffer_load_dwordx4 v11, s[12:15], s38 offen lds
    ds_read_b128 v[80:83], v20 offset:16384
    ds_read_b64_tr_b16 v[96:97], v24 offset:16384
    ds_read_b64_tr_b16 v[98:99], v24 offset:16896
    ds_read_b128 v[84:87], v21 offset:16384
    ds_read_b64_tr_b16 v[100:101], v24 offset:18432
    ds_read_b64_tr_b16 v[102:103], v24 offset:18944
    ds_read_b128 v[88:91], v22 offset:16384
    ds_read_b64_tr_b16 v[104:105], v24 offset:20480
    ds_read_b64_tr_b16 v[106:107], v24 offset:20992
    ds_read_b128 v[92:95], v23 offset:16384
    ds_read_b64_tr_b16 v[108:109], v24 offset:22528
    ds_read_b64_tr_b16 v[110:111], v24 offset:23040
    s_waitcnt lgkmcnt(9)
    v_mfma_f32_32x32x16_bf16 v[64:79], v[80:83], v[96:99], v[64:79]
    s_waitcnt lgkmcnt(6)
    v_mfma_f32_32x32x16_bf16 v[64:79], v[84:87], v[100:103], v[64:79]
    s_waitcnt lgkmcnt(3)
    v_mfma_f32_32x32x16_bf16 v[64:79], v[88:91], v[104:107], v[64:79]
    s_waitcnt lgkmcnt(0)
    v_mfma_f32_32x32x16_bf16 v[64:79], v[92:95], v[108:111], v[64:79]
    s_waitcnt vmcnt(28)
    s_barrier
    s_add_u32 s36, s35, 16384
    s_mov_b32 m0, s36
    s_mov_b32 s37, 1280
    buffer_load_dwordx4 v8, s[16:19], s37 offen lds
    s_add_u32 m0, s36, 4096
    s_mov_b32 s38, 655360
    buffer_load_dwordx4 v9, s[16:19], s37 offen lds
    s_add_u32 m0, s36, 8192
    s_nop 0
    buffer_load_dwordx4 v10, s[12:15], s38 offen lds
    s_add_u32 m0, s36, 12288
    s_nop 0
    buffer_load_dwordx4 v11, s[12:15], s38 offen lds
    ds_read_b128 v[80:83], v20 offset:32768
    ds_read_b64_tr_b16 v[96:97], v24 offset:32768
    ds_read_b64_tr_b16 v[98:99], v24 offset:33280
    ds_read_b128 v[84:87], v21 offset:32768
    ds_read_b64_tr_b16 v[100:101], v24 offset:34816
    ds_read_b64_tr_b16 v[102:103], v24 offset:35328
    ds_read_b128 v[88:91], v22 offset:32768
    ds_read_b64_tr_b16 v[104:105], v24 offset:36864
    ds_read_b64_tr_b16 v[106:107], v24 offset:37376
    ds_read_b128 v[92:95], v23 offset:32768
    ds_read_b64_tr_b16 v[108:109], v24 offset:38912
    ds_read_b64_tr_b16 v[110:111], v24 offset:39424
    s_waitcnt lgkmcnt(9)
    v_mfma_f32_32x32x16_bf16 v[64:79], v[80:83], v[96:99], v[64:79]
    s_waitcnt lgkmcnt(6)
    v_mfma_f32_32x32x16_bf16 v[64:79], v[84:87], v[100:103], v[64:79]
    s_waitcnt lgkmcnt(3)
    v_mfma_f32_32x32x16_bf16 v[64:79], v[88:91], v[104:107], v[64:79]
    s_waitcnt lgkmcnt(0)
    v_mfma_f32_32x32x16_bf16 v[64:79], v[92:95], v[108:111], v[64:79]
    s_waitcnt vmcnt(28)
    s_barrier
    s_add_u32 s36, s35, 32768
    s_mov_b32 m0, s36
    s_mov_b32 s37, 1408
    buffer_load_dwordx4 v8, s[16:19], s37 offen lds
    s_add_u32 m0, s36, 4096
    s_mov_b32 s38, 720896
    buffer_load_dwordx4 v9, s[16:19], s37 offen lds
    s_add_u32 m0, s36, 8192
    s_nop 0
    buffer_load_dwordx4 v10, s[12:15], s38 offen lds
    s_add_u32 m0, s36, 12288
    s_nop 0
    buffer_load_dwordx4 v11, s[12:15], s38 offen lds
    ds_read_b128 v[80:83], v26 offset:0
    ds_read_b64_tr_b16 v[96:97], v30 offset:0
    ds_read_b64_tr_b16 v[98:99], v30 offset:512
    ds_read_b128 v[84:87], v27 offset:0
    ds_read_b64_tr_b16 v[100:101], v30 offset:2048
    ds_read_b64_tr_b16 v[102:103], v30 offset:2560
    ds_read_b128 v[88:91], v28 offset:0
    ds_read_b64_tr_b16 v[104:105], v30 offset:4096
    ds_read_b64_tr_b16 v[106:107], v30 offset:4608
    ds_read_b128 v[92:95], v29 offset:0
    ds_read_b64_tr_b16 v[108:109], v30 offset:6144
    ds_read_b64_tr_b16 v[110:111], v30 offset:6656
    s_waitcnt lgkmcnt(9)
    v_mfma_f32_32x32x16_bf16 v[64:79], v[80:83], v[96:99], v[64:79]
    s_waitcnt lgkmcnt(6)
    v_mfma_f32_32x32x16_bf16 v[64:79], v[84:87], v[100:103], v[64:79]
    s_waitcnt lgkmcnt(3)
    v_mfma_f32_32x32x16_bf16 v[64:79], v[88:91], v[104:107], v[64:79]
    s_waitcnt lgkmcnt(0)
    v_mfma_f32_32x32x16_bf16 v[64:79], v[92:95], v[108:111], v[64:79]
    s_waitcnt vmcnt(28)
    s_barrier
    s_add_u32 s36, s35, 49152
    s_mov_b32 m0, s36
    s_mov_b32 s37, 1536
    buffer_load_dwordx4 v8, s[16:19], s37 offen lds
    s_add_u32 m0, s36, 4096
    s_mov_b32 s38, 786432
    buffer_load_dwordx4 v9, s[16:19], s37 offen lds
    s_add_u32 m0, s36, 8192
    s_nop 0
    buffer_load_dwordx4 v10, s[12:15], s38 offen lds
    s_add_u32 m0, s36, 12288
    s_nop 0
    buffer_load_dwordx4 v11, s[12:15], s38 offen lds
    ds_read_b128 v[80:83], v26 offset:16384
    ds_read_b64_tr_b16 v[96:97], v30 offset:16384
    ds_read_b64_tr_b16 v[98:99], v30 offset:16896
    ds_read_b128 v[84:87], v27 offset:16384
    ds_read_b64_tr_b16 v[100:101], v30 offset:18432
    ds_read_b64_tr_b16 v[102:103], v30 offset:18944
    ds_read_b128 v[88:91], v28 offset:16384
    ds_read_b64_tr_b16 v[104:105], v30 offset:20480
    ds_read_b64_tr_b16 v[106:107], v30 offset:20992
    ds_read_b128 v[92:95], v29 offset:16384
    ds_read_b64_tr_b16 v[108:109], v30 offset:22528
    ds_read_b64_tr_b16 v[110:111], v30 offset:23040
    s_waitcnt lgkmcnt(9)
    v_mfma_f32_32x32x16_bf16 v[64:79], v[80:83], v[96:99], v[64:79]
    s_waitcnt lgkmcnt(6)
    v_mfma_f32_32x32x16_bf16 v[64:79], v[84:87], v[100:103], v[64:79]
    s_waitcnt lgkmcnt(3)
    v_mfma_f32_32x32x16_bf16 v[64:79], v[88:91], v[104:107], v[64:79]
    s_waitcnt lgkmcnt(0)
    v_mfma_f32_32x32x16_bf16 v[64:79], v[92:95], v[108:111], v[64:79]
    s_waitcnt vmcnt(28)
    s_barrier
    s_add_u32 s36, s35, 65536
    s_mov_b32 m0, s36
    s_mov_b32 s37, 1664
    buffer_load_dwordx4 v8, s[16:19], s37 offen lds
    s_add_u32 m0, s36, 4096
    s_mov_b32 s38, 851968
    buffer_load_dwordx4 v9, s[16:19], s37 offen lds
    s_add_u32 m0, s36, 8192
    s_nop 0
    buffer_load_dwordx4 v10, s[12:15], s38 offen lds
    s_add_u32 m0, s36, 12288
    s_nop 0
    buffer_load_dwordx4 v11, s[12:15], s38 offen lds
    ds_read_b128 v[80:83], v26 offset:32768
    ds_read_b64_tr_b16 v[96:97], v30 offset:32768
    ds_read_b64_tr_b16 v[98:99], v30 offset:33280
    ds_read_b128 v[84:87], v27 offset:32768
    ds_read_b64_tr_b16 v[100:101], v30 offset:34816
    ds_read_b64_tr_b16 v[102:103], v30 offset:35328
    ds_read_b128 v[88:91], v28 offset:32768
    ds_read_b64_tr_b16 v[104:105], v30 offset:36864
    ds_read_b64_tr_b16 v[106:107], v30 offset:37376
    ds_read_b128 v[92:95], v29 offset:32768
    ds_read_b64_tr_b16 v[108:109], v30 offset:38912
    ds_read_b64_tr_b16 v[110:111], v30 offset:39424
    s_waitcnt lgkmcnt(9)
    v_mfma_f32_32x32x16_bf16 v[64:79], v[80:83], v[96:99], v[64:79]
    s_waitcnt lgkmcnt(6)
    v_mfma_f32_32x32x16_bf16 v[64:79], v[84:87], v[100:103], v[64:79]
    s_waitcnt lgkmcnt(3)
    v_mfma_f32_32x32x16_bf16 v[64:79], v[88:91], v[104:107], v[64:79]
    s_waitcnt lgkmcnt(0)
    v_mfma_f32_32x32x16_bf16 v[64:79], v[92:95], v[108:111], v[64:79]
    s_waitcnt vmcnt(28)
    s_barrier
    s_add_u32 s36, s35, 81920
    s_mov_b32 m0, s36
    s_mov_b32 s37, 1792
    buffer_load_dwordx4 v8, s[16:19], s37 offen lds
    s_add_u32 m0, s36, 4096
    s_mov_b32 s38, 917504
    buffer_load_dwordx4 v9, s[16:19], s37 offen lds
    s_add_u32 m0, s36, 8192
    s_nop 0
    buffer_load_dwordx4 v10, s[12:15], s38 offen lds
    s_add_u32 m0, s36, 12288
    s_nop 0
    buffer_load_dwordx4 v11, s[12:15], s38 offen lds
    ds_read_b128 v[80:83], v32 offset:0
    ds_read_b64_tr_b16 v[96:97], v36 offset:0
    ds_read_b64_tr_b16 v[98:99], v36 offset:512
    ds_read_b128 v[84:87], v33 offset:0
    ds_read_b64_tr_b16 v[100:101], v36 offset:2048
    ds_read_b64_tr_b16 v[102:103], v36 offset:2560
    ds_read_b128 v[88:91], v34 offset:0
    ds_read_b64_tr_b16 v[104:105], v36 offset:4096
    ds_read_b64_tr_b16 v[106:107], v36 offset:4608
    ds_read_b128 v[92:95], v35 offset:0
    ds_read_b64_tr_b16 v[108:109], v36 offset:6144
    ds_read_b64_tr_b16 v[110:111], v36 offset:6656
    s_waitcnt lgkmcnt(9)
    v_mfma_f32_32x32x16_bf16 v[64:79], v[80:83], v[96:99], v[64:79]
    s_waitcnt lgkmcnt(6)
    v_mfma_f32_32x32x16_bf16 v[64:79], v[84:87], v[100:103], v[64:79]
    s_waitcnt lgkmcnt(3)
    v_mfma_f32_32x32x16_bf16 v[64:79], v[88:91], v[104:107], v[64:79]
    s_waitcnt lgkmcnt(0)
    v_mfma_f32_32x32x16_bf16 v[64:79], v[92:95], v[108:111], v[64:79]
    s_waitcnt vmcnt(28)
    s_barrier
    s_add_u32 s36, s35, 98304
    s_mov_b32 m0, s36
    s_mov_b32 s37, 1920
    buffer_load_dwordx4 v8, s[16:19], s37 offen lds
    s_add_u32 m0, s36, 4096
    s_mov_b32 s38, 983040
    buffer_load_dwordx4 v9, s[16:19], s37 offen lds
    s_add_u32 m0, s36, 8192
    s_nop 0
    buffer_load_dwordx4 v10, s[12:15], s38 offen lds
    s_add_u32 m0, s36, 12288
    s_nop 0
    buffer_load_dwordx4 v11, s[12:15], s38 offen lds
    ds_read_b128 v[80:83], v32 offset:16384
    ds_read_b64_tr_b16 v[96:97], v36 offset:16384
    ds_read_b64_tr_b16 v[98:99], v36 offset:16896
    ds_read_b128 v[84:87], v33 offset:16384
    ds_read_b64_tr_b16 v[100:101], v36 offset:18432
    ds_read_b64_tr_b16 v[102:103], v36 offset:18944
    ds_read_b128 v[88:91], v34 offset:16384
    ds_read_b64_tr_b16 v[104:105], v36 offset:20480
    ds_read_b64_tr_b16 v[106:107], v36 offset:20992
    ds_read_b128 v[92:95], v35 offset:16384
    ds_read_b64_tr_b16 v[108:109], v36 offset:22528
    ds_read_b64_tr_b16 v[110:111], v36 offset:23040
    s_waitcnt lgkmcnt(9)
    v_mfma_f32_32x32x16_bf16 v[64:79], v[80:83], v[96:99], v[64:79]
    s_waitcnt lgkmcnt(6)
    v_mfma_f32_32x32x16_bf16 v[64:79], v[84:87], v[100:103], v[64:79]
    s_waitcnt lgkmcnt(3)
    v_mfma_f32_32x32x16_bf16 v[64:79], v[88:91], v[104:107], v[64:79]
    s_waitcnt lgkmcnt(0)
    v_mfma_f32_32x32x16_bf16 v[64:79], v[92:95], v[108:111], v[64:79]
    s_waitcnt vmcnt(28)
    s_barrier
    s_add_u32 s36, s35, 114688
    s_mov_b32 m0, s36
    s_mov_b32 s37, 2048
    buffer_load_dwordx4 v8, s[16:19], s37 offen lds
    s_add_u32 m0, s36, 4096
    s_mov_b32 s38, 1048576
    buffer_load_dwordx4 v9, s[16:19], s37 offen lds
    s_add_u32 m0, s36, 8192
    s_nop 0
    buffer_load_dwordx4 v10, s[12:15], s38 offen lds
    s_add_u32 m0, s36, 12288
    s_nop 0
    buffer_load_dwordx4 v11, s[12:15], s38 offen lds
    ds_read_b128 v[80:83], v32 offset:32768
    ds_read_b64_tr_b16 v[96:97], v36 offset:32768
    ds_read_b64_tr_b16 v[98:99], v36 offset:33280
    ds_read_b128 v[84:87], v33 offset:32768
    ds_read_b64_tr_b16 v[100:101], v36 offset:34816
    ds_read_b64_tr_b16 v[102:103], v36 offset:35328
    ds_read_b128 v[88:91], v34 offset:32768
    ds_read_b64_tr_b16 v[104:105], v36 offset:36864
    ds_read_b64_tr_b16 v[106:107], v36 offset:37376
    ds_read_b128 v[92:95], v35 offset:32768
    ds_read_b64_tr_b16 v[108:109], v36 offset:38912
    ds_read_b64_tr_b16 v[110:111], v36 offset:39424
    s_waitcnt lgkmcnt(9)
    v_mfma_f32_32x32x16_bf16 v[64:79], v[80:83], v[96:99], v[64:79]
    s_waitcnt lgkmcnt(6)
    v_mfma_f32_32x32x16_bf16 v[64:79], v[84:87], v[100:103], v[64:79]
    s_waitcnt lgkmcnt(3)
    v_mfma_f32_32x32x16_bf16 v[64:79], v[88:91], v[104:107], v[64:79]
    s_waitcnt lgkmcnt(0)
    v_mfma_f32_32x32x16_bf16 v[64:79], v[92:95], v[108:111], v[64:79]
    s_waitcnt vmcnt(28)
    s_barrier
    s_add_u32 s36, s35, 131072
    s_mov_b32 m0, s36
    s_mov_b32 s37, 2176
    buffer_load_dwordx4 v8, s[16:19], s37 offen lds
    s_add_u32 m0, s36, 4096
    s_mov_b32 s38, 1114112
    buffer_load_dwordx4 v9, s[16:19], s37 offen lds
    s_add_u32 m0, s36, 8192
    s_nop 0
    buffer_load_dwordx4 v10, s[12:15], s38 offen lds
    s_add_u32 m0, s36, 12288
    s_nop 0
    buffer_load_dwordx4 v11, s[12:15], s38 offen lds
    ds_read_b128 v[80:83], v20 offset:0
    ds_read_b64_tr_b16 v[96:97], v24 offset:0
    ds_read_b64_tr_b16 v[98:99], v24 offset:512
    ds_read_b128 v[84:87], v21 offset:0
    ds_read_b64_tr_b16 v[100:101], v24 offset:2048
    ds_read_b64_tr_b16 v[102:103], v24 offset:2560
    ds_read_b128 v[88:91], v22 offset:0
    ds_read_b64_tr_b16 v[104:105], v24 offset:4096
    ds_read_b64_tr_b16 v[106:107], v24 offset:4608
    ds_read_b128 v[92:95], v23 offset:0
    ds_read_b64_tr_b16 v[108:109], v24 offset:6144
    ds_read_b64_tr_b16 v[110:111], v24 offset:6656
    s_waitcnt lgkmcnt(9)
    v_mfma_f32_32x32x16_bf16 v[64:79], v[80:83], v[96:99], v[64:79]
    s_waitcnt lgkmcnt(6)
    v_mfma_f32_32x32x16_bf16 v[64:79], v[84:87], v[100:103], v[64:79]
    s_waitcnt lgkmcnt(3)
    v_mfma_f32_32x32x16_bf16 v[64:79], v[88:91], v[104:107], v[64:79]
    s_waitcnt lgkmcnt(0)
    v_mfma_f32_32x32x16_bf16 v[64:79], v[92:95], v[108:111], v[64:79]
    s_waitcnt vmcnt(28)
    s_barrier
    s_add_u32 s36, s35, 0
    s_mov_b32 m0, s36
    s_mov_b32 s37, 2304
    buffer_load_dwordx4 v8, s[16:19], s37 offen lds
    s_add_u32 m0, s36, 4096
    s_mov_b32 s38, 1179648
    buffer_load_dwordx4 v9, s[16:19], s37 offen lds
    s_add_u32 m0, s36, 8192
    s_nop 0
    buffer_load_dwordx4 v10, s[12:15], s38 offen lds
    s_add_u32 m0, s36, 12288
    s_nop 0
    buffer_load_dwordx4 v11, s[12:15], s38 offen lds
    ds_read_b128 v[80:83], v20 offset:16384
    ds_read_b64_tr_b16 v[96:97], v24 offset:16384
    ds_read_b64_tr_b16 v[98:99], v24 offset:16896
    ds_read_b128 v[84:87], v21 offset:16384
    ds_read_b64_tr_b16 v[100:101], v24 offset:18432
    ds_read_b64_tr_b16 v[102:103], v24 offset:18944
    ds_read_b128 v[88:91], v22 offset:16384
    ds_read_b64_tr_b16 v[104:105], v24 offset:20480
    ds_read_b64_tr_b16 v[106:107], v24 offset:20992
    ds_read_b128 v[92:95], v23 offset:16384
    ds_read_b64_tr_b16 v[108:109], v24 offset:22528
    ds_read_b64_tr_b16 v[110:111], v24 offset:23040
    s_waitcnt lgkmcnt(9)
    v_mfma_f32_32x32x16_bf16 v[64:79], v[80:83], v[96:99], v[64:79]
    s_waitcnt lgkmcnt(6)
    v_mfma_f32_32x32x16_bf16 v[64:79], v[84:87], v[100:103], v[64:79]
    s_waitcnt lgkmcnt(3)
    v_mfma_f32_32x32x16_bf16 v[64:79], v[88:91], v[104:107], v[64:79]
    s_waitcnt lgkmcnt(0)
    v_mfma_f32_32x32x16_bf16 v[64:79], v[92:95], v[108:111], v[64:79]
    s_waitcnt vmcnt(28)
    s_barrier
    s_add_u32 s36, s35, 16384
    s_mov_b32 m0, s36
    s_mov_b32 s37, 2432
    buffer_load_dwordx4 v8, s[16:19], s37 offen lds
    s_add_u32 m0, s36, 4096
    s_mov_b32 s38, 1245184
    buffer_load_dwordx4 v9, s[16:19], s37 offen lds
    s_add_u32 m0, s36, 8192
    s_nop 0
    buffer_load_dwordx4 v10, s[12:15], s38 offen lds
    s_add_u32 m0, s36, 12288
    s_nop 0
    buffer_load_dwordx4 v11, s[12:15], s38 offen lds
    ds_read_b128 v[80:83], v20 offset:32768
    ds_read_b64_tr_b16 v[96:97], v24 offset:32768
    ds_read_b64_tr_b16 v[98:99], v24 offset:33280
    ds_read_b128 v[84:87], v21 offset:32768
    ds_read_b64_tr_b16 v[100:101], v24 offset:34816
    ds_read_b64_tr_b16 v[102:103], v24 offset:35328
    ds_read_b128 v[88:91], v22 offset:32768
    ds_read_b64_tr_b16 v[104:105], v24 offset:36864
    ds_read_b64_tr_b16 v[106:107], v24 offset:37376
    ds_read_b128 v[92:95], v23 offset:32768
    ds_read_b64_tr_b16 v[108:109], v24 offset:38912
    ds_read_b64_tr_b16 v[110:111], v24 offset:39424
    s_waitcnt lgkmcnt(9)
    v_mfma_f32_32x32x16_bf16 v[64:79], v[80:83], v[96:99], v[64:79]
    s_waitcnt lgkmcnt(6)
    v_mfma_f32_32x32x16_bf16 v[64:79], v[84:87], v[100:103], v[64:79]
    s_waitcnt lgkmcnt(3)
    v_mfma_f32_32x32x16_bf16 v[64:79], v[88:91], v[104:107], v[64:79]
    s_waitcnt lgkmcnt(0)
    v_mfma_f32_32x32x16_bf16 v[64:79], v[92:95], v[108:111], v[64:79]
    s_waitcnt vmcnt(28)
    s_barrier
    s_add_u32 s36, s35, 32768
    s_mov_b32 m0, s36
    s_mov_b32 s37, 2560
    buffer_load_dwordx4 v8, s[16:19], s37 offen lds
    s_add_u32 m0, s36, 4096
    s_mov_b32 s38, 1310720
    buffer_load_dwordx4 v9, s[16:19], s37 offen lds
    s_add_u32 m0, s36, 8192
    s_nop 0
    buffer_load_dwordx4 v10, s[12:15], s38 offen lds
    s_add_u32 m0, s36, 12288
    s_nop 0
    buffer_load_dwordx4 v11, s[12:15], s38 offen lds
    ds_read_b128 v[80:83], v26 offset:0
    ds_read_b64_tr_b16 v[96:97], v30 offset:0
    ds_read_b64_tr_b16 v[98:99], v30 offset:512
    ds_read_b128 v[84:87], v27 offset:0
    ds_read_b64_tr_b16 v[100:101], v30 offset:2048
    ds_read_b64_tr_b16 v[102:103], v30 offset:2560
    ds_read_b128 v[88:91], v28 offset:0
    ds_read_b64_tr_b16 v[104:105], v30 offset:4096
    ds_read_b64_tr_b16 v[106:107], v30 offset:4608
    ds_read_b128 v[92:95], v29 offset:0
    ds_read_b64_tr_b16 v[108:109], v30 offset:6144
    ds_read_b64_tr_b16 v[110:111], v30 offset:6656
    s_waitcnt lgkmcnt(9)
    v_mfma_f32_32x32x16_bf16 v[64:79], v[80:83], v[96:99], v[64:79]
    s_waitcnt lgkmcnt(6)
    v_mfma_f32_32x32x16_bf16 v[64:79], v[84:87], v[100:103], v[64:79]
    s_waitcnt lgkmcnt(3)
    v_mfma_f32_32x32x16_bf16 v[64:79], v[88:91], v[104:107], v[64:79]
    s_waitcnt lgkmcnt(0)
    v_mfma_f32_32x32x16_bf16 v[64:79], v[92:95], v[108:111], v[64:79]
    s_waitcnt vmcnt(28)
    s_barrier
    s_add_u32 s36, s35, 49152
    s_mov_b32 m0, s36
    s_mov_b32 s37, 2688
    buffer_load_dwordx4 v8, s[16:19], s37 offen lds
    s_add_u32 m0, s36, 4096
    s_mov_b32 s38, 1376256
    buffer_load_dwordx4 v9, s[16:19], s37 offen lds
    s_add_u32 m0, s36, 8192
    s_nop 0
    buffer_load_dwordx4 v10, s[12:15], s38 offen lds
    s_add_u32 m0, s36, 12288
    s_nop 0
    buffer_load_dwordx4 v11, s[12:15], s38 offen lds
    ds_read_b128 v[80:83], v26 offset:16384
    ds_read_b64_tr_b16 v[96:97], v30 offset:16384
    ds_read_b64_tr_b16 v[98:99], v30 offset:16896
    ds_read_b128 v[84:87], v27 offset:16384
    ds_read_b64_tr_b16 v[100:101], v30 offset:18432
    ds_read_b64_tr_b16 v[102:103], v30 offset:18944
    ds_read_b128 v[88:91], v28 offset:16384
    ds_read_b64_tr_b16 v[104:105], v30 offset:20480
    ds_read_b64_tr_b16 v[106:107], v30 offset:20992
    ds_read_b128 v[92:95], v29 offset:16384
    ds_read_b64_tr_b16 v[108:109], v30 offset:22528
    ds_read_b64_tr_b16 v[110:111], v30 offset:23040
    s_waitcnt lgkmcnt(9)
    v_mfma_f32_32x32x16_bf16 v[64:79], v[80:83], v[96:99], v[64:79]
    s_waitcnt lgkmcnt(6)
    v_mfma_f32_32x32x16_bf16 v[64:79], v[84:87], v[100:103], v[64:79]
    s_waitcnt lgkmcnt(3)
    v_mfma_f32_32x32x16_bf16 v[64:79], v[88:91], v[104:107], v[64:79]
    s_waitcnt lgkmcnt(0)
    v_mfma_f32_32x32x16_bf16 v[64:79], v[92:95], v[108:111], v[64:79]
    s_waitcnt vmcnt(28)
    s_barrier
    ds_read_b128 v[80:83], v26 offset:32768
    ds_read_b64_tr_b16 v[96:97], v30 offset:32768
    ds_read_b64_tr_b16 v[98:99], v30 offset:33280
    ds_read_b128 v[84:87], v27 offset:32768
    ds_read_b64_tr_b16 v[100:101], v30 offset:34816
    ds_read_b64_tr_b16 v[102:103], v30 offset:35328
    ds_read_b128 v[88:91], v28 offset:32768
    ds_read_b64_tr_b16 v[104:105], v30 offset:36864
    ds_read_b64_tr_b16 v[106:107], v30 offset:37376
    ds_read_b128 v[92:95], v29 offset:32768
    ds_read_b64_tr_b16 v[108:109], v30 offset:38912
    ds_read_b64_tr_b16 v[110:111], v30 offset:39424
    s_waitcnt lgkmcnt(9)
    v_mfma_f32_32x32x16_bf16 v[64:79], v[80:83], v[96:99], v[64:79]
    s_waitcnt lgkmcnt(6)
    v_mfma_f32_32x32x16_bf16 v[64:79], v[84:87], v[100:103], v[64:79]
    s_waitcnt lgkmcnt(3)
    v_mfma_f32_32x32x16_bf16 v[64:79], v[88:91], v[104:107], v[64:79]
    s_waitcnt lgkmcnt(0)
    v_mfma_f32_32x32x16_bf16 v[64:79], v[92:95], v[108:111], v[64:79]
    s_waitcnt vmcnt(24)
    s_barrier
    ds_read_b128 v[80:83], v32 offset:0
    ds_read_b64_tr_b16 v[96:97], v36 offset:0
    ds_read_b64_tr_b16 v[98:99], v36 offset:512
    ds_read_b128 v[84:87], v33 offset:0
    ds_read_b64_tr_b16 v[100:101], v36 offset:2048
    ds_read_b64_tr_b16 v[102:103], v36 offset:2560
    ds_read_b128 v[88:91], v34 offset:0
    ds_read_b64_tr_b16 v[104:105], v36 offset:4096
    ds_read_b64_tr_b16 v[106:107], v36 offset:4608
    ds_read_b128 v[92:95], v35 offset:0
    ds_read_b64_tr_b16 v[108:109], v36 offset:6144
    ds_read_b64_tr_b16 v[110:111], v36 offset:6656
    s_waitcnt lgkmcnt(9)
    v_mfma_f32_32x32x16_bf16 v[64:79], v[80:83], v[96:99], v[64:79]
    s_waitcnt lgkmcnt(6)
    v_mfma_f32_32x32x16_bf16 v[64:79], v[84:87], v[100:103], v[64:79]
    s_waitcnt lgkmcnt(3)
    v_mfma_f32_32x32x16_bf16 v[64:79], v[88:91], v[104:107], v[64:79]
    s_waitcnt lgkmcnt(0)
    v_mfma_f32_32x32x16_bf16 v[64:79], v[92:95], v[108:111], v[64:79]
    s_waitcnt vmcnt(20)
    s_barrier
    ds_read_b128 v[80:83], v32 offset:16384
    ds_read_b64_tr_b16 v[96:97], v36 offset:16384
    ds_read_b64_tr_b16 v[98:99], v36 offset:16896
    ds_read_b128 v[84:87], v33 offset:16384
    ds_read_b64_tr_b16 v[100:101], v36 offset:18432
    ds_read_b64_tr_b16 v[102:103], v36 offset:18944
    ds_read_b128 v[88:91], v34 offset:16384
    ds_read_b64_tr_b16 v[104:105], v36 offset:20480
    ds_read_b64_tr_b16 v[106:107], v36 offset:20992
    ds_read_b128 v[92:95], v35 offset:16384
    ds_read_b64_tr_b16 v[108:109], v36 offset:22528
    ds_read_b64_tr_b16 v[110:111], v36 offset:23040
    s_waitcnt lgkmcnt(9)
    v_mfma_f32_32x32x16_bf16 v[64:79], v[80:83], v[96:99], v[64:79]
    s_waitcnt lgkmcnt(6)
    v_mfma_f32_32x32x16_bf16 v[64:79], v[84:87], v[100:103], v[64:79]
    s_waitcnt lgkmcnt(3)
    v_mfma_f32_32x32x16_bf16 v[64:79], v[88:91], v[104:107], v[64:79]
    s_waitcnt lgkmcnt(0)
    v_mfma_f32_32x32x16_bf16 v[64:79], v[92:95], v[108:111], v[64:79]
    s_waitcnt vmcnt(16)
    s_barrier
    ds_read_b128 v[80:83], v32 offset:32768
    ds_read_b64_tr_b16 v[96:97], v36 offset:32768
    ds_read_b64_tr_b16 v[98:99], v36 offset:33280
    ds_read_b128 v[84:87], v33 offset:32768
    ds_read_b64_tr_b16 v[100:101], v36 offset:34816
    ds_read_b64_tr_b16 v[102:103], v36 offset:35328
    ds_read_b128 v[88:91], v34 offset:32768
    ds_read_b64_tr_b16 v[104:105], v36 offset:36864
    ds_read_b64_tr_b16 v[106:107], v36 offset:37376
    ds_read_b128 v[92:95], v35 offset:32768
    ds_read_b64_tr_b16 v[108:109], v36 offset:38912
    ds_read_b64_tr_b16 v[110:111], v36 offset:39424
    s_waitcnt lgkmcnt(9)
    v_mfma_f32_32x32x16_bf16 v[64:79], v[80:83], v[96:99], v[64:79]
    s_waitcnt lgkmcnt(6)
    v_mfma_f32_32x32x16_bf16 v[64:79], v[84:87], v[100:103], v[64:79]
    s_waitcnt lgkmcnt(3)
    v_mfma_f32_32x32x16_bf16 v[64:79], v[88:91], v[104:107], v[64:79]
    s_waitcnt lgkmcnt(0)
    v_mfma_f32_32x32x16_bf16 v[64:79], v[92:95], v[108:111], v[64:79]
    s_waitcnt vmcnt(12)
    s_barrier
    ds_read_b128 v[80:83], v20 offset:0
    ds_read_b64_tr_b16 v[96:97], v24 offset:0
    ds_read_b64_tr_b16 v[98:99], v24 offset:512
    ds_read_b128 v[84:87], v21 offset:0
    ds_read_b64_tr_b16 v[100:101], v24 offset:2048
    ds_read_b64_tr_b16 v[102:103], v24 offset:2560
    ds_read_b128 v[88:91], v22 offset:0
    ds_read_b64_tr_b16 v[104:105], v24 offset:4096
    ds_read_b64_tr_b16 v[106:107], v24 offset:4608
    ds_read_b128 v[92:95], v23 offset:0
    ds_read_b64_tr_b16 v[108:109], v24 offset:6144
    ds_read_b64_tr_b16 v[110:111], v24 offset:6656
    s_waitcnt lgkmcnt(9)
    v_mfma_f32_32x32x16_bf16 v[64:79], v[80:83], v[96:99], v[64:79]
    s_waitcnt lgkmcnt(6)
    v_mfma_f32_32x32x16_bf16 v[64:79], v[84:87], v[100:103], v[64:79]
    s_waitcnt lgkmcnt(3)
    v_mfma_f32_32x32x16_bf16 v[64:79], v[88:91], v[104:107], v[64:79]
    s_waitcnt lgkmcnt(0)
    v_mfma_f32_32x32x16_bf16 v[64:79], v[92:95], v[108:111], v[64:79]
    s_waitcnt vmcnt(8)
    s_barrier
    ds_read_b128 v[80:83], v20 offset:16384
    ds_read_b64_tr_b16 v[96:97], v24 offset:16384
    ds_read_b64_tr_b16 v[98:99], v24 offset:16896
    ds_read_b128 v[84:87], v21 offset:16384
    ds_read_b64_tr_b16 v[100:101], v24 offset:18432
    ds_read_b64_tr_b16 v[102:103], v24 offset:18944
    ds_read_b128 v[88:91], v22 offset:16384
    ds_read_b64_tr_b16 v[104:105], v24 offset:20480
    ds_read_b64_tr_b16 v[106:107], v24 offset:20992
    ds_read_b128 v[92:95], v23 offset:16384
    ds_read_b64_tr_b16 v[108:109], v24 offset:22528
    ds_read_b64_tr_b16 v[110:111], v24 offset:23040
    s_waitcnt lgkmcnt(9)
    v_mfma_f32_32x32x16_bf16 v[64:79], v[80:83], v[96:99], v[64:79]
    s_waitcnt lgkmcnt(6)
    v_mfma_f32_32x32x16_bf16 v[64:79], v[84:87], v[100:103], v[64:79]
    s_waitcnt lgkmcnt(3)
    v_mfma_f32_32x32x16_bf16 v[64:79], v[88:91], v[104:107], v[64:79]
    s_waitcnt lgkmcnt(0)
    v_mfma_f32_32x32x16_bf16 v[64:79], v[92:95], v[108:111], v[64:79]
    s_waitcnt vmcnt(4)
    s_barrier
    ds_read_b128 v[80:83], v20 offset:32768
    ds_read_b64_tr_b16 v[96:97], v24 offset:32768
    ds_read_b64_tr_b16 v[98:99], v24 offset:33280
    ds_read_b128 v[84:87], v21 offset:32768
    ds_read_b64_tr_b16 v[100:101], v24 offset:34816
    ds_read_b64_tr_b16 v[102:103], v24 offset:35328
    ds_read_b128 v[88:91], v22 offset:32768
    ds_read_b64_tr_b16 v[104:105], v24 offset:36864
    ds_read_b64_tr_b16 v[106:107], v24 offset:37376
    ds_read_b128 v[92:95], v23 offset:32768
    ds_read_b64_tr_b16 v[108:109], v24 offset:38912
    ds_read_b64_tr_b16 v[110:111], v24 offset:39424
    s_waitcnt lgkmcnt(9)
    v_mfma_f32_32x32x16_bf16 v[64:79], v[80:83], v[96:99], v[64:79]
    s_waitcnt lgkmcnt(6)
    v_mfma_f32_32x32x16_bf16 v[64:79], v[84:87], v[100:103], v[64:79]
    s_waitcnt lgkmcnt(3)
    v_mfma_f32_32x32x16_bf16 v[64:79], v[88:91], v[104:107], v[64:79]
    s_waitcnt lgkmcnt(0)
    v_mfma_f32_32x32x16_bf16 v[64:79], v[92:95], v[108:111], v[64:79]
    s_waitcnt vmcnt(0)
    s_barrier
    ds_read_b128 v[80:83], v26 offset:0
    ds_read_b64_tr_b16 v[96:97], v30 offset:0
    ds_read_b64_tr_b16 v[98:99], v30 offset:512
    ds_read_b128 v[84:87], v27 offset:0
    ds_read_b64_tr_b16 v[100:101], v30 offset:2048
    ds_read_b64_tr_b16 v[102:103], v30 offset:2560
    ds_read_b128 v[88:91], v28 offset:0
    ds_read_b64_tr_b16 v[104:105], v30 offset:4096
    ds_read_b64_tr_b16 v[106:107], v30 offset:4608
    ds_read_b128 v[92:95], v29 offset:0
    ds_read_b64_tr_b16 v[108:109], v30 offset:6144
    ds_read_b64_tr_b16 v[110:111], v30 offset:6656
    s_waitcnt lgkmcnt(9)
    v_mfma_f32_32x32x16_bf16 v[64:79], v[80:83], v[96:99], v[64:79]
    s_waitcnt lgkmcnt(6)
    v_mfma_f32_32x32x16_bf16 v[64:79], v[84:87], v[100:103], v[64:79]
    s_waitcnt lgkmcnt(3)
    v_mfma_f32_32x32x16_bf16 v[64:79], v[88:91], v[104:107], v[64:79]
    s_waitcnt lgkmcnt(0)
    v_mfma_f32_32x32x16_bf16 v[64:79], v[92:95], v[108:111], v[64:79]
    s_nop 15
    s_barrier
    v_and_b32 v12, 31, v0
    v_bfe_u32 v13, v0, 5, 1
    s_lshl_b32 s33, s31, 5
    v_lshl_add_u32 v14, v13, 2, s33
    v_mul_u32_u24 v14, 144, v14
    s_lshl_b32 s33, s32, 5
    v_add_u32 v12, s33, v12
    v_lshl_add_u32 v14, v12, 1, v14
    v_cvt_pk_bf16_f32 v16, v64, v65
    v_lshlrev_b32 v17, 16, v16
    v_and_b32 v18, 0xffff0000, v16
    v_lshlrev_b32 v19, 16, v40
    v_and_b32 v16, 0xffff0000, v40
    v_add_f32 v17, v17, v19
    v_add_f32 v18, v18, v16
    v_cvt_pk_bf16_f32 v40, v17, v18
    ds_write_b16 v14, v40 offset:0
    ds_write_b16_d16_hi v14, v40 offset:144
    v_cvt_pk_bf16_f32 v16, v66, v67
    v_lshlrev_b32 v17, 16, v16
    v_and_b32 v18, 0xffff0000, v16
    v_lshlrev_b32 v19, 16, v41
    v_and_b32 v16, 0xffff0000, v41
    v_add_f32 v17, v17, v19
    v_add_f32 v18, v18, v16
    v_cvt_pk_bf16_f32 v41, v17, v18
    ds_write_b16 v14, v41 offset:288
    ds_write_b16_d16_hi v14, v41 offset:432
    buffer_store_dwordx2 v[40:41], v4, s[24:27], 0 offen offset:0
    v_cvt_pk_bf16_f32 v16, v68, v69
    v_lshlrev_b32 v17, 16, v16
    v_and_b32 v18, 0xffff0000, v16
    v_lshlrev_b32 v19, 16, v42
    v_and_b32 v16, 0xffff0000, v42
    v_add_f32 v17, v17, v19
    v_add_f32 v18, v18, v16
    v_cvt_pk_bf16_f32 v42, v17, v18
    ds_write_b16 v14, v42 offset:1152
    ds_write_b16_d16_hi v14, v42 offset:1296
    v_cvt_pk_bf16_f32 v16, v70, v71
    v_lshlrev_b32 v17, 16, v16
    v_and_b32 v18, 0xffff0000, v16
    v_lshlrev_b32 v19, 16, v43
    v_and_b32 v16, 0xffff0000, v43
    v_add_f32 v17, v17, v19
    v_add_f32 v18, v18, v16
    v_cvt_pk_bf16_f32 v43, v17, v18
    ds_write_b16 v14, v43 offset:1440
    ds_write_b16_d16_hi v14, v43 offset:1584
    buffer_store_dwordx2 v[42:43], v4, s[24:27], 0 offen offset:16
    v_cvt_pk_bf16_f32 v16, v72, v73
    v_lshlrev_b32 v17, 16, v16
    v_and_b32 v18, 0xffff0000, v16
    v_lshlrev_b32 v19, 16, v44
    v_and_b32 v16, 0xffff0000, v44
    v_add_f32 v17, v17, v19
    v_add_f32 v18, v18, v16
    v_cvt_pk_bf16_f32 v44, v17, v18
    ds_write_b16 v14, v44 offset:2304
    ds_write_b16_d16_hi v14, v44 offset:2448
    v_cvt_pk_bf16_f32 v16, v74, v75
    v_lshlrev_b32 v17, 16, v16
    v_and_b32 v18, 0xffff0000, v16
    v_lshlrev_b32 v19, 16, v45
    v_and_b32 v16, 0xffff0000, v45
    v_add_f32 v17, v17, v19
    v_add_f32 v18, v18, v16
    v_cvt_pk_bf16_f32 v45, v17, v18
    ds_write_b16 v14, v45 offset:2592
    ds_write_b16_d16_hi v14, v45 offset:2736
    buffer_store_dwordx2 v[44:45], v4, s[24:27], 0 offen offset:32
    v_cvt_pk_bf16_f32 v16, v76, v77
    v_lshlrev_b32 v17, 16, v16
    v_and_b32 v18, 0xffff0000, v16
    v_lshlrev_b32 v19, 16, v46
    v_and_b32 v16, 0xffff0000, v46
    v_add_f32 v17, v17, v19
    v_add_f32 v18, v18, v16
    v_cvt_pk_bf16_f32 v46, v17, v18
    ds_write_b16 v14, v46 offset:3456
    ds_write_b16_d16_hi v14, v46 offset:3600
    v_cvt_pk_bf16_f32 v16, v78, v79
    v_lshlrev_b32 v17, 16, v16
    v_and_b32 v18, 0xffff0000, v16
    v_lshlrev_b32 v19, 16, v47
    v_and_b32 v16, 0xffff0000, v47
    v_add_f32 v17, v17, v19
    v_add_f32 v18, v18, v16
    v_cvt_pk_bf16_f32 v47, v17, v18
    ds_write_b16 v14, v47 offset:3744
    ds_write_b16_d16_hi v14, v47 offset:3888
    buffer_store_dwordx2 v[46:47], v4, s[24:27], 0 offen offset:48
    s_waitcnt lgkmcnt(0)
    s_barrier
    v_lshrrev_b32 v12, 2, v0
    v_and_b32 v13, 3, v0
    v_mul_u32_u24 v14, 144, v12
    v_lshl_add_u32 v14, v13, 5, v14
    ds_read_b128 v[48:51], v14
    ds_read_b128 v[52:55], v14 offset:16
    s_lshl_b32 s33, s29, 6
    v_add_u32 v12, s33, v12
    s_waitcnt lgkmcnt(0)
    v_mov_b32 v62, 0
    v_mov_b32 v63, 0
    v_lshlrev_b32 v16, 16, v48
    v_and_b32 v17, 0xffff0000, v48
    v_add_f32 v62, v62, v16
    v_fma_f32 v63, v16, v16, v63
    v_add_f32 v62, v62, v17
    v_fma_f32 v63, v17, v17, v63
    v_lshlrev_b32 v16, 16, v49
    v_and_b32 v17, 0xffff0000, v49
    v_add_f32 v62, v62, v16
    v_fma_f32 v63, v16, v16, v63
    v_add_f32 v62, v62, v17
    v_fma_f32 v63, v17, v17, v63
    v_lshlrev_b32 v16, 16, v50
    v_and_b32 v17, 0xffff0000, v50
    v_add_f32 v62, v62, v16
    v_fma_f32 v63, v16, v16, v63
    v_add_f32 v62, v62, v17
    v_fma_f32 v63, v17, v17, v63
    v_lshlrev_b32 v16, 16, v51
    v_and_b32 v17, 0xffff0000, v51
    v_add_f32 v62, v62, v16
    v_fma_f32 v63, v16, v16, v63
    v_add_f32 v62, v62, v17
    v_fma_f32 v63, v17, v17, v63
    v_lshlrev_b32 v16, 16, v52
    v_and_b32 v17, 0xffff0000, v52
    v_add_f32 v62, v62, v16
    v_fma_f32 v63, v16, v16, v63
    v_add_f32 v62, v62, v17
    v_fma_f32 v63, v17, v17, v63
    v_lshlrev_b32 v16, 16, v53
    v_and_b32 v17, 0xffff0000, v53
    v_add_f32 v62, v62, v16
    v_fma_f32 v63, v16, v16, v63
    v_add_f32 v62, v62, v17
    v_fma_f32 v63, v17, v17, v63
    v_lshlrev_b32 v16, 16, v54
    v_and_b32 v17, 0xffff0000, v54
    v_add_f32 v62, v62, v16
    v_fma_f32 v63, v16, v16, v63
    v_add_f32 v62, v62, v17
    v_fma_f32 v63, v17, v17, v63
    v_lshlrev_b32 v16, 16, v55
    v_and_b32 v17, 0xffff0000, v55
    v_add_f32 v62, v62, v16
    v_fma_f32 v63, v16, v16, v63
    v_add_f32 v62, v62, v17
    v_fma_f32 v63, v17, v17, v63
    ds_swizzle_b32 v16, v62 offset:0x41f
    ds_swizzle_b32 v17, v63 offset:0x41f
    s_waitcnt lgkmcnt(0)
    v_add_f32 v62, v62, v16
    v_add_f32 v63, v63, v17
    ds_swizzle_b32 v16, v62 offset:0x81f
    ds_swizzle_b32 v17, v63 offset:0x81f
    s_waitcnt lgkmcnt(0)
    v_add_f32 v62, v62, v16
    v_add_f32 v63, v63, v17
    v_lshlrev_b32 v12, 3, v12
    v_cmp_eq_u32 vcc, 0, v13
    s_and_saveexec_b64 s[44:45], vcc
    buffer_atomic_add_f32 v62, v12, s[40:43], 0 offen
    buffer_atomic_add_f32 v63, v12, s[40:43], 0 offen offset:4
    s_mov_b64 exec, -1
gemm2a_kernel_end:
    s_endpgm
.section .rodata,"a"
.p2align 6
.amdhsa_kernel gemm2a_kernel
  .amdhsa_next_free_vgpr 128
  .amdhsa_next_free_sgpr 102
  .amdhsa_accum_offset 128
  .amdhsa_group_segment_fixed_size 0
  .amdhsa_kernarg_size 112
  .amdhsa_user_sgpr_count 2
  .amdhsa_user_sgpr_kernarg_segment_ptr 1
  .amdhsa_system_sgpr_workgroup_id_x 1
.end_amdhsa_kernel
.text
.globl conv2_kernel
.p2align 8
.type conv2_kernel,@function
conv2_kernel:
    s_cmp_ge_u32 s2, 512
    s_cbranch_scc1 conv2_kernel_end
    s_load_dwordx2 s[4:5], s[0:1], 48
    s_load_dwordx2 s[6:7], s[0:1], 104
    s_and_b32 s24, s2, 0x1fe
    s_lshl_b32 s24, s24, 1
    s_waitcnt lgkmcnt(0)
    s_load_dword s25, s[4:5], s24
    s_add_u32 s8, s6, 0x600000
    s_addc_u32 s9, s7, 0
    s_mov_b32 s10, 0x220000
    s_mov_b32 s11, 0x00020000
    s_add_u32 s12, s6, 0x900000
    s_addc_u32 s13, s7, 0
    s_mov_b32 s14, 0x220000
    s_mov_b32 s15, 0x00020000
    s_add_u32 s16, s6, 0x1400000
    s_addc_u32 s17, s7, 0
    s_mov_b32 s18, 0x480000
    s_mov_b32 s19, 0x00020000
    s_add_u32 s20, s6, 0x1c04000
    s_addc_u32 s21, s7, 0
    s_mov_b32 s22, 0x4000
    s_mov_b32 s23, 0x00020000
    s_mul_i32 s26, s2, 4352
    v_lshl_add_u32 v1, v0, 4, s26
    buffer_load_dwordx4 v[4:7], v1, s[8:11], 0 offen
    v_lshlrev_b32 v2, 6, v0
    buffer_load_dwordx4 v[32:35], v2, s[20:23], 0 offen
    buffer_load_dwordx4 v[36:39], v2, s[20:23], 0 offen offset:16
    buffer_load_dwordx4 v[40:43], v2, s[20:23], 0 offen offset:32
    buffer_load_dwordx4 v[44:47], v2, s[20:23], 0 offen offset:48
    s_mul_i32 s27, s2, 9216
    v_lshl_add_u32 v2, v0, 4, s27
    buffer_load_dwordx4 v[48:51], v2, s[16:19], 0 offen
    v_add_u32 v3, 0x1000, v2
    buffer_load_dwordx4 v[52:55], v3, s[16:19], 0 offen
    v_add_u32 v3, 0x2000, v2
    v_cmp_gt_u32 vcc, 64, v0
    s_and_saveexec_b64 s[28:29], vcc
    buffer_load_dwordx4 v[56:59], v3, s[16:19], 0 offen
    s_mov_b64 exec, s[28:29]
    v_mov_b32 v60, 0
    v_mov_b32 v61, 0
    v_mov_b32 v62, 0
    v_mov_b32 v63, 0
    v_lshrrev_b32 v3, 4, v0
    v_mul_u32_u24 v3, 4384, v3
    v_and_b32 v2, 15, v0
    v_lshl_add_u32 v3, v2, 4, v3
    v_cmp_gt_u32 vcc, 128, v0
    s_and_saveexec_b64 s[28:29], vcc
    ds_write_b128 v3, v[60:63] offset:4112
    s_mov_b64 exec, s[28:29]
    v_mov_b32 v3, 44288
    v_cmp_eq_u32 vcc, 0, v0
    s_and_saveexec_b64 s[28:29], vcc
    ds_write_b128 v3, v[60:63]
    s_mov_b64 exec, s[28:29]
    s_mov_b32 s30, 0x3b000000
    s_mov_b32 s31, 0x3727c5ac
    s_waitcnt vmcnt(3)
    v_lshlrev_b32 v8, 16, v4
    v_and_b32 v9, 0xffff0000, v4
    v_lshlrev_b32 v10, 16, v5
    v_and_b32 v11, 0xffff0000, v5
    v_lshlrev_b32 v12, 16, v6
    v_and_b32 v13, 0xffff0000, v6
    v_lshlrev_b32 v14, 16, v7
    v_and_b32 v15, 0xffff0000, v7
    v_mul_f32 v32, s30, v32
    v_mul_f32 v33, s30, v33
    v_fma_f32 v33, -v32, v32, v33
    v_max_f32 v33, 0, v33
    v_cvt_pk_bf16_f32 v32, v32, v33
    v_and_b32 v33, 0xffff0000, v32
    v_lshlrev_b32 v32, 16, v32
    v_add_f32 v33, s31, v33
    v_sub_f32 v16, v8, v32
    v_cvt_pk_bf16_f32 v33, v33, v16
    v_and_b32 v16, 0xffff0000, v33
    v_lshlrev_b32 v33, 16, v33
    v_sqrt_f32 v33, v33
    s_nop 0
    v_cvt_pk_bf16_f32 v33, v33, v33
    v_lshlrev_b32 v33, 16, v33
    v_rcp_f32 v32, v33
    s_nop 0
    v_mul_f32 v60, v16, v32
    v_fma_f32 v61, -v60, v33, v16
    v_fma_f32 v16, v61, v32, v60
    v_mul_f32 v34, s30, v34
    v_mul_f32 v35, s30, v35
    v_fma_f32 v35, -v34, v34, v35
    v_max_f32 v35, 0, v35
    v_cvt_pk_bf16_f32 v34, v34, v35
    v_and_b32 v35, 0xffff0000, v34
    v_lshlrev_b32 v34, 16, v34
    v_add_f32 v35, s31, v35
    v_sub_f32 v17, v9, v34
    v_cvt_pk_bf16_f32 v35, v35, v17
    v_and_b32 v17, 0xffff0000, v35
    v_lshlrev_b32 v35, 16, v35
    v_sqrt_f32 v35, v35
    s_nop 0
    v_cvt_pk_bf16_f32 v35, v35, v35
    v_lshlrev_b32 v35, 16, v35
    v_rcp_f32 v34, v35
    s_nop 0
    v_mul_f32 v60, v17, v34
    v_fma_f32 v61, -v60, v35, v17
    v_fma_f32 v17, v61, v34, v60
    v_mul_f32 v36, s30, v36
    v_mul_f32 v37, s30, v37
    v_fma_f32 v37, -v36, v36, v37
    v_max_f32 v37, 0, v37
    v_cvt_pk_bf16_f32 v36, v36, v37
    v_and_b32 v37, 0xffff0000, v36
    v_lshlrev_b32 v36, 16, v36
    v_add_f32 v37, s31, v37
    v_sub_f32 v18, v10, v36
    v_cvt_pk_bf16_f32 v37, v37, v18
    v_and_b32 v18, 0xffff0000, v37
    v_lshlrev_b32 v37, 16, v37
    v_sqrt_f32 v37, v37
    s_nop 0
    v_cvt_pk_bf16_f32 v37, v37, v37
    v_lshlrev_b32 v37, 16, v37
    v_rcp_f32 v36, v37
    s_nop 0
    v_mul_f32 v60, v18, v36
    v_fma_f32 v61, -v60, v37, v18
    v_fma_f32 v18, v61, v36, v60
    v_mul_f32 v38, s30, v38
    v_mul_f32 v39, s30, v39
    v_fma_f32 v39, -v38, v38, v39
    v_max_f32 v39, 0, v39
    v_cvt_pk_bf16_f32 v38, v38, v39
    v_and_b32 v39, 0xffff0000, v38
    v_lshlrev_b32 v38, 16, v38
    v_add_f32 v39, s31, v39
    v_sub_f32 v19, v11, v38
    v_cvt_pk_bf16_f32 v39, v39, v19
    v_and_b32 v19, 0xffff0000, v39
    v_lshlrev_b32 v39, 16, v39
    v_sqrt_f32 v39, v39
    s_nop 0
    v_cvt_pk_bf16_f32 v39, v39, v39
    v_lshlrev_b32 v39, 16, v39
    v_rcp_f32 v38, v39
    s_nop 0
    v_mul_f32 v60, v19, v38
    v_fma_f32 v61, -v60, v39, v19
    v_fma_f32 v19, v61, v38, v60
    v_mul_f32 v40, s30, v40
    v_mul_f32 v41, s30, v41
    v_fma_f32 v41, -v40, v40, v41
    v_max_f32 v41, 0, v41
    v_cvt_pk_bf16_f32 v40, v40, v41
    v_and_b32 v41, 0xffff0000, v40
    v_lshlrev_b32 v40, 16, v40
    v_add_f32 v41, s31, v41
    v_sub_f32 v20, v12, v40
    v_cvt_pk_bf16_f32 v41, v41, v20
    v_and_b32 v20, 0xffff0000, v41
    v_lshlrev_b32 v41, 16, v41
    v_sqrt_f32 v41, v41
    s_nop 0
    v_cvt_pk_bf16_f32 v41, v41, v41
    v_lshlrev_b32 v41, 16, v41
    v_rcp_f32 v40, v41
    s_nop 0
    v_mul_f32 v60, v20, v40
    v_fma_f32 v61, -v60, v41, v20
    v_fma_f32 v20, v61, v40, v60
    v_mul_f32 v42, s30, v42
    v_mul_f32 v43, s30, v43
    v_fma_f32 v43, -v42, v42, v43
    v_max_f32 v43, 0, v43
    v_cvt_pk_bf16_f32 v42, v42, v43
    v_and_b32 v43, 0xffff0000, v42
    v_lshlrev_b32 v42, 16, v42
    v_add_f32 v43, s31, v43
    v_sub_f32 v21, v13, v42
    v_cvt_pk_bf16_f32 v43, v43, v21
    v_and_b32 v21, 0xffff0000, v43
    v_lshlrev_b32 v43, 16, v43
    v_sqrt_f32 v43, v43
    s_nop 0
    v_cvt_pk_bf16_f32 v43, v43, v43
    v_lshlrev_b32 v43, 16, v43
    v_rcp_f32 v42, v43
    s_nop 0
    v_mul_f32 v60, v21, v42
    v_fma_f32 v61, -v60, v43, v21
    v_fma_f32 v21, v61, v42, v60
    v_mul_f32 v44, s30, v44
    v_mul_f32 v45, s30, v45
    v_fma_f32 v45, -v44, v44, v45
    v_max_f32 v45, 0, v45
    v_cvt_pk_bf16_f32 v44, v44, v45
    v_and_b32 v45, 0xffff0000, v44
    v_lshlrev_b32 v44, 16, v44
    v_add_f32 v45, s31, v45
    v_sub_f32 v22, v14, v44
    v_cvt_pk_bf16_f32 v45, v45, v22
    v_and_b32 v22, 0xffff0000, v45
    v_lshlrev_b32 v45, 16, v45
    v_sqrt_f32 v45, v45
    s_nop 0
    v_cvt_pk_bf16_f32 v45, v45, v45
    v_lshlrev_b32 v45, 16, v45
    v_rcp_f32 v44, v45
    s_nop 0
    v_mul_f32 v60, v22, v44
    v_fma_f32 v61, -v60, v45, v22
    v_fma_f32 v22, v61, v44, v60
    v_mul_f32 v46, s30, v46
    v_mul_f32 v47, s30, v47
    v_fma_f32 v47, -v46, v46, v47
    v_max_f32 v47, 0, v47
    v_cvt_pk_bf16_f32 v46, v46, v47
    v_and_b32 v47, 0xffff0000, v46
    v_lshlrev_b32 v46, 16, v46
    v_add_f32 v47, s31, v47
    v_sub_f32 v23, v15, v46
    v_cvt_pk_bf16_f32 v47, v47, v23
    v_and_b32 v23, 0xffff0000, v47
    v_lshlrev_b32 v47, 16, v47
    v_sqrt_f32 v47, v47
    s_nop 0
    v_cvt_pk_bf16_f32 v47, v47, v47
    v_lshlrev_b32 v47, 16, v47
    v_rcp_f32 v46, v47
    s_nop 0
    v_mul_f32 v60, v23, v46
    v_fma_f32 v61, -v60, v47, v23
    v_fma_f32 v23, v61, v46, v60
    v_cvt_pk_bf16_f32 v24, v16, v17
    v_cvt_pk_bf16_f32 v25, v18, v19
    v_cvt_pk_bf16_f32 v26, v20, v21
    v_cvt_pk_bf16_f32 v27, v22, v23
    v_lshlrev_b32 v16, 16, v24
    v_and_b32 v17, 0xffff0000, v24
    v_lshlrev_b32 v18, 16, v25
    v_and_b32 v19, 0xffff0000, v25
    v_lshlrev_b32 v20, 16, v26
    v_and_b32 v21, 0xffff0000, v26
    v_lshlrev_b32 v22, 16, v27
    v_and_b32 v23, 0xffff0000, v27
    v_lshlrev_b32 v3, 4, v0
    ds_write_b128 v3, v[24:27] offset:44304
    s_waitcnt vmcnt(0)
    ds_write_b128 v3, v[48:51] offset:35072
    ds_write_b128 v3, v[52:55] offset:39168
    v_cmp_gt_u32 vcc, 64, v0
    s_and_saveexec_b64 s[28:29], vcc
    ds_write_b128 v3, v[56:59] offset:43264
    s_mov_b64 exec, s[28:29]
    s_waitcnt lgkmcnt(0)
    s_barrier
    ds_read_b128 v[32:35], v3 offset:44288
    s_mov_b32 s31, 0xffff
    v_sub_u32 v2, 4096, v3
    s_waitcnt lgkmcnt(0)
    v_bfi_b32 v36, s31, v24, v35
    v_bfi_b32 v37, s31, v35, v34
    v_bfi_b32 v38, s31, v34, v33
    v_bfi_b32 v39, s31, v33, v32
    ds_write_b128 v2, v[36:39] offset:0
    v_alignbit_b32 v40, v24, v24, 16
    v_alignbit_b32 v41, v35, v35, 16
    v_alignbit_b32 v42, v34, v34, 16
    v_alignbit_b32 v43, v33, v33, 16
    ds_write_b128 v2, v[40:43] offset:4384
    v_bfi_b32 v36, s31, v25, v24
    v_bfi_b32 v37, s31, v24, v35
    v_bfi_b32 v38, s31, v35, v34
    v_bfi_b32 v39, s31, v34, v33
    ds_write_b128 v2, v[36:39] offset:8768
    v_alignbit_b32 v40, v25, v25, 16
    v_alignbit_b32 v41, v24, v24, 16
    v_alignbit_b32 v42, v35, v35, 16
    v_alignbit_b32 v43, v34, v34, 16
    ds_write_b128 v2, v[40:43] offset:13152
    v_bfi_b32 v36, s31, v26, v25
    v_bfi_b32 v37, s31, v25, v24
    v_bfi_b32 v38, s31, v24, v35
    v_bfi_b32 v39, s31, v35, v34
    ds_write_b128 v2, v[36:39] offset:17536
    v_alignbit_b32 v40, v26, v26, 16
    v_alignbit_b32 v41, v25, v25, 16
    v_alignbit_b32 v42, v24, v24, 16
    v_alignbit_b32 v43, v35, v35, 16
    ds_write_b128 v2, v[40:43] offset:21920
    v_bfi_b32 v36, s31, v27, v26
    v_bfi_b32 v37, s31, v26, v25
    v_bfi_b32 v38, s31, v25, v24
    v_bfi_b32 v39, s31, v24, v35
    ds_write_b128 v2, v[36:39] offset:26304
    v_alignbit_b32 v40, v27, v27, 16
    v_alignbit_b32 v41, v26, v26, 16
    v_alignbit_b32 v42, v25, v25, 16
    v_alignbit_b32 v43, v24, v24, 16
    ds_write_b128 v2, v[40:43] offset:30688
    v_and_b32 v1, 15, v0
    v_bfe_u32 v2, v0, 4, 2
    v_lshrrev_b32 v3, 6, v0
    v_add_u32 v4, v1, v2
    v_lshlrev_b32 v4, 4, v4
    v_lshl_add_u32 v4, v3, 7, v4
    v_and_b32 v5, 7, v1
    v_lshrrev_b32 v6, 3, v1
    v_lshlrev_b32 v7, 8, v6
    v_mul_u32_u24 v5, 4384, v5
    v_sub_u32 v5, v5, v7
    v_add_u32 v5, 272, v5
    v_lshl_add_u32 v5, v3, 7, v5
    v_lshl_add_u32 v5, v2, 4, v5
    s_waitcnt lgkmcnt(0)
    s_barrier
    v_mov_b32 v224, 0
    v_mov_b32 v225, 0
    v_mov_b32 v226, 0
    v_mov_b32 v227, 0
    v_mov_b32 v228, 0
    v_mov_b32 v229, 0
    v_mov_b32 v230, 0
    v_mov_b32 v231, 0
    v_mov_b32 v232, 0
    v_mov_b32 v233, 0
    v_mov_b32 v234, 0
    v_mov_b32 v235, 0
    v_mov_b32 v236, 0
    v_mov_b32 v237, 0
    v_mov_b32 v238, 0
    v_mov_b32 v239, 0
    v_mov_b32 v240, 0
    v_mov_b32 v241, 0
    v_mov_b32 v242, 0
    v_mov_b32 v243, 0
    v_mov_b32 v244, 0
    v_mov_b32 v245, 0
    v_mov_b32 v246, 0
    v_mov_b32 v247, 0
    v_mov_b32 v248, 0
    v_mov_b32 v249, 0
    v_mov_b32 v250, 0
    v_mov_b32 v251, 0
    v_mov_b32 v252, 0
    v_mov_b32 v253, 0
    v_mov_b32 v254, 0
    v_mov_b32 v255, 0
    ds_read_b128 v[96:99], v5 offset:3584
    ds_read_b128 v[32:35], v4 offset:35072
    ds_read_b128 v[64:67], v4 offset:39680
    ds_read_b128 v[100:103], v5 offset:3072
    ds_read_b128 v[36:39], v4 offset:35584
    ds_read_b128 v[68:71], v4 offset:40192
    ds_read_b128 v[104:107], v5 offset:2560
    ds_read_b128 v[40:43], v4 offset:36096
    ds_read_b128 v[72:75], v4 offset:40704
    ds_read_b128 v[108:111], v5 offset:2048
    ds_read_b128 v[44:47], v4 offset:36608
    ds_read_b128 v[76:79], v4 offset:41216
    s_waitcnt lgkmcnt(9)
    v_mfma_f32_16x16x32_bf16 v[224:227], v[32:35], v[96:99], v[224:227]
    v_mfma_f32_16x16x32_bf16 v[224:227], v[64:67], v[96:99], v[224:227]
    ds_read_b128 v[112:115], v5 offset:1536
    ds_read_b128 v[48:51], v4 offset:37120
    ds_read_b128 v[80:83], v4 offset:41728
    s_waitcnt lgkmcnt(9)
    v_mfma_f32_16x16x32_bf16 v[228:231], v[36:39], v[96:99], v[228:231]
    v_mfma_f32_16x16x32_bf16 v[232:235], v[36:39], v[100:103], v[232:235]
    v_mfma_f32_16x16x32_bf16 v[228:231], v[32:35], v[100:103], v[228:231]
    v_mfma_f32_16x16x32_bf16 v[228:231], v[68:71], v[96:99], v[228:231]
    v_mfma_f32_16x16x32_bf16 v[232:235], v[68:71], v[100:103], v[232:235]
    v_mfma_f32_16x16x32_bf16 v[228:231], v[64:67], v[100:103], v[228:231]
    ds_read_b128 v[116:119], v5 offset:1024
    ds_read_b128 v[52:55], v4 offset:37632
    ds_read_b128 v[84:87], v4 offset:42240
    s_waitcnt lgkmcnt(9)
    v_mfma_f32_16x16x32_bf16 v[232:235], v[40:43], v[96:99], v[232:235]
    v_mfma_f32_16x16x32_bf16 v[236:239], v[40:43], v[100:103], v[236:239]
    v_mfma_f32_16x16x32_bf16 v[240:243], v[40:43], v[104:107], v[240:243]
    v_mfma_f32_16x16x32_bf16 v[232:235], v[32:35], v[104:107], v[232:235]
    v_mfma_f32_16x16x32_bf16 v[236:239], v[36:39], v[104:107], v[236:239]
    v_mfma_f32_16x16x32_bf16 v[232:235], v[72:75], v[96:99], v[232:235]
    v_mfma_f32_16x16x32_bf16 v[236:239], v[72:75], v[100:103], v[236:239]
    v_mfma_f32_16x16x32_bf16 v[240:243], v[72:75], v[104:107], v[240:243]
    v_mfma_f32_16x16x32_bf16 v[232:235], v[64:67], v[104:107], v[232:235]
    v_mfma_f32_16x16x32_bf16 v[236:239], v[68:71], v[104:107], v[236:239]
    ds_read_b128 v[120:123], v5 offset:512
    ds_read_b128 v[56:59], v4 offset:38144
    ds_read_b128 v[88:91], v4 offset:42752
    s_waitcnt lgkmcnt(9)
    v_mfma_f32_16x16x32_bf16 v[236:239], v[44:47], v[96:99], v[236:239]
    v_mfma_f32_16x16x32_bf16 v[240:243], v[44:47], v[100:103], v[240:243]
    v_mfma_f32_16x16x32_bf16 v[244:247], v[44:47], v[104:107], v[244:247]
    v_mfma_f32_16x16x32_bf16 v[248:251], v[44:47], v[108:111], v[248:251]
    v_mfma_f32_16x16x32_bf16 v[236:239], v[32:35], v[108:111], v[236:239]
    v_mfma_f32_16x16x32_bf16 v[240:243], v[36:39], v[108:111], v[240:243]
    v_mfma_f32_16x16x32_bf16 v[244:247], v[40:43], v[108:111], v[244:247]
    v_mfma_f32_16x16x32_bf16 v[236:239], v[76:79], v[96:99], v[236:239]
    v_mfma_f32_16x16x32_bf16 v[240:243], v[76:79], v[100:103], v[240:243]
    v_mfma_f32_16x16x32_bf16 v[244:247], v[76:79], v[104:107], v[244:247]
    v_mfma_f32_16x16x32_bf16 v[248:251], v[76:79], v[108:111], v[248:251]
    v_mfma_f32_16x16x32_bf16 v[236:239], v[64:67], v[108:111], v[236:239]
    v_mfma_f32_16x16x32_bf16 v[240:243], v[68:71], v[108:111], v[240:243]
    v_mfma_f32_16x16x32_bf16 v[244:247], v[72:75], v[108:111], v[244:247]
    ds_read_b128 v[124:127], v5 offset:0
    ds_read_b128 v[60:63], v4 offset:38656
    ds_read_b128 v[92:95], v4 offset:43264
    s_waitcnt lgkmcnt(9)
    v_mfma_f32_16x16x32_bf16 v[240:243], v[48:51], v[96:99], v[240:243]
    v_mfma_f32_16x16x32_bf16 v[244:247], v[48:51], v[100:103], v[244:247]
    v_mfma_f32_16x16x32_bf16 v[248:251], v[48:51], v[104:107], v[248:251]
    v_mfma_f32_16x16x32_bf16 v[252:255], v[48:51], v[108:111], v[252:255]
    v_mfma_f32_16x16x32_bf16 v[240:243], v[32:35], v[112:115], v[240:243]
    v_mfma_f32_16x16x32_bf16 v[244:247], v[36:39], v[112:115], v[244:247]
    v_mfma_f32_16x16x32_bf16 v[248:251], v[40:43], v[112:115], v[248:251]
    v_mfma_f32_16x16x32_bf16 v[252:255], v[44:47], v[112:115], v[252:255]
    v_mfma_f32_16x16x32_bf16 v[240:243], v[80:83], v[96:99], v[240:243]
    v_mfma_f32_16x16x32_bf16 v[244:247], v[80:83], v[100:103], v[244:247]
    v_mfma_f32_16x16x32_bf16 v[248:251], v[80:83], v[104:107], v[248:251]
    v_mfma_f32_16x16x32_bf16 v[252:255], v[80:83], v[108:111], v[252:255]
    v_mfma_f32_16x16x32_bf16 v[240:243], v[64:67], v[112:115], v[240:243]
    v_mfma_f32_16x16x32_bf16 v[244:247], v[68:71], v[112:115], v[244:247]
    v_mfma_f32_16x16x32_bf16 v[248:251], v[72:75], v[112:115], v[248:251]
    v_mfma_f32_16x16x32_bf16 v[252:255], v[76:79], v[112:115], v[252:255]
    ds_read_b128 v[192:195], v5 offset:3648
    ds_read_b128 v[128:131], v4 offset:35136
    ds_read_b128 v[160:163], v4 offset:39744
    s_waitcnt lgkmcnt(9)
    v_mfma_f32_16x16x32_bf16 v[244:247], v[52:55], v[96:99], v[244:247]
    v_mfma_f32_16x16x32_bf16 v[248:251], v[52:55], v[100:103], v[248:251]
    v_mfma_f32_16x16x32_bf16 v[252:255], v[52:55], v[104:107], v[252:255]
    v_mfma_f32_16x16x32_bf16 v[244:247], v[32:35], v[116:119], v[244:247]
    v_mfma_f32_16x16x32_bf16 v[248:251], v[36:39], v[116:119], v[248:251]
    v_mfma_f32_16x16x32_bf16 v[252:255], v[40:43], v[116:119], v[252:255]
    v_mfma_f32_16x16x32_bf16 v[244:247], v[84:87], v[96:99], v[244:247]
    v_mfma_f32_16x16x32_bf16 v[248:251], v[84:87], v[100:103], v[248:251]
    v_mfma_f32_16x16x32_bf16 v[252:255], v[84:87], v[104:107], v[252:255]
    v_mfma_f32_16x16x32_bf16 v[244:247], v[64:67], v[116:119], v[244:247]
    v_mfma_f32_16x16x32_bf16 v[248:251], v[68:71], v[116:119], v[248:251]
    v_mfma_f32_16x16x32_bf16 v[252:255], v[72:75], v[116:119], v[252:255]
    ds_read_b128 v[196:199], v5 offset:3136
    ds_read_b128 v[132:135], v4 offset:35648
    ds_read_b128 v[164:167], v4 offset:40256
    s_waitcnt lgkmcnt(9)
    v_mfma_f32_16x16x32_bf16 v[248:251], v[56:59], v[96:99], v[248:251]
    v_mfma_f32_16x16x32_bf16 v[252:255], v[56:59], v[100:103], v[252:255]
    v_mfma_f32_16x16x32_bf16 v[248:251], v[32:35], v[120:123], v[248:251]
    v_mfma_f32_16x16x32_bf16 v[252:255], v[36:39], v[120:123], v[252:255]
    v_mfma_f32_16x16x32_bf16 v[248:251], v[88:91], v[96:99], v[248:251]
    v_mfma_f32_16x16x32_bf16 v[252:255], v[88:91], v[100:103], v[252:255]
    v_mfma_f32_16x16x32_bf16 v[248:251], v[64:67], v[120:123], v[248:251]
    v_mfma_f32_16x16x32_bf16 v[252:255], v[68:71], v[120:123], v[252:255]
    ds_read_b128 v[200:203], v5 offset:2624
    ds_read_b128 v[136:139], v4 offset:36160
    ds_read_b128 v[168:171], v4 offset:40768
    s_waitcnt lgkmcnt(9)
    v_mfma_f32_16x16x32_bf16 v[252:255], v[60:63], v[96:99], v[252:255]
    v_mfma_f32_16x16x32_bf16 v[252:255], v[32:35], v[124:127], v[252:255]
    v_mfma_f32_16x16x32_bf16 v[252:255], v[92:95], v[96:99], v[252:255]
    v_mfma_f32_16x16x32_bf16 v[252:255], v[64:67], v[124:127], v[252:255]
    ds_read_b128 v[204:207], v5 offset:2112
    ds_read_b128 v[140:143], v4 offset:36672
    ds_read_b128 v[172:175], v4 offset:41280
    s_waitcnt lgkmcnt(9)
    v_mfma_f32_16x16x32_bf16 v[224:227], v[128:131], v[192:195], v[224:227]
    v_mfma_f32_16x16x32_bf16 v[224:227], v[160:163], v[192:195], v[224:227]
    ds_read_b128 v[208:211], v5 offset:1600
    ds_read_b128 v[144:147], v4 offset:37184
    ds_read_b128 v[176:179], v4 offset:41792
    s_waitcnt lgkmcnt(9)
    v_mfma_f32_16x16x32_bf16 v[228:231], v[132:135], v[192:195], v[228:231]
    v_mfma_f32_16x16x32_bf16 v[232:235], v[132:135], v[196:199], v[232:235]
    v_mfma_f32_16x16x32_bf16 v[228:231], v[128:131], v[196:199], v[228:231]
    v_mfma_f32_16x16x32_bf16 v[228:231], v[164:167], v[192:195], v[228:231]
    v_mfma_f32_16x16x32_bf16 v[232:235], v[164:167], v[196:199], v[232:235]
    v_mfma_f32_16x16x32_bf16 v[228:231], v[160:163], v[196:199], v[228:231]
    ds_read_b128 v[212:215], v5 offset:1088
    ds_read_b128 v[148:151], v4 offset:37696
    ds_read_b128 v[180:183], v4 offset:42304
    s_waitcnt lgkmcnt(9)
    v_mfma_f32_16x16x32_bf16 v[232:235], v[136:139], v[192:195], v[232:235]
    v_mfma_f32_16x16x32_bf16 v[236:239], v[136:139], v[196:199], v[236:239]
    v_mfma_f32_16x16x32_bf16 v[240:243], v[136:139], v[200:203], v[240:243]
    v_mfma_f32_16x16x32_bf16 v[232:235], v[128:131], v[200:203], v[232:235]
    v_mfma_f32_16x16x32_bf16 v[236:239], v[132:135], v[200:203], v[236:239]
    v_mfma_f32_16x16x32_bf16 v[232:235], v[168:171], v[192:195], v[232:235]
    v_mfma_f32_16x16x32_bf16 v[236:239], v[168:171], v[196:199], v[236:239]
    v_mfma_f32_16x16x32_bf16 v[240:243], v[168:171], v[200:203], v[240:243]
    v_mfma_f32_16x16x32_bf16 v[232:235], v[160:163], v[200:203], v[232:235]
    v_mfma_f32_16x16x32_bf16 v[236:239], v[164:167], v[200:203], v[236:239]
    ds_read_b128 v[216:219], v5 offset:576
    ds_read_b128 v[152:155], v4 offset:38208
    ds_read_b128 v[184:187], v4 offset:42816
    s_waitcnt lgkmcnt(9)
    v_mfma_f32_16x16x32_bf16 v[236:239], v[140:143], v[192:195], v[236:239]
    v_mfma_f32_16x16x32_bf16 v[240:243], v[140:143], v[196:199], v[240:243]
    v_mfma_f32_16x16x32_bf16 v[244:247], v[140:143], v[200:203], v[244:247]
    v_mfma_f32_16x16x32_bf16 v[248:251], v[140:143], v[204:207], v[248:251]
    v_mfma_f32_16x16x32_bf16 v[236:239], v[128:131], v[204:207], v[236:239]
    v_mfma_f32_16x16x32_bf16 v[240:243], v[132:135], v[204:207], v[240:243]
    v_mfma_f32_16x16x32_bf16 v[244:247], v[136:139], v[204:207], v[244:247]
    v_mfma_f32_16x16x32_bf16 v[236:239], v[172:175], v[192:195], v[236:239]
    v_mfma_f32_16x16x32_bf16 v[240:243], v[172:175], v[196:199], v[240:243]
    v_mfma_f32_16x16x32_bf16 v[244:247], v[172:175], v[200:203], v[244:247]
    v_mfma_f32_16x16x32_bf16 v[248:251], v[172:175], v[204:207], v[248:251]
    v_mfma_f32_16x16x32_bf16 v[236:239], v[160:163], v[204:207], v[236:239]
    v_mfma_f32_16x16x32_bf16 v[240:243], v[164:167], v[204:207], v[240:243]
    v_mfma_f32_16x16x32_bf16 v[244:247], v[168:171], v[204:207], v[244:247]
    ds_read_b128 v[220:223], v5 offset:64
    ds_read_b128 v[156:159], v4 offset:38720
    ds_read_b128 v[188:191], v4 offset:43328
    s_waitcnt lgkmcnt(9)
    v_mfma_f32_16x16x32_bf16 v[240:243], v[144:147], v[192:195], v[240:243]
    v_mfma_f32_16x16x32_bf16 v[244:247], v[144:147], v[196:199], v[244:247]
    v_mfma_f32_16x16x32_bf16 v[248:251], v[144:147], v[200:203], v[248:251]
    v_mfma_f32_16x16x32_bf16 v[252:255], v[144:147], v[204:207], v[252:255]
    v_mfma_f32_16x16x32_bf16 v[240:243], v[128:131], v[208:211], v[240:243]
    v_mfma_f32_16x16x32_bf16 v[244:247], v[132:135], v[208:211], v[244:247]
    v_mfma_f32_16x16x32_bf16 v[248:251], v[136:139], v[208:211], v[248:251]
    v_mfma_f32_16x16x32_bf16 v[252:255], v[140:143], v[208:211], v[252:255]
    v_mfma_f32_16x16x32_bf16 v[240:243], v[176:179], v[192:195], v[240:243]
    v_mfma_f32_16x16x32_bf16 v[244:247], v[176:179], v[196:199], v[244:247]
    v_mfma_f32_16x16x32_bf16 v[248:251], v[176:179], v[200:203], v[248:251]
    v_mfma_f32_16x16x32_bf16 v[252:255], v[176:179], v[204:207], v[252:255]
    v_mfma_f32_16x16x32_bf16 v[240:243], v[160:163], v[208:211], v[240:243]
    v_mfma_f32_16x16x32_bf16 v[244:247], v[164:167], v[208:211], v[244:247]
    v_mfma_f32_16x16x32_bf16 v[248:251], v[168:171], v[208:211], v[248:251]
    v_mfma_f32_16x16x32_bf16 v[252:255], v[172:175], v[208:211], v[252:255]
    s_waitcnt lgkmcnt(6)
    v_mfma_f32_16x16x32_bf16 v[244:247], v[148:151], v[192:195], v[244:247]
    v_mfma_f32_16x16x32_bf16 v[248:251], v[148:151], v[196:199], v[248:251]
    v_mfma_f32_16x16x32_bf16 v[252:255], v[148:151], v[200:203], v[252:255]
    v_mfma_f32_16x16x32_bf16 v[244:247], v[128:131], v[212:215], v[244:247]
    v_mfma_f32_16x16x32_bf16 v[248:251], v[132:135], v[212:215], v[248:251]
    v_mfma_f32_16x16x32_bf16 v[252:255], v[136:139], v[212:215], v[252:255]
    v_mfma_f32_16x16x32_bf16 v[244:247], v[180:183], v[192:195], v[244:247]
    v_mfma_f32_16x16x32_bf16 v[248:251], v[180:183], v[196:199], v[248:251]
    v_mfma_f32_16x16x32_bf16 v[252:255], v[180:183], v[200:203], v[252:255]
    v_mfma_f32_16x16x32_bf16 v[244:247], v[160:163], v[212:215], v[244:247]
    v_mfma_f32_16x16x32_bf16 v[248:251], v[164:167], v[212:215], v[248:251]
    v_mfma_f32_16x16x32_bf16 v[252:255], v[168:171], v[212:215], v[252:255]
    s_waitcnt lgkmcnt(3)
    v_mfma_f32_16x16x32_bf16 v[248:251], v[152:155], v[192:195], v[248:251]
    v_mfma_f32_16x16x32_bf16 v[252:255], v[152:155], v[196:199], v[252:255]
    v_mfma_f32_16x16x32_bf16 v[248:251], v[128:131], v[216:219], v[248:251]
    v_mfma_f32_16x16x32_bf16 v[252:255], v[132:135], v[216:219], v[252:255]
    v_mfma_f32_16x16x32_bf16 v[248:251], v[184:187], v[192:195], v[248:251]
    v_mfma_f32_16x16x32_bf16 v[252:255], v[184:187], v[196:199], v[252:255]
    v_mfma_f32_16x16x32_bf16 v[248:251], v[160:163], v[216:219], v[248:251]
    v_mfma_f32_16x16x32_bf16 v[252:255], v[164:167], v[216:219], v[252:255]
    s_waitcnt lgkmcnt(0)
    v_mfma_f32_16x16x32_bf16 v[252:255], v[156:159], v[192:195], v[252:255]
    v_mfma_f32_16x16x32_bf16 v[252:255], v[128:131], v[220:223], v[252:255]
    v_mfma_f32_16x16x32_bf16 v[252:255], v[188:191], v[192:195], v[252:255]
    v_mfma_f32_16x16x32_bf16 v[252:255], v[160:163], v[220:223], v[252:255]
    s_nop 15
    s_barrier
    v_and_b32 v1, 15, v0
    v_bfe_u32 v2, v0, 4, 2
    v_lshrrev_b32 v3, 6, v0
    v_and_b32 v5, 7, v1
    v_lshrrev_b32 v6, 3, v1
    v_and_b32 v7, 1, v2
    v_lshlrev_b32 v7, 3, v7
    v_lshl_add_u32 v7, v6, 4, v7
    v_lshl_add_u32 v5, v6, 7, v5
    v_lshl_add_u32 v5, v2, 5, v5
    v_lshl_add_u32 v5, v3, 11, v5
    v_xor_b32 v32, 0, v7
    v_add_lshl_u32 v32, v32, v5, 2
    v_xor_b32 v33, 8, v7
    v_add_lshl_u32 v33, v33, v5, 2
    v_xor_b32 v34, 16, v7
    v_add_lshl_u32 v34, v34, v5, 2
    v_xor_b32 v35, 24, v7
    v_add_lshl_u32 v35, v35, v5, 2
    ds_write_b32 v32, v224 offset:0
    ds_write_b32 v33, v225 offset:0
    ds_write_b32 v34, v226 offset:0
    ds_write_b32 v35, v227 offset:0
    ds_write_b32 v32, v228 offset:1024
    ds_write_b32 v33, v229 offset:1024
    ds_write_b32 v34, v230 offset:1024
    ds_write_b32 v35, v231 offset:1024
    ds_write_b32 v32, v232 offset:2048
    ds_write_b32 v33, v233 offset:2048
    ds_write_b32 v34, v234 offset:2048
    ds_write_b32 v35, v235 offset:2048
    ds_write_b32 v32, v236 offset:3072
    ds_write_b32 v33, v237 offset:3072
    ds_write_b32 v34, v238 offset:3072
    ds_write_b32 v35, v239 offset:3072
    ds_write_b32 v32, v240 offset:4096
    ds_write_b32 v33, v241 offset:4096
    ds_write_b32 v34, v242 offset:4096
    ds_write_b32 v35, v243 offset:4096
    ds_write_b32 v32, v244 offset:5120
    ds_write_b32 v33, v245 offset:5120
    ds_write_b32 v34, v246 offset:5120
    ds_write_b32 v35, v247 offset:5120
    ds_write_b32 v32, v248 offset:6144
    ds_write_b32 v33, v249 offset:6144
    ds_write_b32 v34, v250 offset:6144
    ds_write_b32 v35, v251 offset:6144
    ds_write_b32 v32, v252 offset:7168
    ds_write_b32 v33, v253 offset:7168
    ds_write_b32 v34, v254 offset:7168
    ds_write_b32 v35, v255 offset:7168
    v_bfe_u32 v1, v0, 2, 1
    v_bfe_u32 v2, v0, 4, 1
    v_lshlrev_b32 v1, 3, v1
    v_lshl_add_u32 v1, v2, 4, v1
    v_lshlrev_b32 v2, 3, v0
    v_xor_b32 v1, v1, v2
    v_lshlrev_b32 v1, 2, v1
    s_waitcnt lgkmcnt(0)
    s_barrier
    ds_read_b128 v[32:35], v1 offset:0
    ds_read_b128 v[36:39], v1 offset:16
    ds_read_b128 v[40:43], v1 offset:8192
    ds_read_b128 v[44:47], v1 offset:8208
    ds_read_b128 v[48:51], v1 offset:16384
    ds_read_b128 v[52:55], v1 offset:16400
    ds_read_b128 v[56:59], v1 offset:24576
    ds_read_b128 v[60:63], v1 offset:24592
    s_and_b32 s24, s2, 1
    s_lshl_b32 s24, s24, 4
    s_lshr_b32 s25, s25, s24
    s_lshl_b32 s25, s25, 16
    s_waitcnt lgkmcnt(0)
    v_add_f32 v32, v32, v40
    v_add_f32 v48, v48, v56
    v_add_f32 v32, v32, v48
    v_mul_f32 v40, s25, v16
    v_cvt_pk_bf16_f32 v32, v32, v40
    v_and_b32 v40, 0xffff0000, v32
    v_lshlrev_b32 v32, 16, v32
    v_add_f32 v32, v32, v40
    v_cvt_pk_bf16_f32 v32, v32, v32
    v_lshlrev_b32 v32, 16, v32
    v_add_f32 v32, v32, v8
    v_add_f32 v33, v33, v41
    v_add_f32 v49, v49, v57
    v_add_f32 v33, v33, v49
    v_mul_f32 v41, s25, v17
    v_cvt_pk_bf16_f32 v33, v33, v41
    v_and_b32 v41, 0xffff0000, v33
    v_lshlrev_b32 v33, 16, v33
    v_add_f32 v33, v33, v41
    v_cvt_pk_bf16_f32 v33, v33, v33
    v_lshlrev_b32 v33, 16, v33
    v_add_f32 v33, v33, v9
    v_add_f32 v34, v34, v42
    v_add_f32 v50, v50, v58
    v_add_f32 v34, v34, v50
    v_mul_f32 v42, s25, v18
    v_cvt_pk_bf16_f32 v34, v34, v42
    v_and_b32 v42, 0xffff0000, v34
    v_lshlrev_b32 v34, 16, v34
    v_add_f32 v34, v34, v42
    v_cvt_pk_bf16_f32 v34, v34, v34
    v_lshlrev_b32 v34, 16, v34
    v_add_f32 v34, v34, v10
    v_add_f32 v35, v35, v43
    v_add_f32 v51, v51, v59
    v_add_f32 v35, v35, v51
    v_mul_f32 v43, s25, v19
    v_cvt_pk_bf16_f32 v35, v35, v43
    v_and_b32 v43, 0xffff0000, v35
    v_lshlrev_b32 v35, 16, v35
    v_add_f32 v35, v35, v43
    v_cvt_pk_bf16_f32 v35, v35, v35
    v_lshlrev_b32 v35, 16, v35
    v_add_f32 v35, v35, v11
    v_add_f32 v36, v36, v44
    v_add_f32 v52, v52, v60
    v_add_f32 v36, v36, v52
    v_mul_f32 v44, s25, v20
    v_cvt_pk_bf16_f32 v36, v36, v44
    v_and_b32 v44, 0xffff0000, v36
    v_lshlrev_b32 v36, 16, v36
    v_add_f32 v36, v36, v44
    v_cvt_pk_bf16_f32 v36, v36, v36
    v_lshlrev_b32 v36, 16, v36
    v_add_f32 v36, v36, v12
    v_add_f32 v37, v37, v45
    v_add_f32 v53, v53, v61
    v_add_f32 v37, v37, v53
    v_mul_f32 v45, s25, v21
    v_cvt_pk_bf16_f32 v37, v37, v45
    v_and_b32 v45, 0xffff0000, v37
    v_lshlrev_b32 v37, 16, v37
    v_add_f32 v37, v37, v45
    v_cvt_pk_bf16_f32 v37, v37, v37
    v_lshlrev_b32 v37, 16, v37
    v_add_f32 v37, v37, v13
    v_add_f32 v38, v38, v46
    v_add_f32 v54, v54, v62
    v_add_f32 v38, v38, v54
    v_mul_f32 v46, s25, v22
    v_cvt_pk_bf16_f32 v38, v38, v46
    v_and_b32 v46, 0xffff0000, v38
    v_lshlrev_b32 v38, 16, v38
    v_add_f32 v38, v38, v46
    v_cvt_pk_bf16_f32 v38, v38, v38
    v_lshlrev_b32 v38, 16, v38
    v_add_f32 v38, v38, v14
    v_add_f32 v39, v39, v47
    v_add_f32 v55, v55, v63
    v_add_f32 v39, v39, v55
    v_mul_f32 v47, s25, v23
    v_cvt_pk_bf16_f32 v39, v39, v47
    v_and_b32 v47, 0xffff0000, v39
    v_lshlrev_b32 v39, 16, v39
    v_add_f32 v39, v39, v47
    v_cvt_pk_bf16_f32 v39, v39, v39
    v_lshlrev_b32 v39, 16, v39
    v_add_f32 v39, v39, v15
    v_cvt_pk_bf16_f32 v40, v32, v33
    v_cvt_pk_bf16_f32 v41, v34, v35
    v_cvt_pk_bf16_f32 v42, v36, v37
    v_cvt_pk_bf16_f32 v43, v38, v39
    v_lshl_add_u32 v1, v0, 4, s26
    buffer_store_dwordx4 v[40:43], v1, s[12:15], 0 offen
conv2_kernel_end:
    s_endpgm
.section .rodata,"a"
.p2align 6
.amdhsa_kernel conv2_kernel
  .amdhsa_next_free_vgpr 256
  .amdhsa_next_free_sgpr 102
  .amdhsa_accum_offset 256
  .amdhsa_group_segment_fixed_size 0
  .amdhsa_kernarg_size 112
  .amdhsa_user_sgpr_count 2
  .amdhsa_user_sgpr_kernarg_segment_ptr 1
  .amdhsa_system_sgpr_workgroup_id_x 1
.end_amdhsa_kernel
.text
.globl gemm1b_kernel
.p2align 8
.type gemm1b_kernel,@function
gemm1b_kernel:
    s_cmp_ge_u32 s2, 256
    s_cbranch_scc1 gemm1b_kernel_end
    s_load_dwordx4 s[4:7], s[0:1], 64
    s_load_dwordx2 s[8:9], s[0:1], 104
    s_lshr_b32 s28, s2, 5
    s_and_b32 s29, s2, 31
    v_lshrrev_b32 v1, 6, v0
    s_nop 1
    v_readfirstlane_b32 s30, v1
    s_waitcnt lgkmcnt(0)
    s_mov_b32 s12, s4
    s_mov_b32 s13, s5
    s_mov_b32 s14, 0x158000
    s_mov_b32 s15, 0x00020000
    s_mov_b32 s16, s6
    s_mov_b32 s17, s7
    s_mov_b32 s18, 0x158000
    s_mov_b32 s19, 0x00020000
    s_add_u32 s20, s8, 0x900000
    s_addc_u32 s21, s9, 0
    s_mov_b32 s22, 0x220000
    s_mov_b32 s23, 0x00020000
    s_add_u32 s24, s8, 0xc00000
    s_addc_u32 s25, s9, 0
    s_mov_b32 s26, 0x580000
    s_mov_b32 s27, 0x00020000
    v_mul_u32_u24 v2, 2979, v0
    v_lshrrev_b32 v2, 16, v2
    v_mul_u32_u24 v3, 22, v2
    v_sub_u32 v3, v0, v3
    v_mul_u32_u24 v2, 2752, v2
    v_lshl_add_u32 v2, v3, 4, v2
    s_mul_i32 s31, s28, 352
    v_add_u32 v2, s31, v2
    s_lshl_b32 s32, s30, 10
    s_cmp_ge_u32 s30, 8
    s_cbranch_scc1 gemm1b_kernel_ln_dma
    v_and_b32 v4, 7, v0
    v_lshrrev_b32 v5, 3, v0
    s_lshl_b32 s35, s29, 7
    v_mul_u32_u24 v6, 4352, v5
    v_lshl_add_u32 v6, v4, 4, v6
    v_add_u32 v6, s35, v6
    buffer_load_dwordx4 v[32:35], v6, s[20:23], 0 offen
    v_add_u32 v6, 278528, v6
    buffer_load_dwordx4 v[36:39], v6, s[20:23], 0 offen
    v_add_u32 v6, 278528, v6
    buffer_load_dwordx4 v[40:43], v6, s[20:23], 0 offen
    v_add_u32 v6, 278528, v6
    buffer_load_dwordx4 v[44:47], v6, s[20:23], 0 offen
    v_add_u32 v6, 278528, v6
    buffer_load_dwordx4 v[48:51], v6, s[20:23], 0 offen
    v_add_u32 v6, 278528, v6
    buffer_load_dwordx4 v[52:55], v6, s[20:23], 0 offen
    v_add_u32 v6, 278528, v6
    buffer_load_dwordx4 v[56:59], v6, s[20:23], 0 offen
    v_add_u32 v6, 278528, v6
    buffer_load_dwordx4 v[60:63], v6, s[20:23], 0 offen
    v_mov_b32 v64, 0
    v_mov_b32 v65, 0
    v_mov_b32 v66, 0
    v_mov_b32 v67, 0
    v_mov_b32 v68, 0
    v_mov_b32 v69, 0
    v_mov_b32 v70, 0
    v_mov_b32 v71, 0
    v_mov_b32 v72, 0
    v_mov_b32 v73, 0
    v_mov_b32 v74, 0
    v_mov_b32 v75, 0
    v_mov_b32 v76, 0
    v_mov_b32 v77, 0
    v_mov_b32 v78, 0
    v_mov_b32 v79, 0
    s_waitcnt vmcnt(7)
    v_lshlrev_b32 v104, 16, v32
    v_and_b32 v105, 0xffff0000, v32
    v_pk_add_f32 v[64:65], v[64:65], v[104:105]
    v_pk_fma_f32 v[72:73], v[104:105], v[104:105], v[72:73]
    v_lshlrev_b32 v106, 16, v33
    v_and_b32 v107, 0xffff0000, v33
    v_pk_add_f32 v[66:67], v[66:67], v[106:107]
    v_pk_fma_f32 v[74:75], v[106:107], v[106:107], v[74:75]
    v_lshlrev_b32 v108, 16, v34
    v_and_b32 v109, 0xffff0000, v34
    v_pk_add_f32 v[68:69], v[68:69], v[108:109]
    v_pk_fma_f32 v[76:77], v[108:109], v[108:109], v[76:77]
    v_lshlrev_b32 v110, 16, v35
    v_and_b32 v111, 0xffff0000, v35
    v_pk_add_f32 v[70:71], v[70:71], v[110:111]
    v_pk_fma_f32 v[78:79], v[110:111], v[110:111], v[78:79]
    s_waitcnt vmcnt(6)
    v_lshlrev_b32 v112, 16, v36
    v_and_b32 v113, 0xffff0000, v36
    v_pk_add_f32 v[64:65], v[64:65], v[112:113]
    v_pk_fma_f32 v[72:73], v[112:113], v[112:113], v[72:73]
    v_lshlrev_b32 v114, 16, v37
    v_and_b32 v115, 0xffff0000, v37
    v_pk_add_f32 v[66:67], v[66:67], v[114:115]
    v_pk_fma_f32 v[74:75], v[114:115], v[114:115], v[74:75]
    v_lshlrev_b32 v116, 16, v38
    v_and_b32 v117, 0xffff0000, v38
    v_pk_add_f32 v[68:69], v[68:69], v[116:117]
    v_pk_fma_f32 v[76:77], v[116:117], v[116:117], v[76:77]
    v_lshlrev_b32 v118, 16, v39
    v_and_b32 v119, 0xffff0000, v39
    v_pk_add_f32 v[70:71], v[70:71], v[118:119]
    v_pk_fma_f32 v[78:79], v[118:119], v[118:119], v[78:79]
    s_waitcnt vmcnt(5)
    v_lshlrev_b32 v104, 16, v40
    v_and_b32 v105, 0xffff0000, v40
    v_pk_add_f32 v[64:65], v[64:65], v[104:105]
    v_pk_fma_f32 v[72:73], v[104:105], v[104:105], v[72:73]
    v_lshlrev_b32 v106, 16, v41
    v_and_b32 v107, 0xffff0000, v41
    v_pk_add_f32 v[66:67], v[66:67], v[106:107]
    v_pk_fma_f32 v[74:75], v[106:107], v[106:107], v[74:75]
    v_lshlrev_b32 v108, 16, v42
    v_and_b32 v109, 0xffff0000, v42
    v_pk_add_f32 v[68:69], v[68:69], v[108:109]
    v_pk_fma_f32 v[76:77], v[108:109], v[108:109], v[76:77]
    v_lshlrev_b32 v110, 16, v43
    v_and_b32 v111, 0xffff0000, v43
    v_pk_add_f32 v[70:71], v[70:71], v[110:111]
    v_pk_fma_f32 v[78:79], v[110:111], v[110:111], v[78:79]
    s_waitcnt vmcnt(4)
    v_lshlrev_b32 v112, 16, v44
    v_and_b32 v113, 0xffff0000, v44
    v_pk_add_f32 v[64:65], v[64:65], v[112:113]
    v_pk_fma_f32 v[72:73], v[112:113], v[112:113], v[72:73]
    v_lshlrev_b32 v114, 16, v45
    v_and_b32 v115, 0xffff0000, v45
    v_pk_add_f32 v[66:67], v[66:67], v[114:115]
    v_pk_fma_f32 v[74:75], v[114:115], v[114:115], v[74:75]
    v_lshlrev_b32 v116, 16, v46
    v_and_b32 v117, 0xffff0000, v46
    v_pk_add_f32 v[68:69], v[68:69], v[116:117]
    v_pk_fma_f32 v[76:77], v[116:117], v[116:117], v[76:77]
    v_lshlrev_b32 v118, 16, v47
    v_and_b32 v119, 0xffff0000, v47
    v_pk_add_f32 v[70:71], v[70:71], v[118:119]
    v_pk_fma_f32 v[78:79], v[118:119], v[118:119], v[78:79]
    s_waitcnt vmcnt(3)
    v_lshlrev_b32 v104, 16, v48
    v_and_b32 v105, 0xffff0000, v48
    v_pk_add_f32 v[64:65], v[64:65], v[104:105]
    v_pk_fma_f32 v[72:73], v[104:105], v[104:105], v[72:73]
    v_lshlrev_b32 v106, 16, v49
    v_and_b32 v107, 0xffff0000, v49
    v_pk_add_f32 v[66:67], v[66:67], v[106:107]
    v_pk_fma_f32 v[74:75], v[106:107], v[106:107], v[74:75]
    v_lshlrev_b32 v108, 16, v50
    v_and_b32 v109, 0xffff0000, v50
    v_pk_add_f32 v[68:69], v[68:69], v[108:109]
    v_pk_fma_f32 v[76:77], v[108:109], v[108:109], v[76:77]
    v_lshlrev_b32 v110, 16, v51
    v_and_b32 v111, 0xffff0000, v51
    v_pk_add_f32 v[70:71], v[70:71], v[110:111]
    v_pk_fma_f32 v[78:79], v[110:111], v[110:111], v[78:79]
    s_waitcnt vmcnt(2)
    v_lshlrev_b32 v112, 16, v52
    v_and_b32 v113, 0xffff0000, v52
    v_pk_add_f32 v[64:65], v[64:65], v[112:113]
    v_pk_fma_f32 v[72:73], v[112:113], v[112:113], v[72:73]
    v_lshlrev_b32 v114, 16, v53
    v_and_b32 v115, 0xffff0000, v53
    v_pk_add_f32 v[66:67], v[66:67], v[114:115]
    v_pk_fma_f32 v[74:75], v[114:115], v[114:115], v[74:75]
    v_lshlrev_b32 v116, 16, v54
    v_and_b32 v117, 0xffff0000, v54
    v_pk_add_f32 v[68:69], v[68:69], v[116:117]
    v_pk_fma_f32 v[76:77], v[116:117], v[116:117], v[76:77]
    v_lshlrev_b32 v118, 16, v55
    v_and_b32 v119, 0xffff0000, v55
    v_pk_add_f32 v[70:71], v[70:71], v[118:119]
    v_pk_fma_f32 v[78:79], v[118:119], v[118:119], v[78:79]
    s_waitcnt vmcnt(1)
    v_lshlrev_b32 v104, 16, v56
    v_and_b32 v105, 0xffff0000, v56
    v_pk_add_f32 v[64:65], v[64:65], v[104:105]
    v_pk_fma_f32 v[72:73], v[104:105], v[104:105], v[72:73]
    v_lshlrev_b32 v106, 16, v57
    v_and_b32 v107, 0xffff0000, v57
    v_pk_add_f32 v[66:67], v[66:67], v[106:107]
    v_pk_fma_f32 v[74:75], v[106:107], v[106:107], v[74:75]
    v_lshlrev_b32 v108, 16, v58
    v_and_b32 v109, 0xffff0000, v58
    v_pk_add_f32 v[68:69], v[68:69], v[108:109]
    v_pk_fma_f32 v[76:77], v[108:109], v[108:109], v[76:77]
    v_lshlrev_b32 v110, 16, v59
    v_and_b32 v111, 0xffff0000, v59
    v_pk_add_f32 v[70:71], v[70:71], v[110:111]
    v_pk_fma_f32 v[78:79], v[110:111], v[110:111], v[78:79]
    s_waitcnt vmcnt(0)
    v_lshlrev_b32 v112, 16, v60
    v_and_b32 v113, 0xffff0000, v60
    v_pk_add_f32 v[64:65], v[64:65], v[112:113]
    v_pk_fma_f32 v[72:73], v[112:113], v[112:113], v[72:73]
    v_lshlrev_b32 v114, 16, v61
    v_and_b32 v115, 0xffff0000, v61
    v_pk_add_f32 v[66:67], v[66:67], v[114:115]
    v_pk_fma_f32 v[74:75], v[114:115], v[114:115], v[74:75]
    v_lshlrev_b32 v116, 16, v62
    v_and_b32 v117, 0xffff0000, v62
    v_pk_add_f32 v[68:69], v[68:69], v[116:117]
    v_pk_fma_f32 v[76:77], v[116:117], v[116:117], v[76:77]
    v_lshlrev_b32 v118, 16, v63
    v_and_b32 v119, 0xffff0000, v63
    v_pk_add_f32 v[70:71], v[70:71], v[118:119]
    v_pk_fma_f32 v[78:79], v[118:119], v[118:119], v[78:79]
    s_branch gemm1b_kernel_ln_cont
gemm1b_kernel_ln_dma:
    s_sub_u32 s40, s30, 8
    v_and_b32 v17, 63, v0
    s_add_u32 s41, s40, 0
    s_lshl_b32 s44, s41, 10
    s_lshl_b32 s41, s41, 6
    v_add_u32 v18, s41, v17
    v_mul_u32_u24 v19, 2979, v18
    v_lshrrev_b32 v19, 16, v19
    v_mul_u32_u24 v20, 22, v19
    v_sub_u32 v20, v18, v20
    v_mul_u32_u24 v19, 2752, v19
    v_lshl_add_u32 v19, v20, 4, v19
    v_add_u32 v24, s31, v19
    s_add_u32 s41, s40, 3
    s_lshl_b32 s45, s41, 10
    s_lshl_b32 s41, s41, 6
    v_add_u32 v18, s41, v17
    v_mul_u32_u24 v19, 2979, v18
    v_lshrrev_b32 v19, 16, v19
    v_mul_u32_u24 v20, 22, v19
    v_sub_u32 v20, v18, v20
    v_mul_u32_u24 v19, 2752, v19
    v_lshl_add_u32 v19, v20, 4, v19
    v_add_u32 v25, s31, v19
    s_add_u32 s41, s40, 6
    s_lshl_b32 s46, s41, 10
    s_lshl_b32 s41, s41, 6
    v_add_u32 v18, s41, v17
    v_mul_u32_u24 v19, 2979, v18
    v_lshrrev_b32 v19, 16, v19
    v_mul_u32_u24 v20, 22, v19
    v_sub_u32 v20, v18, v20
    v_mul_u32_u24 v19, 2752, v19
    v_lshl_add_u32 v19, v20, 4, v19
    v_add_u32 v26, s31, v19
    s_add_u32 s41, s40, 9
    s_min_u32 s41, s41, 10
    s_lshl_b32 s47, s41, 10
    s_lshl_b32 s41, s41, 6
    v_add_u32 v18, s41, v17
    v_mul_u32_u24 v19, 2979, v18
    v_lshrrev_b32 v19, 16, v19
    v_mul_u32_u24 v20, 22, v19
    v_sub_u32 v20, v18, v20
    v_mul_u32_u24 v19, 2752, v19
    v_lshl_add_u32 v19, v20, 4, v19
    v_add_u32 v27, s31, v19
    s_add_u32 s33, s44, 65536
    s_mov_b32 m0, s33
    s_mov_b32 s34, 0
    buffer_load_dwordx4 v24, s[12:15], s34 offen lds
    s_add_u32 m0, s33, 11392
    s_nop 0
    buffer_load_dwordx4 v24, s[16:19], s34 offen lds
    s_add_u32 s33, s45, 65536
    s_mov_b32 m0, s33
    s_mov_b32 s34, 0
    buffer_load_dwordx4 v25, s[12:15], s34 offen lds
    s_add_u32 m0, s33, 11392
    s_nop 0
    buffer_load_dwordx4 v25, s[16:19], s34 offen lds
    s_add_u32 s33, s46, 65536
    s_mov_b32 m0, s33
    s_mov_b32 s34, 0
    buffer_load_dwordx4 v26, s[12:15], s34 offen lds
    s_add_u32 m0, s33, 11392
    s_nop 0
    buffer_load_dwordx4 v26, s[16:19], s34 offen lds
    s_add_u32 s33, s47, 65536
    s_mov_b32 m0, s33
    s_mov_b32 s34, 0
    buffer_load_dwordx4 v27, s[12:15], s34 offen lds
    s_add_u32 m0, s33, 11392
    s_nop 0
    buffer_load_dwordx4 v27, s[16:19], s34 offen lds
    s_add_u32 s33, s44, 88320
    s_mov_b32 m0, s33
    s_mov_b32 s34, 88064
    buffer_load_dwordx4 v24, s[12:15], s34 offen lds
    s_add_u32 m0, s33, 11392
    s_nop 0
    buffer_load_dwordx4 v24, s[16:19], s34 offen lds
    s_add_u32 s33, s45, 88320
    s_mov_b32 m0, s33
    s_mov_b32 s34, 88064
    buffer_load_dwordx4 v25, s[12:15], s34 offen lds
    s_add_u32 m0, s33, 11392
    s_nop 0
    buffer_load_dwordx4 v25, s[16:19], s34 offen lds
    s_add_u32 s33, s46, 88320
    s_mov_b32 m0, s33
    s_mov_b32 s34, 88064
    buffer_load_dwordx4 v26, s[12:15], s34 offen lds
    s_add_u32 m0, s33, 11392
    s_nop 0
    buffer_load_dwordx4 v26, s[16:19], s34 offen lds
    s_add_u32 s33, s47, 88320
    s_mov_b32 m0, s33
    s_mov_b32 s34, 88064
    buffer_load_dwordx4 v27, s[12:15], s34 offen lds
    s_add_u32 m0, s33, 11392
    s_nop 0
    buffer_load_dwordx4 v27, s[16:19], s34 offen lds
    s_add_u32 s33, s44, 111104
    s_mov_b32 m0, s33
    s_mov_b32 s34, 176128
    buffer_load_dwordx4 v24, s[12:15], s34 offen lds
    s_add_u32 m0, s33, 11392
    s_nop 0
    buffer_load_dwordx4 v24, s[16:19], s34 offen lds
    s_add_u32 s33, s45, 111104
    s_mov_b32 m0, s33
    s_mov_b32 s34, 176128
    buffer_load_dwordx4 v25, s[12:15], s34 offen lds
    s_add_u32 m0, s33, 11392
    s_nop 0
    buffer_load_dwordx4 v25, s[16:19], s34 offen lds
    s_add_u32 s33, s46, 111104
    s_mov_b32 m0, s33
    s_mov_b32 s34, 176128
    buffer_load_dwordx4 v26, s[12:15], s34 offen lds
    s_add_u32 m0, s33, 11392
    s_nop 0
    buffer_load_dwordx4 v26, s[16:19], s34 offen lds
    s_add_u32 s33, s47, 111104
    s_mov_b32 m0, s33
    s_mov_b32 s34, 176128
    buffer_load_dwordx4 v27, s[12:15], s34 offen lds
    s_add_u32 m0, s33, 11392
    s_nop 0
    buffer_load_dwordx4 v27, s[16:19], s34 offen lds
    s_branch gemm1b_kernel_ln_skip1
gemm1b_kernel_ln_cont:
    ds_swizzle_b32 v80, v64 offset:0x201f
    ds_swizzle_b32 v81, v65 offset:0x201f
    ds_swizzle_b32 v82, v66 offset:0x201f
    ds_swizzle_b32 v83, v67 offset:0x201f
    ds_swizzle_b32 v84, v68 offset:0x201f
    ds_swizzle_b32 v85, v69 offset:0x201f
    ds_swizzle_b32 v86, v70 offset:0x201f
    ds_swizzle_b32 v87, v71 offset:0x201f
    ds_swizzle_b32 v88, v72 offset:0x201f
    ds_swizzle_b32 v89, v73 offset:0x201f
    ds_swizzle_b32 v90, v74 offset:0x201f
    ds_swizzle_b32 v91, v75 offset:0x201f
    ds_swizzle_b32 v92, v76 offset:0x201f
    ds_swizzle_b32 v93, v77 offset:0x201f
    ds_swizzle_b32 v94, v78 offset:0x201f
    ds_swizzle_b32 v95, v79 offset:0x201f
    s_waitcnt lgkmcnt(0)
    v_add_f32 v64, v64, v80
    v_add_f32 v65, v65, v81
    v_add_f32 v66, v66, v82
    v_add_f32 v67, v67, v83
    v_add_f32 v68, v68, v84
    v_add_f32 v69, v69, v85
    v_add_f32 v70, v70, v86
    v_add_f32 v71, v71, v87
    v_add_f32 v72, v72, v88
    v_add_f32 v73, v73, v89
    v_add_f32 v74, v74, v90
    v_add_f32 v75, v75, v91
    v_add_f32 v76, v76, v92
    v_add_f32 v77, v77, v93
    v_add_f32 v78, v78, v94
    v_add_f32 v79, v79, v95
    ds_swizzle_b32 v80, v64 offset:0x401f
    ds_swizzle_b32 v81, v65 offset:0x401f
    ds_swizzle_b32 v82, v66 offset:0x401f
    ds_swizzle_b32 v83, v67 offset:0x401f
    ds_swizzle_b32 v84, v68 offset:0x401f
    ds_swizzle_b32 v85, v69 offset:0x401f
    ds_swizzle_b32 v86, v70 offset:0x401f
    ds_swizzle_b32 v87, v71 offset:0x401f
    ds_swizzle_b32 v88, v72 offset:0x401f
    ds_swizzle_b32 v89, v73 offset:0x401f
    ds_swizzle_b32 v90, v74 offset:0x401f
    ds_swizzle_b32 v91, v75 offset:0x401f
    ds_swizzle_b32 v92, v76 offset:0x401f
    ds_swizzle_b32 v93, v77 offset:0x401f
    ds_swizzle_b32 v94, v78 offset:0x401f
    ds_swizzle_b32 v95, v79 offset:0x401f
    s_waitcnt lgkmcnt(0)
    v_add_f32 v64, v64, v80
    v_add_f32 v65, v65, v81
    v_add_f32 v66, v66, v82
    v_add_f32 v67, v67, v83
    v_add_f32 v68, v68, v84
    v_add_f32 v69, v69, v85
    v_add_f32 v70, v70, v86
    v_add_f32 v71, v71, v87
    v_add_f32 v72, v72, v88
    v_add_f32 v73, v73, v89
    v_add_f32 v74, v74, v90
    v_add_f32 v75, v75, v91
    v_add_f32 v76, v76, v92
    v_add_f32 v77, v77, v93
    v_add_f32 v78, v78, v94
    v_add_f32 v79, v79, v95
    v_lshrrev_b32 v8, 5, v0
    v_lshlrev_b32 v8, 9, v8
    v_lshl_add_u32 v8, v4, 6, v8
    v_add_u32 v8, 133888, v8
    v_and_b32 v9, 31, v0
    v_cmp_gt_u32 vcc, 8, v9
    s_and_saveexec_b64 s[36:37], vcc
    ds_write_b128 v8, v[64:67] offset:0
    ds_write_b128 v8, v[68:71] offset:16
    ds_write_b128 v8, v[72:75] offset:32
    ds_write_b128 v8, v[76:79] offset:48
    s_mov_b64 exec, s[36:37]
    s_waitcnt lgkmcnt(0)
gemm1b_kernel_ln_skip1:
    s_barrier
    s_cmp_lg_u32 s30, 0
    s_cbranch_scc1 gemm1b_kernel_ln_skip2
    v_lshrrev_b32 v8, 3, v0
    v_lshlrev_b32 v8, 6, v8
    v_and_b32 v9, 7, v0
    v_lshl_add_u32 v8, v9, 2, v8
    v_add_u32 v8, 133888, v8
    ds_read_b32 v104, v8 offset:0
    ds_read_b32 v120, v8 offset:32
    ds_read_b32 v105, v8 offset:512
    ds_read_b32 v121, v8 offset:544
    ds_read_b32 v106, v8 offset:1024
    ds_read_b32 v122, v8 offset:1056
    ds_read_b32 v107, v8 offset:1536
    ds_read_b32 v123, v8 offset:1568
    ds_read_b32 v108, v8 offset:2048
    ds_read_b32 v124, v8 offset:2080
    ds_read_b32 v109, v8 offset:2560
    ds_read_b32 v125, v8 offset:2592
    ds_read_b32 v110, v8 offset:3072
    ds_read_b32 v126, v8 offset:3104
    ds_read_b32 v111, v8 offset:3584
    ds_read_b32 v127, v8 offset:3616
    ds_read_b32 v112, v8 offset:4096
    ds_read_b32 v128, v8 offset:4128
    ds_read_b32 v113, v8 offset:4608
    ds_read_b32 v129, v8 offset:4640
    ds_read_b32 v114, v8 offset:5120
    ds_read_b32 v130, v8 offset:5152
    ds_read_b32 v115, v8 offset:5632
    ds_read_b32 v131, v8 offset:5664
    ds_read_b32 v116, v8 offset:6144
    ds_read_b32 v132, v8 offset:6176
    ds_read_b32 v117, v8 offset:6656
    ds_read_b32 v133, v8 offset:6688
    ds_read_b32 v118, v8 offset:7168
    ds_read_b32 v134, v8 offset:7200
    ds_read_b32 v119, v8 offset:7680
    ds_read_b32 v135, v8 offset:7712
    s_waitcnt lgkmcnt(0)
    v_add_f32 v104, v104, v112
    v_add_f32 v120, v120, v128
    v_add_f32 v105, v105, v113
    v_add_f32 v121, v121, v129
    v_add_f32 v106, v106, v114
    v_add_f32 v122, v122, v130
    v_add_f32 v107, v107, v115
    v_add_f32 v123, v123, v131
    v_add_f32 v108, v108, v116
    v_add_f32 v124, v124, v132
    v_add_f32 v109, v109, v117
    v_add_f32 v125, v125, v133
    v_add_f32 v110, v110, v118
    v_add_f32 v126, v126, v134
    v_add_f32 v111, v111, v119
    v_add_f32 v127, v127, v135
    v_add_f32 v104, v104, v108
    v_add_f32 v120, v120, v124
    v_add_f32 v105, v105, v109
    v_add_f32 v121, v121, v125
    v_add_f32 v106, v106, v110
    v_add_f32 v122, v122, v126
    v_add_f32 v107, v107, v111
    v_add_f32 v123, v123, v127
    v_add_f32 v104, v104, v106
    v_add_f32 v120, v120, v122
    v_add_f32 v105, v105, v107
    v_add_f32 v121, v121, v123
    v_add_f32 v104, v104, v105
    v_add_f32 v120, v120, v121
    s_mov_b32 s36, 0x3b000000
    s_mov_b32 s37, 0x3727c5ac
    v_mul_f32 v104, s36, v104
    v_mul_f32 v120, s36, v120
    v_fma_f32 v120, -v104, v104, v120
    v_max_f32 v120, 0, v120
    v_cvt_pk_bf16_f32 v104, v104, v120
    v_and_b32 v120, 0xffff0000, v104
    v_lshlrev_b32 v104, 16, v104
    v_add_f32 v120, s37, v120
    v_cvt_pk_bf16_f32 v120, v120, v120
    v_lshlrev_b32 v120, 16, v120
    v_sqrt_f32 v120, v120
    s_nop 0
    v_cvt_pk_bf16_f32 v120, v120, v120
    v_lshlrev_b32 v120, 16, v120
    v_rcp_f32 v120, v120
    v_lshlrev_b32 v8, 2, v0
    v_add_u32 v8, 142080, v8
    ds_write_b32 v8, v104 offset:0
    ds_write_b32 v8, v120 offset:256
    s_waitcnt lgkmcnt(0)
gemm1b_kernel_ln_skip2:
    s_barrier
    s_cmp_ge_u32 s30, 8
    s_cbranch_scc1 gemm1b_kernel_ln_skip3
    v_lshlrev_b32 v8, 5, v4
    v_add_u32 v8, 142080, v8
    ds_read_b128 v[64:67], v8 offset:0
    ds_read_b128 v[68:71], v8 offset:16
    ds_read_b128 v[72:75], v8 offset:256
    ds_read_b128 v[76:79], v8 offset:272
    v_bfe_u32 v8, v5, 1, 1
    v_lshrrev_b32 v9, 2, v4
    v_xor_b32 v8, v8, v9
    v_lshlrev_b32 v8, 6, v8
    v_and_b32 v9, 3, v4
    v_lshl_add_u32 v8, v9, 4, v8
    v_lshl_add_u32 v7, v5, 7, v8
    s_waitcnt lgkmcnt(0)
gemm1b_kernel_ln_skip3:
    v_and_b32 v8, 63, v0
    v_bfe_u32 v9, v8, 4, 1
    v_lshrrev_b32 v10, 5, v8
    v_bfe_u32 v11, v8, 2, 2
    v_and_b32 v12, 3, v8
    v_lshl_add_u32 v13, v10, 3, v11
    v_mul_u32_u24 v14, 352, v13
    v_mul_u32_u24 v15, 11392, v9
    v_add_u32 v14, v14, v15
    v_lshl_add_u32 v14, v12, 3, v14
    s_lshl_b32 s35, s30, 5
    v_add_u32 v4, s35, v14
    v_add_u32 v4, 65536, v4
    v_add_u32 v3, 45568, v4
    v_lshlrev_b32 v14, 7, v13
    v_lshl_add_u32 v14, v9, 5, v14
    v_lshl_add_u32 v14, v12, 3, v14
    v_lshrrev_b32 v15, 1, v11
    v_lshl_add_u32 v5, v15, 6, v14
    v_xor_b32 v15, 1, v15
    v_lshl_add_u32 v6, v15, 6, v14
    s_lshr_b32 s39, s30, 2
    s_cmp_ge_u32 s30, 8
    s_cbranch_scc1 gemm1b_kernel_nskip
    v_lshlrev_b32 v80, 16, v32
    v_lshlrev_b32 v82, 16, v33
    v_lshlrev_b32 v84, 16, v34
    v_lshlrev_b32 v86, 16, v35
    v_and_b32 v81, 0xffff0000, v32
    v_and_b32 v83, 0xffff0000, v33
    v_and_b32 v85, 0xffff0000, v34
    v_and_b32 v87, 0xffff0000, v35
    v_pk_add_f32 v[80:81], v[80:81], v[64:65] neg_lo:[0,1] neg_hi:[0,1]
    v_pk_add_f32 v[82:83], v[82:83], v[66:67] neg_lo:[0,1] neg_hi:[0,1]
    v_pk_add_f32 v[84:85], v[84:85], v[68:69] neg_lo:[0,1] neg_hi:[0,1]
    v_pk_add_f32 v[86:87], v[86:87], v[70:71] neg_lo:[0,1] neg_hi:[0,1]
    v_cvt_pk_bf16_f32 v88, v80, v81
    v_cvt_pk_bf16_f32 v89, v82, v83
    v_cvt_pk_bf16_f32 v90, v84, v85
    v_cvt_pk_bf16_f32 v91, v86, v87
    v_lshlrev_b32 v80, 16, v88
    v_lshlrev_b32 v82, 16, v89
    v_lshlrev_b32 v84, 16, v90
    v_lshlrev_b32 v86, 16, v91
    v_and_b32 v81, 0xffff0000, v88
    v_and_b32 v83, 0xffff0000, v89
    v_and_b32 v85, 0xffff0000, v90
    v_and_b32 v87, 0xffff0000, v91
    v_pk_mul_f32 v[80:81], v[80:81], v[72:73]
    v_pk_mul_f32 v[82:83], v[82:83], v[74:75]
    v_pk_mul_f32 v[84:85], v[84:85], v[76:77]
    v_pk_mul_f32 v[86:87], v[86:87], v[78:79]
    v_cvt_pk_bf16_f32 v92, v80, v81
    v_cvt_pk_bf16_f32 v93, v82, v83
    v_cvt_pk_bf16_f32 v94, v84, v85
    v_cvt_pk_bf16_f32 v95, v86, v87
    ds_write_b128 v7, v[92:95] offset:0
    v_lshlrev_b32 v96, 16, v36
    v_lshlrev_b32 v98, 16, v37
    v_lshlrev_b32 v100, 16, v38
    v_lshlrev_b32 v102, 16, v39
    v_and_b32 v97, 0xffff0000, v36
    v_and_b32 v99, 0xffff0000, v37
    v_and_b32 v101, 0xffff0000, v38
    v_and_b32 v103, 0xffff0000, v39
    v_pk_add_f32 v[96:97], v[96:97], v[64:65] neg_lo:[0,1] neg_hi:[0,1]
    v_pk_add_f32 v[98:99], v[98:99], v[66:67] neg_lo:[0,1] neg_hi:[0,1]
    v_pk_add_f32 v[100:101], v[100:101], v[68:69] neg_lo:[0,1] neg_hi:[0,1]
    v_pk_add_f32 v[102:103], v[102:103], v[70:71] neg_lo:[0,1] neg_hi:[0,1]
    v_cvt_pk_bf16_f32 v104, v96, v97
    v_cvt_pk_bf16_f32 v105, v98, v99
    v_cvt_pk_bf16_f32 v106, v100, v101
    v_cvt_pk_bf16_f32 v107, v102, v103
    v_lshlrev_b32 v96, 16, v104
    v_lshlrev_b32 v98, 16, v105
    v_lshlrev_b32 v100, 16, v106
    v_lshlrev_b32 v102, 16, v107
    v_and_b32 v97, 0xffff0000, v104
    v_and_b32 v99, 0xffff0000, v105
    v_and_b32 v101, 0xffff0000, v106
    v_and_b32 v103, 0xffff0000, v107
    v_pk_mul_f32 v[96:97], v[96:97], v[72:73]
    v_pk_mul_f32 v[98:99], v[98:99], v[74:75]
    v_pk_mul_f32 v[100:101], v[100:101], v[76:77]
    v_pk_mul_f32 v[102:103], v[102:103], v[78:79]
    v_cvt_pk_bf16_f32 v108, v96, v97
    v_cvt_pk_bf16_f32 v109, v98, v99
    v_cvt_pk_bf16_f32 v110, v100, v101
    v_cvt_pk_bf16_f32 v111, v102, v103
    ds_write_b128 v7, v[108:111] offset:8192
    v_lshlrev_b32 v80, 16, v40
    v_lshlrev_b32 v82, 16, v41
    v_lshlrev_b32 v84, 16, v42
    v_lshlrev_b32 v86, 16, v43
    v_and_b32 v81, 0xffff0000, v40
    v_and_b32 v83, 0xffff0000, v41
    v_and_b32 v85, 0xffff0000, v42
    v_and_b32 v87, 0xffff0000, v43
    v_pk_add_f32 v[80:81], v[80:81], v[64:65] neg_lo:[0,1] neg_hi:[0,1]
    v_pk_add_f32 v[82:83], v[82:83], v[66:67] neg_lo:[0,1] neg_hi:[0,1]
    v_pk_add_f32 v[84:85], v[84:85], v[68:69] neg_lo:[0,1] neg_hi:[0,1]
    v_pk_add_f32 v[86:87], v[86:87], v[70:71] neg_lo:[0,1] neg_hi:[0,1]
    v_cvt_pk_bf16_f32 v88, v80, v81
    v_cvt_pk_bf16_f32 v89, v82, v83
    v_cvt_pk_bf16_f32 v90, v84, v85
    v_cvt_pk_bf16_f32 v91, v86, v87
    v_lshlrev_b32 v80, 16, v88
    v_lshlrev_b32 v82, 16, v89
    v_lshlrev_b32 v84, 16, v90
    v_lshlrev_b32 v86, 16, v91
    v_and_b32 v81, 0xffff0000, v88
    v_and_b32 v83, 0xffff0000, v89
    v_and_b32 v85, 0xffff0000, v90
    v_and_b32 v87, 0xffff0000, v91
    v_pk_mul_f32 v[80:81], v[80:81], v[72:73]
    v_pk_mul_f32 v[82:83], v[82:83], v[74:75]
    v_pk_mul_f32 v[84:85], v[84:85], v[76:77]
    v_pk_mul_f32 v[86:87], v[86:87], v[78:79]
    v_cvt_pk_bf16_f32 v92, v80, v81
    v_cvt_pk_bf16_f32 v93, v82, v83
    v_cvt_pk_bf16_f32 v94, v84, v85
    v_cvt_pk_bf16_f32 v95, v86, v87
    ds_write_b128 v7, v[92:95] offset:16384
    v_lshlrev_b32 v96, 16, v44
    v_lshlrev_b32 v98, 16, v45
    v_lshlrev_b32 v100, 16, v46
    v_lshlrev_b32 v102, 16, v47
    v_and_b32 v97, 0xffff0000, v44
    v_and_b32 v99, 0xffff0000, v45
    v_and_b32 v101, 0xffff0000, v46
    v_and_b32 v103, 0xffff0000, v47
    v_pk_add_f32 v[96:97], v[96:97], v[64:65] neg_lo:[0,1] neg_hi:[0,1]
    v_pk_add_f32 v[98:99], v[98:99], v[66:67] neg_lo:[0,1] neg_hi:[0,1]
    v_pk_add_f32 v[100:101], v[100:101], v[68:69] neg_lo:[0,1] neg_hi:[0,1]
    v_pk_add_f32 v[102:103], v[102:103], v[70:71] neg_lo:[0,1] neg_hi:[0,1]
    v_cvt_pk_bf16_f32 v104, v96, v97
    v_cvt_pk_bf16_f32 v105, v98, v99
    v_cvt_pk_bf16_f32 v106, v100, v101
    v_cvt_pk_bf16_f32 v107, v102, v103
    v_lshlrev_b32 v96, 16, v104
    v_lshlrev_b32 v98, 16, v105
    v_lshlrev_b32 v100, 16, v106
    v_lshlrev_b32 v102, 16, v107
    v_and_b32 v97, 0xffff0000, v104
    v_and_b32 v99, 0xffff0000, v105
    v_and_b32 v101, 0xffff0000, v106
    v_and_b32 v103, 0xffff0000, v107
    v_pk_mul_f32 v[96:97], v[96:97], v[72:73]
    v_pk_mul_f32 v[98:99], v[98:99], v[74:75]
    v_pk_mul_f32 v[100:101], v[100:101], v[76:77]
    v_pk_mul_f32 v[102:103], v[102:103], v[78:79]
    v_cvt_pk_bf16_f32 v108, v96, v97
    v_cvt_pk_bf16_f32 v109, v98, v99
    v_cvt_pk_bf16_f32 v110, v100, v101
    v_cvt_pk_bf16_f32 v111, v102, v103
    ds_write_b128 v7, v[108:111] offset:24576
    v_lshlrev_b32 v80, 16, v48
    v_lshlrev_b32 v82, 16, v49
    v_lshlrev_b32 v84, 16, v50
    v_lshlrev_b32 v86, 16, v51
    v_and_b32 v81, 0xffff0000, v48
    v_and_b32 v83, 0xffff0000, v49
    v_and_b32 v85, 0xffff0000, v50
    v_and_b32 v87, 0xffff0000, v51
    v_pk_add_f32 v[80:81], v[80:81], v[64:65] neg_lo:[0,1] neg_hi:[0,1]
    v_pk_add_f32 v[82:83], v[82:83], v[66:67] neg_lo:[0,1] neg_hi:[0,1]
    v_pk_add_f32 v[84:85], v[84:85], v[68:69] neg_lo:[0,1] neg_hi:[0,1]
    v_pk_add_f32 v[86:87], v[86:87], v[70:71] neg_lo:[0,1] neg_hi:[0,1]
    v_cvt_pk_bf16_f32 v88, v80, v81
    v_cvt_pk_bf16_f32 v89, v82, v83
    v_cvt_pk_bf16_f32 v90, v84, v85
    v_cvt_pk_bf16_f32 v91, v86, v87
    v_lshlrev_b32 v80, 16, v88
    v_lshlrev_b32 v82, 16, v89
    v_lshlrev_b32 v84, 16, v90
    v_lshlrev_b32 v86, 16, v91
    v_and_b32 v81, 0xffff0000, v88
    v_and_b32 v83, 0xffff0000, v89
    v_and_b32 v85, 0xffff0000, v90
    v_and_b32 v87, 0xffff0000, v91
    v_pk_mul_f32 v[80:81], v[80:81], v[72:73]
    v_pk_mul_f32 v[82:83], v[82:83], v[74:75]
    v_pk_mul_f32 v[84:85], v[84:85], v[76:77]
    v_pk_mul_f32 v[86:87], v[86:87], v[78:79]
    v_cvt_pk_bf16_f32 v92, v80, v81
    v_cvt_pk_bf16_f32 v93, v82, v83
    v_cvt_pk_bf16_f32 v94, v84, v85
    v_cvt_pk_bf16_f32 v95, v86, v87
    ds_write_b128 v7, v[92:95] offset:32768
    v_lshlrev_b32 v96, 16, v52
    v_lshlrev_b32 v98, 16, v53
    v_lshlrev_b32 v100, 16, v54
    v_lshlrev_b32 v102, 16, v55
    v_and_b32 v97, 0xffff0000, v52
    v_and_b32 v99, 0xffff0000, v53
    v_and_b32 v101, 0xffff0000, v54
    v_and_b32 v103, 0xffff0000, v55
    v_pk_add_f32 v[96:97], v[96:97], v[64:65] neg_lo:[0,1] neg_hi:[0,1]
    v_pk_add_f32 v[98:99], v[98:99], v[66:67] neg_lo:[0,1] neg_hi:[0,1]
    v_pk_add_f32 v[100:101], v[100:101], v[68:69] neg_lo:[0,1] neg_hi:[0,1]
    v_pk_add_f32 v[102:103], v[102:103], v[70:71] neg_lo:[0,1] neg_hi:[0,1]
    v_cvt_pk_bf16_f32 v104, v96, v97
    v_cvt_pk_bf16_f32 v105, v98, v99
    v_cvt_pk_bf16_f32 v106, v100, v101
    v_cvt_pk_bf16_f32 v107, v102, v103
    v_lshlrev_b32 v96, 16, v104
    v_lshlrev_b32 v98, 16, v105
    v_lshlrev_b32 v100, 16, v106
    v_lshlrev_b32 v102, 16, v107
    v_and_b32 v97, 0xffff0000, v104
    v_and_b32 v99, 0xffff0000, v105
    v_and_b32 v101, 0xffff0000, v106
    v_and_b32 v103, 0xffff0000, v107
    v_pk_mul_f32 v[96:97], v[96:97], v[72:73]
    v_pk_mul_f32 v[98:99], v[98:99], v[74:75]
    v_pk_mul_f32 v[100:101], v[100:101], v[76:77]
    v_pk_mul_f32 v[102:103], v[102:103], v[78:79]
    v_cvt_pk_bf16_f32 v108, v96, v97
    v_cvt_pk_bf16_f32 v109, v98, v99
    v_cvt_pk_bf16_f32 v110, v100, v101
    v_cvt_pk_bf16_f32 v111, v102, v103
    ds_write_b128 v7, v[108:111] offset:40960
    v_lshlrev_b32 v80, 16, v56
    v_lshlrev_b32 v82, 16, v57
    v_lshlrev_b32 v84, 16, v58
    v_lshlrev_b32 v86, 16, v59
    v_and_b32 v81, 0xffff0000, v56
    v_and_b32 v83, 0xffff0000, v57
    v_and_b32 v85, 0xffff0000, v58
    v_and_b32 v87, 0xffff0000, v59
    v_pk_add_f32 v[80:81], v[80:81], v[64:65] neg_lo:[0,1] neg_hi:[0,1]
    v_pk_add_f32 v[82:83], v[82:83], v[66:67] neg_lo:[0,1] neg_hi:[0,1]
    v_pk_add_f32 v[84:85], v[84:85], v[68:69] neg_lo:[0,1] neg_hi:[0,1]
    v_pk_add_f32 v[86:87], v[86:87], v[70:71] neg_lo:[0,1] neg_hi:[0,1]
    v_cvt_pk_bf16_f32 v88, v80, v81
    v_cvt_pk_bf16_f32 v89, v82, v83
    v_cvt_pk_bf16_f32 v90, v84, v85
    v_cvt_pk_bf16_f32 v91, v86, v87
    v_lshlrev_b32 v80, 16, v88
    v_lshlrev_b32 v82, 16, v89
    v_lshlrev_b32 v84, 16, v90
    v_lshlrev_b32 v86, 16, v91
    v_and_b32 v81, 0xffff0000, v88
    v_and_b32 v83, 0xffff0000, v89
    v_and_b32 v85, 0xffff0000, v90
    v_and_b32 v87, 0xffff0000, v91
    v_pk_mul_f32 v[80:81], v[80:81], v[72:73]
    v_pk_mul_f32 v[82:83], v[82:83], v[74:75]
    v_pk_mul_f32 v[84:85], v[84:85], v[76:77]
    v_pk_mul_f32 v[86:87], v[86:87], v[78:79]
    v_cvt_pk_bf16_f32 v92, v80, v81
    v_cvt_pk_bf16_f32 v93, v82, v83
    v_cvt_pk_bf16_f32 v94, v84, v85
    v_cvt_pk_bf16_f32 v95, v86, v87
    ds_write_b128 v7, v[92:95] offset:49152
    v_lshlrev_b32 v96, 16, v60
    v_lshlrev_b32 v98, 16, v61
    v_lshlrev_b32 v100, 16, v62
    v_lshlrev_b32 v102, 16, v63
    v_and_b32 v97, 0xffff0000, v60
    v_and_b32 v99, 0xffff0000, v61
    v_and_b32 v101, 0xffff0000, v62
    v_and_b32 v103, 0xffff0000, v63
    v_pk_add_f32 v[96:97], v[96:97], v[64:65] neg_lo:[0,1] neg_hi:[0,1]
    v_pk_add_f32 v[98:99], v[98:99], v[66:67] neg_lo:[0,1] neg_hi:[0,1]
    v_pk_add_f32 v[100:101], v[100:101], v[68:69] neg_lo:[0,1] neg_hi:[0,1]
    v_pk_add_f32 v[102:103], v[102:103], v[70:71] neg_lo:[0,1] neg_hi:[0,1]
    v_cvt_pk_bf16_f32 v104, v96, v97
    v_cvt_pk_bf16_f32 v105, v98, v99
    v_cvt_pk_bf16_f32 v106, v100, v101
    v_cvt_pk_bf16_f32 v107, v102, v103
    v_lshlrev_b32 v96, 16, v104
    v_lshlrev_b32 v98, 16, v105
    v_lshlrev_b32 v100, 16, v106
    v_lshlrev_b32 v102, 16, v107
    v_and_b32 v97, 0xffff0000, v104
    v_and_b32 v99, 0xffff0000, v105
    v_and_b32 v101, 0xffff0000, v106
    v_and_b32 v103, 0xffff0000, v107
    v_pk_mul_f32 v[96:97], v[96:97], v[72:73]
    v_pk_mul_f32 v[98:99], v[98:99], v[74:75]
    v_pk_mul_f32 v[100:101], v[100:101], v[76:77]
    v_pk_mul_f32 v[102:103], v[102:103], v[78:79]
    v_cvt_pk_bf16_f32 v108, v96, v97
    v_cvt_pk_bf16_f32 v109, v98, v99
    v_cvt_pk_bf16_f32 v110, v100, v101
    v_cvt_pk_bf16_f32 v111, v102, v103
    ds_write_b128 v7, v[108:111] offset:57344
gemm1b_kernel_nskip:
    s_waitcnt lgkmcnt(0)
    v_mov_b32 v128, 0
    v_mov_b32 v129, 0
    v_mov_b32 v130, 0
    v_mov_b32 v131, 0
    v_mov_b32 v132, 0
    v_mov_b32 v133, 0
    v_mov_b32 v134, 0
    v_mov_b32 v135, 0
    v_mov_b32 v136, 0
    v_mov_b32 v137, 0
    v_mov_b32 v138, 0
    v_mov_b32 v139, 0
    v_mov_b32 v140, 0
    v_mov_b32 v141, 0
    v_mov_b32 v142, 0
    v_mov_b32 v143, 0
    v_mov_b32 v144, 0
    v_mov_b32 v145, 0
    v_mov_b32 v146, 0
    v_mov_b32 v147, 0
    v_mov_b32 v148, 0
    v_mov_b32 v149, 0
    v_mov_b32 v150, 0
    v_mov_b32 v151, 0
    v_mov_b32 v152, 0
    v_mov_b32 v153, 0
    v_mov_b32 v154, 0
    v_mov_b32 v155, 0
    v_mov_b32 v156, 0
    v_mov_b32 v157, 0
    v_mov_b32 v158, 0
    v_mov_b32 v159, 0
    s_cmp_lt_u32 s30, 8
    s_cbranch_scc1 gemm1b_kernel_w_21
    s_waitcnt vmcnt(16)
gemm1b_kernel_w_21:
    s_waitcnt lgkmcnt(0)
    s_barrier
    ds_read_b64_tr_b16 v[80:81], v4 offset:0
    ds_read_b64_tr_b16 v[82:83], v4 offset:1408
    ds_read_b64_tr_b16 v[88:89], v5 offset:0
    ds_read_b64_tr_b16 v[90:91], v5 offset:512
    ds_read_b64_tr_b16 v[96:97], v6 offset:0
    ds_read_b64_tr_b16 v[98:99], v6 offset:512
    ds_read_b64_tr_b16 v[84:85], v4 offset:5632
    ds_read_b64_tr_b16 v[86:87], v4 offset:7040
    ds_read_b64_tr_b16 v[92:93], v5 offset:2048
    ds_read_b64_tr_b16 v[94:95], v5 offset:2560
    ds_read_b64_tr_b16 v[100:101], v6 offset:2048
    ds_read_b64_tr_b16 v[102:103], v6 offset:2560
    s_cmp_lt_u32 s30, 8
    s_cbranch_scc1 gemm1b_kernel_w_22
    s_waitcnt vmcnt(8)
gemm1b_kernel_w_22:
    s_waitcnt lgkmcnt(0)
    s_barrier
    v_mfma_f32_32x32x16_bf16 v[128:143], v[80:83], v[88:91], v[128:143]
    ds_read_b64_tr_b16 v[104:105], v4 offset:22784
    ds_read_b64_tr_b16 v[106:107], v4 offset:24192
    ds_read_b64_tr_b16 v[112:113], v5 offset:4096
    ds_read_b64_tr_b16 v[114:115], v5 offset:4608
    ds_read_b64_tr_b16 v[120:121], v6 offset:4096
    ds_read_b64_tr_b16 v[122:123], v6 offset:4608
    ds_read_b64_tr_b16 v[108:109], v4 offset:28416
    ds_read_b64_tr_b16 v[110:111], v4 offset:29824
    ds_read_b64_tr_b16 v[116:117], v5 offset:6144
    ds_read_b64_tr_b16 v[118:119], v5 offset:6656
    ds_read_b64_tr_b16 v[124:125], v6 offset:6144
    ds_read_b64_tr_b16 v[126:127], v6 offset:6656
    s_add_u32 s33, s32, 133888
    s_mov_b32 m0, s33
    s_mov_b32 s34, 264192
    buffer_load_dwordx4 v2, s[12:15], s34 offen lds
    s_add_u32 m0, s33, 11392
    s_nop 0
    buffer_load_dwordx4 v2, s[16:19], s34 offen lds
    v_mfma_f32_32x32x16_bf16 v[144:159], v[80:83], v[96:99], v[144:159]
    v_mfma_f32_32x32x16_bf16 v[128:143], v[84:87], v[92:95], v[128:143]
    v_mfma_f32_32x32x16_bf16 v[144:159], v[84:87], v[100:103], v[144:159]
    s_cmp_lt_u32 s30, 8
    s_cbranch_scc1 gemm1b_kernel_w_23
    s_waitcnt vmcnt(2)
gemm1b_kernel_w_23:
    s_waitcnt lgkmcnt(0)
    s_barrier
    v_mfma_f32_32x32x16_bf16 v[128:143], v[104:107], v[112:115], v[128:143]
    ds_read_b64_tr_b16 v[80:81], v3 offset:0
    ds_read_b64_tr_b16 v[82:83], v3 offset:1408
    ds_read_b64_tr_b16 v[88:89], v5 offset:8192
    ds_read_b64_tr_b16 v[90:91], v5 offset:8704
    ds_read_b64_tr_b16 v[96:97], v6 offset:8192
    ds_read_b64_tr_b16 v[98:99], v6 offset:8704
    ds_read_b64_tr_b16 v[84:85], v3 offset:5632
    ds_read_b64_tr_b16 v[86:87], v3 offset:7040
    ds_read_b64_tr_b16 v[92:93], v5 offset:10240
    ds_read_b64_tr_b16 v[94:95], v5 offset:10752
    ds_read_b64_tr_b16 v[100:101], v6 offset:10240
    ds_read_b64_tr_b16 v[102:103], v6 offset:10752
    s_add_u32 s33, s32, 65536
    s_mov_b32 m0, s33
    s_mov_b32 s34, 352256
    buffer_load_dwordx4 v2, s[12:15], s34 offen lds
    s_add_u32 m0, s33, 11392
    s_nop 0
    buffer_load_dwordx4 v2, s[16:19], s34 offen lds
    v_mfma_f32_32x32x16_bf16 v[144:159], v[104:107], v[120:123], v[144:159]
    v_mfma_f32_32x32x16_bf16 v[128:143], v[108:111], v[116:119], v[128:143]
    v_mfma_f32_32x32x16_bf16 v[144:159], v[108:111], v[124:127], v[144:159]
    s_cmp_lt_u32 s30, 8
    s_cbranch_scc1 gemm1b_kernel_w_24
    s_waitcnt vmcnt(2)
gemm1b_kernel_w_24:
    s_waitcnt vmcnt(2) lgkmcnt(0)
    s_barrier
    v_mfma_f32_32x32x16_bf16 v[128:143], v[80:83], v[88:91], v[128:143]
    ds_read_b64_tr_b16 v[104:105], v3 offset:22784
    ds_read_b64_tr_b16 v[106:107], v3 offset:24192
    ds_read_b64_tr_b16 v[112:113], v5 offset:12288
    ds_read_b64_tr_b16 v[114:115], v5 offset:12800
    ds_read_b64_tr_b16 v[120:121], v6 offset:12288
    ds_read_b64_tr_b16 v[122:123], v6 offset:12800
    ds_read_b64_tr_b16 v[108:109], v3 offset:28416
    ds_read_b64_tr_b16 v[110:111], v3 offset:29824
    ds_read_b64_tr_b16 v[116:117], v5 offset:14336
    ds_read_b64_tr_b16 v[118:119], v5 offset:14848
    ds_read_b64_tr_b16 v[124:125], v6 offset:14336
    ds_read_b64_tr_b16 v[126:127], v6 offset:14848
    s_add_u32 s33, s32, 88320
    s_mov_b32 m0, s33
    s_mov_b32 s34, 440320
    buffer_load_dwordx4 v2, s[12:15], s34 offen lds
    s_add_u32 m0, s33, 11392
    s_nop 0
    buffer_load_dwordx4 v2, s[16:19], s34 offen lds
    v_mfma_f32_32x32x16_bf16 v[144:159], v[80:83], v[96:99], v[144:159]
    v_mfma_f32_32x32x16_bf16 v[128:143], v[84:87], v[92:95], v[128:143]
    v_mfma_f32_32x32x16_bf16 v[144:159], v[84:87], v[100:103], v[144:159]
    s_cmp_lt_u32 s30, 8
    s_cbranch_scc1 gemm1b_kernel_w_25
    s_waitcnt vmcnt(2)
gemm1b_kernel_w_25:
    s_waitcnt vmcnt(2) lgkmcnt(0)
    s_barrier
    v_mfma_f32_32x32x16_bf16 v[128:143], v[104:107], v[112:115], v[128:143]
    ds_read_b64_tr_b16 v[80:81], v4 offset:0
    ds_read_b64_tr_b16 v[82:83], v4 offset:1408
    ds_read_b64_tr_b16 v[88:89], v5 offset:16384
    ds_read_b64_tr_b16 v[90:91], v5 offset:16896
    ds_read_b64_tr_b16 v[96:97], v6 offset:16384
    ds_read_b64_tr_b16 v[98:99], v6 offset:16896
    ds_read_b64_tr_b16 v[84:85], v4 offset:5632
    ds_read_b64_tr_b16 v[86:87], v4 offset:7040
    ds_read_b64_tr_b16 v[92:93], v5 offset:18432
    ds_read_b64_tr_b16 v[94:95], v5 offset:18944
    ds_read_b64_tr_b16 v[100:101], v6 offset:18432
    ds_read_b64_tr_b16 v[102:103], v6 offset:18944
    s_add_u32 s33, s32, 111104
    s_mov_b32 m0, s33
    s_mov_b32 s34, 528384
    buffer_load_dwordx4 v2, s[12:15], s34 offen lds
    s_add_u32 m0, s33, 11392
    s_nop 0
    buffer_load_dwordx4 v2, s[16:19], s34 offen lds
    v_mfma_f32_32x32x16_bf16 v[144:159], v[104:107], v[120:123], v[144:159]
    v_mfma_f32_32x32x16_bf16 v[128:143], v[108:111], v[116:119], v[128:143]
    v_mfma_f32_32x32x16_bf16 v[144:159], v[108:111], v[124:127], v[144:159]
    s_cmp_lt_u32 s30, 8
    s_cbranch_scc1 gemm1b_kernel_w_26
    s_waitcnt vmcnt(2)
gemm1b_kernel_w_26:
    s_waitcnt vmcnt(2) lgkmcnt(0)
    s_barrier
    v_mfma_f32_32x32x16_bf16 v[128:143], v[80:83], v[88:91], v[128:143]
    ds_read_b64_tr_b16 v[104:105], v4 offset:22784
    ds_read_b64_tr_b16 v[106:107], v4 offset:24192
    ds_read_b64_tr_b16 v[112:113], v5 offset:20480
    ds_read_b64_tr_b16 v[114:115], v5 offset:20992
    ds_read_b64_tr_b16 v[120:121], v6 offset:20480
    ds_read_b64_tr_b16 v[122:123], v6 offset:20992
    ds_read_b64_tr_b16 v[108:109], v4 offset:28416
    ds_read_b64_tr_b16 v[110:111], v4 offset:29824
    ds_read_b64_tr_b16 v[116:117], v5 offset:22528
    ds_read_b64_tr_b16 v[118:119], v5 offset:23040
    ds_read_b64_tr_b16 v[124:125], v6 offset:22528
    ds_read_b64_tr_b16 v[126:127], v6 offset:23040
    s_add_u32 s33, s32, 133888
    s_mov_b32 m0, s33
    s_mov_b32 s34, 616448
    buffer_load_dwordx4 v2, s[12:15], s34 offen lds
    s_add_u32 m0, s33, 11392
    s_nop 0
    buffer_load_dwordx4 v2, s[16:19], s34 offen lds
    v_mfma_f32_32x32x16_bf16 v[144:159], v[80:83], v[96:99], v[144:159]
    v_mfma_f32_32x32x16_bf16 v[128:143], v[84:87], v[92:95], v[128:143]
    v_mfma_f32_32x32x16_bf16 v[144:159], v[84:87], v[100:103], v[144:159]
    s_cmp_lt_u32 s30, 8
    s_cbranch_scc1 gemm1b_kernel_w_27
    s_waitcnt vmcnt(2)
gemm1b_kernel_w_27:
    s_waitcnt vmcnt(2) lgkmcnt(0)
    s_barrier
    v_mfma_f32_32x32x16_bf16 v[128:143], v[104:107], v[112:115], v[128:143]
    ds_read_b64_tr_b16 v[80:81], v3 offset:0
    ds_read_b64_tr_b16 v[82:83], v3 offset:1408
    ds_read_b64_tr_b16 v[88:89], v5 offset:24576
    ds_read_b64_tr_b16 v[90:91], v5 offset:25088
    ds_read_b64_tr_b16 v[96:97], v6 offset:24576
    ds_read_b64_tr_b16 v[98:99], v6 offset:25088
    ds_read_b64_tr_b16 v[84:85], v3 offset:5632
    ds_read_b64_tr_b16 v[86:87], v3 offset:7040
    ds_read_b64_tr_b16 v[92:93], v5 offset:26624
    ds_read_b64_tr_b16 v[94:95], v5 offset:27136
    ds_read_b64_tr_b16 v[100:101], v6 offset:26624
    ds_read_b64_tr_b16 v[102:103], v6 offset:27136
    s_add_u32 s33, s32, 65536
    s_mov_b32 m0, s33
    s_mov_b32 s34, 704512
    buffer_load_dwordx4 v2, s[12:15], s34 offen lds
    s_add_u32 m0, s33, 11392
    s_nop 0
    buffer_load_dwordx4 v2, s[16:19], s34 offen lds
    v_mfma_f32_32x32x16_bf16 v[144:159], v[104:107], v[120:123], v[144:159]
    v_mfma_f32_32x32x16_bf16 v[128:143], v[108:111], v[116:119], v[128:143]
    v_mfma_f32_32x32x16_bf16 v[144:159], v[108:111], v[124:127], v[144:159]
    s_cmp_lt_u32 s30, 8
    s_cbranch_scc1 gemm1b_kernel_w_28
    s_waitcnt vmcnt(2)
gemm1b_kernel_w_28:
    s_waitcnt vmcnt(2) lgkmcnt(0)
    s_barrier
    v_mfma_f32_32x32x16_bf16 v[128:143], v[80:83], v[88:91], v[128:143]
    ds_read_b64_tr_b16 v[104:105], v3 offset:22784
    ds_read_b64_tr_b16 v[106:107], v3 offset:24192
    ds_read_b64_tr_b16 v[112:113], v5 offset:28672
    ds_read_b64_tr_b16 v[114:115], v5 offset:29184
    ds_read_b64_tr_b16 v[120:121], v6 offset:28672
    ds_read_b64_tr_b16 v[122:123], v6 offset:29184
    ds_read_b64_tr_b16 v[108:109], v3 offset:28416
    ds_read_b64_tr_b16 v[110:111], v3 offset:29824
    ds_read_b64_tr_b16 v[116:117], v5 offset:30720
    ds_read_b64_tr_b16 v[118:119], v5 offset:31232
    ds_read_b64_tr_b16 v[124:125], v6 offset:30720
    ds_read_b64_tr_b16 v[126:127], v6 offset:31232
    s_add_u32 s33, s32, 88320
    s_mov_b32 m0, s33
    s_mov_b32 s34, 792576
    buffer_load_dwordx4 v2, s[12:15], s34 offen lds
    s_add_u32 m0, s33, 11392
    s_nop 0
    buffer_load_dwordx4 v2, s[16:19], s34 offen lds
    v_mfma_f32_32x32x16_bf16 v[144:159], v[80:83], v[96:99], v[144:159]
    v_mfma_f32_32x32x16_bf16 v[128:143], v[84:87], v[92:95], v[128:143]
    v_mfma_f32_32x32x16_bf16 v[144:159], v[84:87], v[100:103], v[144:159]
    s_cmp_lt_u32 s30, 8
    s_cbranch_scc1 gemm1b_kernel_w_29
    s_waitcnt vmcnt(2)
gemm1b_kernel_w_29:
    s_waitcnt vmcnt(2) lgkmcnt(0)
    s_barrier
    v_mfma_f32_32x32x16_bf16 v[128:143], v[104:107], v[112:115], v[128:143]
    ds_read_b64_tr_b16 v[80:81], v4 offset:0
    ds_read_b64_tr_b16 v[82:83], v4 offset:1408
    ds_read_b64_tr_b16 v[88:89], v5 offset:32768
    ds_read_b64_tr_b16 v[90:91], v5 offset:33280
    ds_read_b64_tr_b16 v[96:97], v6 offset:32768
    ds_read_b64_tr_b16 v[98:99], v6 offset:33280
    ds_read_b64_tr_b16 v[84:85], v4 offset:5632
    ds_read_b64_tr_b16 v[86:87], v4 offset:7040
    ds_read_b64_tr_b16 v[92:93], v5 offset:34816
    ds_read_b64_tr_b16 v[94:95], v5 offset:35328
    ds_read_b64_tr_b16 v[100:101], v6 offset:34816
    ds_read_b64_tr_b16 v[102:103], v6 offset:35328
    s_add_u32 s33, s32, 111104
    s_mov_b32 m0, s33
    s_mov_b32 s34, 880640
    buffer_load_dwordx4 v2, s[12:15], s34 offen lds
    s_add_u32 m0, s33, 11392
    s_nop 0
    buffer_load_dwordx4 v2, s[16:19], s34 offen lds
    v_mfma_f32_32x32x16_bf16 v[144:159], v[104:107], v[120:123], v[144:159]
    v_mfma_f32_32x32x16_bf16 v[128:143], v[108:111], v[116:119], v[128:143]
    v_mfma_f32_32x32x16_bf16 v[144:159], v[108:111], v[124:127], v[144:159]
    s_cmp_lt_u32 s30, 8
    s_cbranch_scc1 gemm1b_kernel_w_30
    s_waitcnt vmcnt(2)
gemm1b_kernel_w_30:
    s_waitcnt vmcnt(2) lgkmcnt(0)
    s_barrier
    v_mfma_f32_32x32x16_bf16 v[128:143], v[80:83], v[88:91], v[128:143]
    ds_read_b64_tr_b16 v[104:105], v4 offset:22784
    ds_read_b64_tr_b16 v[106:107], v4 offset:24192
    ds_read_b64_tr_b16 v[112:113], v5 offset:36864
    ds_read_b64_tr_b16 v[114:115], v5 offset:37376
    ds_read_b64_tr_b16 v[120:121], v6 offset:36864
    ds_read_b64_tr_b16 v[122:123], v6 offset:37376
    ds_read_b64_tr_b16 v[108:109], v4 offset:28416
    ds_read_b64_tr_b16 v[110:111], v4 offset:29824
    ds_read_b64_tr_b16 v[116:117], v5 offset:38912
    ds_read_b64_tr_b16 v[118:119], v5 offset:39424
    ds_read_b64_tr_b16 v[124:125], v6 offset:38912
    ds_read_b64_tr_b16 v[126:127], v6 offset:39424
    s_add_u32 s33, s32, 133888
    s_mov_b32 m0, s33
    s_mov_b32 s34, 968704
    buffer_load_dwordx4 v2, s[12:15], s34 offen lds
    s_add_u32 m0, s33, 11392
    s_nop 0
    buffer_load_dwordx4 v2, s[16:19], s34 offen lds
    v_mfma_f32_32x32x16_bf16 v[144:159], v[80:83], v[96:99], v[144:159]
    v_mfma_f32_32x32x16_bf16 v[128:143], v[84:87], v[92:95], v[128:143]
    v_mfma_f32_32x32x16_bf16 v[144:159], v[84:87], v[100:103], v[144:159]
    s_cmp_lt_u32 s30, 8
    s_cbranch_scc1 gemm1b_kernel_w_31
    s_waitcnt vmcnt(2)
gemm1b_kernel_w_31:
    s_waitcnt vmcnt(2) lgkmcnt(0)
    s_barrier
    v_mfma_f32_32x32x16_bf16 v[128:143], v[104:107], v[112:115], v[128:143]
    ds_read_b64_tr_b16 v[80:81], v3 offset:0
    ds_read_b64_tr_b16 v[82:83], v3 offset:1408
    ds_read_b64_tr_b16 v[88:89], v5 offset:40960
    ds_read_b64_tr_b16 v[90:91], v5 offset:41472
    ds_read_b64_tr_b16 v[96:97], v6 offset:40960
    ds_read_b64_tr_b16 v[98:99], v6 offset:41472
    ds_read_b64_tr_b16 v[84:85], v3 offset:5632
    ds_read_b64_tr_b16 v[86:87], v3 offset:7040
    ds_read_b64_tr_b16 v[92:93], v5 offset:43008
    ds_read_b64_tr_b16 v[94:95], v5 offset:43520
    ds_read_b64_tr_b16 v[100:101], v6 offset:43008
    ds_read_b64_tr_b16 v[102:103], v6 offset:43520
    s_add_u32 s33, s32, 65536
    s_mov_b32 m0, s33
    s_mov_b32 s34, 1056768
    buffer_load_dwordx4 v2, s[12:15], s34 offen lds
    s_add_u32 m0, s33, 11392
    s_nop 0
    buffer_load_dwordx4 v2, s[16:19], s34 offen lds
    v_mfma_f32_32x32x16_bf16 v[144:159], v[104:107], v[120:123], v[144:159]
    v_mfma_f32_32x32x16_bf16 v[128:143], v[108:111], v[116:119], v[128:143]
    v_mfma_f32_32x32x16_bf16 v[144:159], v[108:111], v[124:127], v[144:159]
    s_cmp_lt_u32 s30, 8
    s_cbranch_scc1 gemm1b_kernel_w_32
    s_waitcnt vmcnt(2)
gemm1b_kernel_w_32:
    s_waitcnt vmcnt(2) lgkmcnt(0)
    s_barrier
    v_mfma_f32_32x32x16_bf16 v[128:143], v[80:83], v[88:91], v[128:143]
    ds_read_b64_tr_b16 v[104:105], v3 offset:22784
    ds_read_b64_tr_b16 v[106:107], v3 offset:24192
    ds_read_b64_tr_b16 v[112:113], v5 offset:45056
    ds_read_b64_tr_b16 v[114:115], v5 offset:45568
    ds_read_b64_tr_b16 v[120:121], v6 offset:45056
    ds_read_b64_tr_b16 v[122:123], v6 offset:45568
    ds_read_b64_tr_b16 v[108:109], v3 offset:28416
    ds_read_b64_tr_b16 v[110:111], v3 offset:29824
    ds_read_b64_tr_b16 v[116:117], v5 offset:47104
    ds_read_b64_tr_b16 v[118:119], v5 offset:47616
    ds_read_b64_tr_b16 v[124:125], v6 offset:47104
    ds_read_b64_tr_b16 v[126:127], v6 offset:47616
    s_add_u32 s33, s32, 88320
    s_mov_b32 m0, s33
    s_mov_b32 s34, 1144832
    buffer_load_dwordx4 v2, s[12:15], s34 offen lds
    s_add_u32 m0, s33, 11392
    s_nop 0
    buffer_load_dwordx4 v2, s[16:19], s34 offen lds
    v_mfma_f32_32x32x16_bf16 v[144:159], v[80:83], v[96:99], v[144:159]
    v_mfma_f32_32x32x16_bf16 v[128:143], v[84:87], v[92:95], v[128:143]
    v_mfma_f32_32x32x16_bf16 v[144:159], v[84:87], v[100:103], v[144:159]
    s_cmp_lt_u32 s30, 8
    s_cbranch_scc1 gemm1b_kernel_w_33
    s_waitcnt vmcnt(2)
gemm1b_kernel_w_33:
    s_waitcnt vmcnt(2) lgkmcnt(0)
    s_barrier
    v_mfma_f32_32x32x16_bf16 v[128:143], v[104:107], v[112:115], v[128:143]
    ds_read_b64_tr_b16 v[80:81], v4 offset:0
    ds_read_b64_tr_b16 v[82:83], v4 offset:1408
    ds_read_b64_tr_b16 v[88:89], v5 offset:49152
    ds_read_b64_tr_b16 v[90:91], v5 offset:49664
    ds_read_b64_tr_b16 v[96:97], v6 offset:49152
    ds_read_b64_tr_b16 v[98:99], v6 offset:49664
    ds_read_b64_tr_b16 v[84:85], v4 offset:5632
    ds_read_b64_tr_b16 v[86:87], v4 offset:7040
    ds_read_b64_tr_b16 v[92:93], v5 offset:51200
    ds_read_b64_tr_b16 v[94:95], v5 offset:51712
    ds_read_b64_tr_b16 v[100:101], v6 offset:51200
    ds_read_b64_tr_b16 v[102:103], v6 offset:51712
    s_add_u32 s33, s32, 111104
    s_mov_b32 m0, s33
    s_mov_b32 s34, 1232896
    buffer_load_dwordx4 v2, s[12:15], s34 offen lds
    s_add_u32 m0, s33, 11392
    s_nop 0
    buffer_load_dwordx4 v2, s[16:19], s34 offen lds
    v_mfma_f32_32x32x16_bf16 v[144:159], v[104:107], v[120:123], v[144:159]
    v_mfma_f32_32x32x16_bf16 v[128:143], v[108:111], v[116:119], v[128:143]
    v_mfma_f32_32x32x16_bf16 v[144:159], v[108:111], v[124:127], v[144:159]
    s_cmp_lt_u32 s30, 8
    s_cbranch_scc1 gemm1b_kernel_w_34
    s_waitcnt vmcnt(2)
gemm1b_kernel_w_34:
    s_waitcnt vmcnt(2) lgkmcnt(0)
    s_barrier
    v_mfma_f32_32x32x16_bf16 v[128:143], v[80:83], v[88:91], v[128:143]
    ds_read_b64_tr_b16 v[104:105], v4 offset:22784
    ds_read_b64_tr_b16 v[106:107], v4 offset:24192
    ds_read_b64_tr_b16 v[112:113], v5 offset:53248
    ds_read_b64_tr_b16 v[114:115], v5 offset:53760
    ds_read_b64_tr_b16 v[120:121], v6 offset:53248
    ds_read_b64_tr_b16 v[122:123], v6 offset:53760
    ds_read_b64_tr_b16 v[108:109], v4 offset:28416
    ds_read_b64_tr_b16 v[110:111], v4 offset:29824
    ds_read_b64_tr_b16 v[116:117], v5 offset:55296
    ds_read_b64_tr_b16 v[118:119], v5 offset:55808
    ds_read_b64_tr_b16 v[124:125], v6 offset:55296
    ds_read_b64_tr_b16 v[126:127], v6 offset:55808
    s_add_u32 s33, s32, 133888
    s_mov_b32 m0, s33
    s_mov_b32 s34, 1320960
    buffer_load_dwordx4 v2, s[12:15], s34 offen lds
    s_add_u32 m0, s33, 11392
    s_nop 0
    buffer_load_dwordx4 v2, s[16:19], s34 offen lds
    v_mfma_f32_32x32x16_bf16 v[144:159], v[80:83], v[96:99], v[144:159]
    v_mfma_f32_32x32x16_bf16 v[128:143], v[84:87], v[92:95], v[128:143]
    v_mfma_f32_32x32x16_bf16 v[144:159], v[84:87], v[100:103], v[144:159]
    s_cmp_lt_u32 s30, 8
    s_cbranch_scc1 gemm1b_kernel_w_35
    s_waitcnt vmcnt(2)
gemm1b_kernel_w_35:
    s_waitcnt vmcnt(2) lgkmcnt(0)
    s_barrier
    v_mfma_f32_32x32x16_bf16 v[128:143], v[104:107], v[112:115], v[128:143]
    ds_read_b64_tr_b16 v[80:81], v3 offset:0
    ds_read_b64_tr_b16 v[82:83], v3 offset:1408
    ds_read_b64_tr_b16 v[88:89], v5 offset:57344
    ds_read_b64_tr_b16 v[90:91], v5 offset:57856
    ds_read_b64_tr_b16 v[96:97], v6 offset:57344
    ds_read_b64_tr_b16 v[98:99], v6 offset:57856
    ds_read_b64_tr_b16 v[84:85], v3 offset:5632
    ds_read_b64_tr_b16 v[86:87], v3 offset:7040
    ds_read_b64_tr_b16 v[92:93], v5 offset:59392
    ds_read_b64_tr_b16 v[94:95], v5 offset:59904
    ds_read_b64_tr_b16 v[100:101], v6 offset:59392
    ds_read_b64_tr_b16 v[102:103], v6 offset:59904
    v_mfma_f32_32x32x16_bf16 v[144:159], v[104:107], v[120:123], v[144:159]
    v_mfma_f32_32x32x16_bf16 v[128:143], v[108:111], v[116:119], v[128:143]
    v_mfma_f32_32x32x16_bf16 v[144:159], v[108:111], v[124:127], v[144:159]
    s_cmp_lt_u32 s30, 8
    s_cbranch_scc1 gemm1b_kernel_w_36
    s_waitcnt vmcnt(0)
gemm1b_kernel_w_36:
    s_waitcnt vmcnt(0) lgkmcnt(0)
    s_barrier
    v_mfma_f32_32x32x16_bf16 v[128:143], v[80:83], v[88:91], v[128:143]
    ds_read_b64_tr_b16 v[104:105], v3 offset:22784
    ds_read_b64_tr_b16 v[106:107], v3 offset:24192
    ds_read_b64_tr_b16 v[112:113], v5 offset:61440
    ds_read_b64_tr_b16 v[114:115], v5 offset:61952
    ds_read_b64_tr_b16 v[120:121], v6 offset:61440
    ds_read_b64_tr_b16 v[122:123], v6 offset:61952
    ds_read_b64_tr_b16 v[108:109], v3 offset:28416
    ds_read_b64_tr_b16 v[110:111], v3 offset:29824
    ds_read_b64_tr_b16 v[116:117], v5 offset:63488
    ds_read_b64_tr_b16 v[118:119], v5 offset:64000
    ds_read_b64_tr_b16 v[124:125], v6 offset:63488
    ds_read_b64_tr_b16 v[126:127], v6 offset:64000
    v_mfma_f32_32x32x16_bf16 v[144:159], v[80:83], v[96:99], v[144:159]
    v_mfma_f32_32x32x16_bf16 v[128:143], v[84:87], v[92:95], v[128:143]
    v_mfma_f32_32x32x16_bf16 v[144:159], v[84:87], v[100:103], v[144:159]
    s_waitcnt lgkmcnt(0)
    s_barrier
    v_mfma_f32_32x32x16_bf16 v[128:143], v[104:107], v[112:115], v[128:143]
    v_mfma_f32_32x32x16_bf16 v[144:159], v[104:107], v[120:123], v[144:159]
    v_mfma_f32_32x32x16_bf16 v[128:143], v[108:111], v[116:119], v[128:143]
    v_mfma_f32_32x32x16_bf16 v[144:159], v[108:111], v[124:127], v[144:159]
    s_nop 15
    s_mov_b32 s36, 0xbfb8aa3b
    v_and_b32 v8, 31, v0
    v_bfe_u32 v9, v0, 5, 1
    s_lshl_b32 s35, s29, 6
    v_add_u32 v8, s35, v8
    v_mul_u32_u24 v8, 2816, v8
    v_lshl_add_u32 v8, v9, 3, v8
    s_lshl_b32 s35, s30, 5
    s_add_u32 s35, s35, s31
    v_add_u32 v8, s35, v8
    s_cmp_eq_u32 s28, 7
    s_cselect_b32 s37, 1, 0
    s_cmp_ge_u32 s30, 9
    s_cselect_b32 s38, 1, 0
    s_and_b32 s37, s37, s38
    v_cvt_pk_bf16_f32 v10, v128, v129
    v_cvt_pk_bf16_f32 v11, v136, v137
    v_lshlrev_b32 v12, 16, v10
    v_and_b32 v13, 0xffff0000, v10
    v_mul_f32 v14, s36, v12
    v_mul_f32 v15, s36, v13
    v_exp_f32 v14, v14
    v_exp_f32 v15, v15
    v_lshlrev_b32 v128, 16, v11
    v_add_f32 v14, 1.0, v14
    v_add_f32 v15, 1.0, v15
    v_rcp_f32 v14, v14
    v_rcp_f32 v15, v15
    v_and_b32 v129, 0xffff0000, v11
    v_pk_mul_f32 v[12:13], v[12:13], v[14:15]
    v_cvt_pk_bf16_f32 v10, v12, v13
    v_lshlrev_b32 v12, 16, v10
    v_and_b32 v13, 0xffff0000, v10
    v_pk_mul_f32 v[12:13], v[12:13], v[128:129]
    v_cvt_pk_bf16_f32 v16, v12, v13
    v_cvt_pk_bf16_f32 v10, v130, v131
    v_cvt_pk_bf16_f32 v11, v138, v139
    v_lshlrev_b32 v12, 16, v10
    v_and_b32 v13, 0xffff0000, v10
    v_mul_f32 v14, s36, v12
    v_mul_f32 v15, s36, v13
    v_exp_f32 v14, v14
    v_exp_f32 v15, v15
    v_lshlrev_b32 v130, 16, v11
    v_add_f32 v14, 1.0, v14
    v_add_f32 v15, 1.0, v15
    v_rcp_f32 v14, v14
    v_rcp_f32 v15, v15
    v_and_b32 v131, 0xffff0000, v11
    v_pk_mul_f32 v[12:13], v[12:13], v[14:15]
    v_cvt_pk_bf16_f32 v10, v12, v13
    v_lshlrev_b32 v12, 16, v10
    v_and_b32 v13, 0xffff0000, v10
    v_pk_mul_f32 v[12:13], v[12:13], v[130:131]
    v_cvt_pk_bf16_f32 v17, v12, v13
    s_cmp_eq_u32 s37, 0
    s_cbranch_scc1 gemm1b_kernel_nz_37
    v_mov_b32 v16, 0
    v_mov_b32 v17, 0
gemm1b_kernel_nz_37:
    buffer_store_dwordx2 v[16:17], v8, s[24:27], 0 offen offset:0
    v_cvt_pk_bf16_f32 v10, v132, v133
    v_cvt_pk_bf16_f32 v11, v140, v141
    v_lshlrev_b32 v12, 16, v10
    v_and_b32 v13, 0xffff0000, v10
    v_mul_f32 v14, s36, v12
    v_mul_f32 v15, s36, v13
    v_exp_f32 v14, v14
    v_exp_f32 v15, v15
    v_lshlrev_b32 v132, 16, v11
    v_add_f32 v14, 1.0, v14
    v_add_f32 v15, 1.0, v15
    v_rcp_f32 v14, v14
    v_rcp_f32 v15, v15
    v_and_b32 v133, 0xffff0000, v11
    v_pk_mul_f32 v[12:13], v[12:13], v[14:15]
    v_cvt_pk_bf16_f32 v10, v12, v13
    v_lshlrev_b32 v12, 16, v10
    v_and_b32 v13, 0xffff0000, v10
    v_pk_mul_f32 v[12:13], v[12:13], v[132:133]
    v_cvt_pk_bf16_f32 v18, v12, v13
    v_cvt_pk_bf16_f32 v10, v134, v135
    v_cvt_pk_bf16_f32 v11, v142, v143
    v_lshlrev_b32 v12, 16, v10
    v_and_b32 v13, 0xffff0000, v10
    v_mul_f32 v14, s36, v12
    v_mul_f32 v15, s36, v13
    v_exp_f32 v14, v14
    v_exp_f32 v15, v15
    v_lshlrev_b32 v134, 16, v11
    v_add_f32 v14, 1.0, v14
    v_add_f32 v15, 1.0, v15
    v_rcp_f32 v14, v14
    v_rcp_f32 v15, v15
    v_and_b32 v135, 0xffff0000, v11
    v_pk_mul_f32 v[12:13], v[12:13], v[14:15]
    v_cvt_pk_bf16_f32 v10, v12, v13
    v_lshlrev_b32 v12, 16, v10
    v_and_b32 v13, 0xffff0000, v10
    v_pk_mul_f32 v[12:13], v[12:13], v[134:135]
    v_cvt_pk_bf16_f32 v19, v12, v13
    s_cmp_eq_u32 s37, 0
    s_cbranch_scc1 gemm1b_kernel_nz_38
    v_mov_b32 v18, 0
    v_mov_b32 v19, 0
gemm1b_kernel_nz_38:
    buffer_store_dwordx2 v[18:19], v8, s[24:27], 0 offen offset:16
    v_cvt_pk_bf16_f32 v10, v144, v145
    v_cvt_pk_bf16_f32 v11, v152, v153
    v_lshlrev_b32 v12, 16, v10
    v_and_b32 v13, 0xffff0000, v10
    v_mul_f32 v14, s36, v12
    v_mul_f32 v15, s36, v13
    v_exp_f32 v14, v14
    v_exp_f32 v15, v15
    v_lshlrev_b32 v144, 16, v11
    v_add_f32 v14, 1.0, v14
    v_add_f32 v15, 1.0, v15
    v_rcp_f32 v14, v14
    v_rcp_f32 v15, v15
    v_and_b32 v145, 0xffff0000, v11
    v_pk_mul_f32 v[12:13], v[12:13], v[14:15]
    v_cvt_pk_bf16_f32 v10, v12, v13
    v_lshlrev_b32 v12, 16, v10
    v_and_b32 v13, 0xffff0000, v10
    v_pk_mul_f32 v[12:13], v[12:13], v[144:145]
    v_cvt_pk_bf16_f32 v20, v12, v13
    v_cvt_pk_bf16_f32 v10, v146, v147
    v_cvt_pk_bf16_f32 v11, v154, v155
    v_lshlrev_b32 v12, 16, v10
    v_and_b32 v13, 0xffff0000, v10
    v_mul_f32 v14, s36, v12
    v_mul_f32 v15, s36, v13
    v_exp_f32 v14, v14
    v_exp_f32 v15, v15
    v_lshlrev_b32 v146, 16, v11
    v_add_f32 v14, 1.0, v14
    v_add_f32 v15, 1.0, v15
    v_rcp_f32 v14, v14
    v_rcp_f32 v15, v15
    v_and_b32 v147, 0xffff0000, v11
    v_pk_mul_f32 v[12:13], v[12:13], v[14:15]
    v_cvt_pk_bf16_f32 v10, v12, v13
    v_lshlrev_b32 v12, 16, v10
    v_and_b32 v13, 0xffff0000, v10
    v_pk_mul_f32 v[12:13], v[12:13], v[146:147]
    v_cvt_pk_bf16_f32 v21, v12, v13
    s_cmp_eq_u32 s37, 0
    s_cbranch_scc1 gemm1b_kernel_nz_39
    v_mov_b32 v20, 0
    v_mov_b32 v21, 0
gemm1b_kernel_nz_39:
    v_add_u32 v8, 90112, v8
    buffer_store_dwordx2 v[20:21], v8, s[24:27], 0 offen offset:0
    v_cvt_pk_bf16_f32 v10, v148, v149
    v_cvt_pk_bf16_f32 v11, v156, v157
    v_lshlrev_b32 v12, 16, v10
    v_and_b32 v13, 0xffff0000, v10
    v_mul_f32 v14, s36, v12
    v_mul_f32 v15, s36, v13
    v_exp_f32 v14, v14
    v_exp_f32 v15, v15
    v_lshlrev_b32 v148, 16, v11
    v_add_f32 v14, 1.0, v14
    v_add_f32 v15, 1.0, v15
    v_rcp_f32 v14, v14
    v_rcp_f32 v15, v15
    v_and_b32 v149, 0xffff0000, v11
    v_pk_mul_f32 v[12:13], v[12:13], v[14:15]
    v_cvt_pk_bf16_f32 v10, v12, v13
    v_lshlrev_b32 v12, 16, v10
    v_and_b32 v13, 0xffff0000, v10
    v_pk_mul_f32 v[12:13], v[12:13], v[148:149]
    v_cvt_pk_bf16_f32 v22, v12, v13
    v_cvt_pk_bf16_f32 v10, v150, v151
    v_cvt_pk_bf16_f32 v11, v158, v159
    v_lshlrev_b32 v12, 16, v10
    v_and_b32 v13, 0xffff0000, v10
    v_mul_f32 v14, s36, v12
    v_mul_f32 v15, s36, v13
    v_exp_f32 v14, v14
    v_exp_f32 v15, v15
    v_lshlrev_b32 v150, 16, v11
    v_add_f32 v14, 1.0, v14
    v_add_f32 v15, 1.0, v15
    v_rcp_f32 v14, v14
    v_rcp_f32 v15, v15
    v_and_b32 v151, 0xffff0000, v11
    v_pk_mul_f32 v[12:13], v[12:13], v[14:15]
    v_cvt_pk_bf16_f32 v10, v12, v13
    v_lshlrev_b32 v12, 16, v10
    v_and_b32 v13, 0xffff0000, v10
    v_pk_mul_f32 v[12:13], v[12:13], v[150:151]
    v_cvt_pk_bf16_f32 v23, v12, v13
    s_cmp_eq_u32 s37, 0
    s_cbranch_scc1 gemm1b_kernel_nz_40
    v_mov_b32 v22, 0
    v_mov_b32 v23, 0
gemm1b_kernel_nz_40:
    buffer_store_dwordx2 v[22:23], v8, s[24:27], 0 offen offset:16
gemm1b_kernel_end:
    s_endpgm
.section .rodata,"a"
.p2align 6
.amdhsa_kernel gemm1b_kernel
  .amdhsa_next_free_vgpr 160
  .amdhsa_next_free_sgpr 102
  .amdhsa_accum_offset 160
  .amdhsa_group_segment_fixed_size 0
  .amdhsa_kernarg_size 112
  .amdhsa_user_sgpr_count 2
  .amdhsa_user_sgpr_kernarg_segment_ptr 1
  .amdhsa_system_sgpr_workgroup_id_x 1
.end_amdhsa_kernel
.text
.globl gemm2b_kernel
.p2align 8
.type gemm2b_kernel,@function
gemm2b_kernel:
    s_cmp_ge_u32 s2, 256
    s_cbranch_scc1 gemm2b_kernel_end
    s_load_dwordx4 s[4:7], s[0:1], 80
    s_load_dwordx2 s[8:9], s[0:1], 104
    s_lshr_b32 s28, s2, 5
    s_and_b32 s29, s2, 31
    v_lshrrev_b32 v1, 6, v0
    s_nop 1
    v_readfirstlane_b32 s30, v1
    s_waitcnt lgkmcnt(0)
    s_mov_b32 s12, s4
    s_mov_b32 s13, s5
    s_mov_b32 s14, 0x158000
    s_mov_b32 s15, 0x00020000
    s_add_u32 s16, s8, 0xc00000
    s_addc_u32 s17, s9, 0
    s_mov_b32 s18, 0x580000
    s_mov_b32 s19, 0x00020000
    s_add_u32 s20, s8, 0x900000
    s_addc_u32 s21, s9, 0
    s_mov_b32 s22, 0x220000
    s_mov_b32 s23, 0x00020000
    s_mov_b32 s24, s6
    s_mov_b32 s25, s7
    s_mov_b32 s26, 0x200000
    s_mov_b32 s27, 0x00020000
    s_and_b32 s31, s30, 1
    s_lshr_b32 s32, s30, 1
    v_and_b32 v2, 31, v0
    v_bfe_u32 v3, v0, 5, 1
    s_lshl_b32 s33, s28, 6
    s_lshl_b32 s34, s32, 5
    s_add_u32 s33, s33, s34
    v_add_u32 v4, s33, v2
    v_mul_u32_u24 v4, 4352, v4
    s_lshl_b32 s33, s29, 6
    s_lshl_b32 s34, s31, 5
    s_add_u32 s33, s33, s34
    s_lshl_b32 s33, s33, 1
    v_lshl_add_u32 v4, v3, 3, v4
    v_add_u32 v4, s33, v4
    buffer_load_dwordx2 v[40:41], v4, s[20:23], 0 offen
    buffer_load_dwordx2 v[42:43], v4, s[20:23], 0 offen offset:16
    buffer_load_dwordx2 v[44:45], v4, s[20:23], 0 offen offset:32
    buffer_load_dwordx2 v[46:47], v4, s[20:23], 0 offen offset:48
    v_lshrrev_b32 v5, 3, v0
    v_and_b32 v6, 7, v0
    v_bfe_u32 v7, v5, 1, 3
    v_xor_b32 v7, v7, v6
    s_lshl_b32 s33, s29, 6
    v_add_u32 v8, s33, v5
    v_mul_u32_u24 v8, 2816, v8
    v_lshl_add_u32 v8, v7, 4, v8
    v_add_u32 v9, 90112, v8
    v_bfe_u32 v7, v5, 1, 1
    v_lshlrev_b32 v7, 2, v7
    v_xor_b32 v7, v7, v6
    v_lshlrev_b32 v10, 10, v5
    v_lshl_add_u32 v10, v7, 4, v10
    s_lshl_b32 s33, s28, 7
    v_add_u32 v10, s33, v10
    v_add_u32 v11, 0x8000, v10
    s_lshl_b32 s35, s30, 10
    s_lshr_b32 s47, s2, 3
    s_sub_u32 s48, s47, 22
    s_cmp_ge_u32 s47, 22
    s_cselect_b32 s47, s48, s47
    s_add_u32 s36, s35, 0
    s_mov_b32 m0, s36
    s_mov_b32 s37, 0
    buffer_load_dwordx4 v8, s[16:19], s37 offen lds
    s_add_u32 m0, s36, 4096
    s_mov_b32 s38, 0
    buffer_load_dwordx4 v9, s[16:19], s37 offen lds
    s_add_u32 m0, s36, 8192
    s_nop 0
    buffer_load_dwordx4 v10, s[12:15], s38 offen lds
    s_add_u32 m0, s36, 12288
    s_nop 0
    buffer_load_dwordx4 v11, s[12:15], s38 offen lds
    s_add_u32 s36, s35, 16384
    s_mov_b32 m0, s36
    s_mov_b32 s37, 128
    buffer_load_dwordx4 v8, s[16:19], s37 offen lds
    s_add_u32 m0, s36, 4096
    s_mov_b32 s38, 65536
    buffer_load_dwordx4 v9, s[16:19], s37 offen lds
    s_add_u32 m0, s36, 8192
    s_nop 0
    buffer_load_dwordx4 v10, s[12:15], s38 offen lds
    s_add_u32 m0, s36, 12288
    s_nop 0
    buffer_load_dwordx4 v11, s[12:15], s38 offen lds
    s_add_u32 s36, s35, 32768
    s_mov_b32 m0, s36
    s_mov_b32 s37, 256
    buffer_load_dwordx4 v8, s[16:19], s37 offen lds
    s_add_u32 m0, s36, 4096
    s_mov_b32 s38, 131072
    buffer_load_dwordx4 v9, s[16:19], s37 offen lds
    s_add_u32 m0, s36, 8192
    s_nop 0
    buffer_load_dwordx4 v10, s[12:15], s38 offen lds
    s_add_u32 m0, s36, 12288
    s_nop 0
    buffer_load_dwordx4 v11, s[12:15], s38 offen lds
    s_add_u32 s36, s35, 49152
    s_mov_b32 m0, s36
    s_mov_b32 s37, 384
    buffer_load_dwordx4 v8, s[16:19], s37 offen lds
    s_add_u32 m0, s36, 4096
    s_mov_b32 s38, 196608
    buffer_load_dwordx4 v9, s[16:19], s37 offen lds
    s_add_u32 m0, s36, 8192
    s_nop 0
    buffer_load_dwordx4 v10, s[12:15], s38 offen lds
    s_add_u32 m0, s36, 12288
    s_nop 0
    buffer_load_dwordx4 v11, s[12:15], s38 offen lds
    s_add_u32 s36, s35, 65536
    s_mov_b32 m0, s36
    s_mov_b32 s37, 512
    buffer_load_dwordx4 v8, s[16:19], s37 offen lds
    s_add_u32 m0, s36, 4096
    s_mov_b32 s38, 262144
    buffer_load_dwordx4 v9, s[16:19], s37 offen lds
    s_add_u32 m0, s36, 8192
    s_nop 0
    buffer_load_dwordx4 v10, s[12:15], s38 offen lds
    s_add_u32 m0, s36, 12288
    s_nop 0
    buffer_load_dwordx4 v11, s[12:15], s38 offen lds
    s_add_u32 s36, s35, 81920
    s_mov_b32 m0, s36
    s_mov_b32 s37, 640
    buffer_load_dwordx4 v8, s[16:19], s37 offen lds
    s_add_u32 m0, s36, 4096
    s_mov_b32 s38, 327680
    buffer_load_dwordx4 v9, s[16:19], s37 offen lds
    s_add_u32 m0, s36, 8192
    s_nop 0
    buffer_load_dwordx4 v10, s[12:15], s38 offen lds
    s_add_u32 m0, s36, 12288
    s_nop 0
    buffer_load_dwordx4 v11, s[12:15], s38 offen lds
    s_add_u32 s36, s35, 98304
    s_mov_b32 m0, s36
    s_mov_b32 s37, 768
    buffer_load_dwordx4 v8, s[16:19], s37 offen lds
    s_add_u32 m0, s36, 4096
    s_mov_b32 s38, 393216
    buffer_load_dwordx4 v9, s[16:19], s37 offen lds
    s_add_u32 m0, s36, 8192
    s_nop 0
    buffer_load_dwordx4 v10, s[12:15], s38 offen lds
    s_add_u32 m0, s36, 12288
    s_nop 0
    buffer_load_dwordx4 v11, s[12:15], s38 offen lds
    s_add_u32 s36, s35, 114688
    s_mov_b32 m0, s36
    s_mov_b32 s37, 896
    buffer_load_dwordx4 v8, s[16:19], s37 offen lds
    s_add_u32 m0, s36, 4096
    s_mov_b32 s38, 458752
    buffer_load_dwordx4 v9, s[16:19], s37 offen lds
    s_add_u32 m0, s36, 8192
    s_nop 0
    buffer_load_dwordx4 v10, s[12:15], s38 offen lds
    s_add_u32 m0, s36, 12288
    s_nop 0
    buffer_load_dwordx4 v11, s[12:15], s38 offen lds
    v_and_b32 v12, 63, v0
    v_and_b32 v13, 31, v12
    v_lshrrev_b32 v14, 5, v12
    s_lshl_b32 s33, s31, 5
    v_add_u32 v13, s33, v13
    v_bfe_u32 v15, v13, 1, 3
    v_lshlrev_b32 v13, 7, v13
    v_add_u32 v16, 0, v14
    v_xor_b32 v16, v16, v15
    v_lshl_add_u32 v20, v16, 4, v13
    v_add_u32 v16, 2, v14
    v_xor_b32 v16, v16, v15
    v_lshl_add_u32 v21, v16, 4, v13
    v_add_u32 v16, 4, v14
    v_xor_b32 v16, v16, v15
    v_lshl_add_u32 v22, v16, 4, v13
    v_add_u32 v16, 6, v14
    v_xor_b32 v16, v16, v15
    v_lshl_add_u32 v23, v16, 4, v13
    v_bfe_u32 v13, v12, 4, 1
    v_bfe_u32 v15, v12, 2, 2
    v_and_b32 v16, 3, v12
    v_lshl_add_u32 v17, v14, 3, v15
    v_lshlrev_b32 v17, 7, v17
    v_lshl_add_u32 v17, v13, 5, v17
    v_lshl_add_u32 v17, v16, 3, v17
    v_lshrrev_b32 v15, 1, v15
    v_xor_b32 v15, s32, v15
    v_lshl_add_u32 v24, v15, 6, v17
    v_add_u32 v24, 0x2000, v24
    v_add_u32 v26, 49152, v20
    v_add_u32 v32, 98304, v20
    v_add_u32 v27, 49152, v21
    v_add_u32 v33, 98304, v21
    v_add_u32 v28, 49152, v22
    v_add_u32 v34, 98304, v22
    v_add_u32 v29, 49152, v23
    v_add_u32 v35, 98304, v23
    v_add_u32 v30, 49152, v24
    v_add_u32 v36, 98304, v24
    v_mov_b32 v64, 0
    v_mov_b32 v65, 0
    v_mov_b32 v66, 0
    v_mov_b32 v67, 0
    v_mov_b32 v68, 0
    v_mov_b32 v69, 0
    v_mov_b32 v70, 0
    v_mov_b32 v71, 0
    v_mov_b32 v72, 0
    v_mov_b32 v73, 0
    v_mov_b32 v74, 0
    v_mov_b32 v75, 0
    v_mov_b32 v76, 0
    v_mov_b32 v77, 0
    v_mov_b32 v78, 0
    v_mov_b32 v79, 0
    s_waitcnt vmcnt(28)
    s_barrier
    s_add_u32 s36, s35, 131072
    s_mov_b32 m0, s36
    s_mov_b32 s37, 1024
    buffer_load_dwordx4 v8, s[16:19], s37 offen lds
    s_add_u32 m0, s36, 4096
    s_mov_b32 s38, 524288
    buffer_load_dwordx4 v9, s[16:19], s37 offen lds
    s_add_u32 m0, s36, 8192
    s_nop 0
    buffer_load_dwordx4 v10, s[12:15], s38 offen lds
    s_add_u32 m0, s36, 12288
    s_nop 0
    buffer_load_dwordx4 v11, s[12:15], s38 offen lds
    ds_read_b128 v[80:83], v20 offset:0
    ds_read_b64_tr_b16 v[96:97], v24 offset:0
    ds_read_b64_tr_b16 v[98:99], v24 offset:512
    ds_read_b128 v[84:87], v21 offset:0
    ds_read_b64_tr_b16 v[100:101], v24 offset:2048
    ds_read_b64_tr_b16 v[102:103], v24 offset:2560
    ds_read_b128 v[88:91], v22 offset:0
    ds_read_b64_tr_b16 v[104:105], v24 offset:4096
    ds_read_b64_tr_b16 v[106:107], v24 offset:4608
    ds_read_b128 v[92:95], v23 offset:0
    ds_read_b64_tr_b16 v[108:109], v24 offset:6144
    ds_read_b64_tr_b16 v[110:111], v24 offset:6656
    s_waitcnt lgkmcnt(9)
    v_mfma_f32_32x32x16_bf16 v[64:79], v[80:83], v[96:99], v[64:79]
    s_waitcnt lgkmcnt(6)
    v_mfma_f32_32x32x16_bf16 v[64:79], v[84:87], v[100:103], v[64:79]
    s_waitcnt lgkmcnt(3)
    v_mfma_f32_32x32x16_bf16 v[64:79], v[88:91], v[104:107], v[64:79]
    s_waitcnt lgkmcnt(0)
    v_mfma_f32_32x32x16_bf16 v[64:79], v[92:95], v[108:111], v[64:79]
    s_waitcnt vmcnt(28)
    s_barrier
    s_add_u32 s36, s35, 0
    s_mov_b32 m0, s36
    s_mov_b32 s37, 1152
    buffer_load_dwordx4 v8, s[16:19], s37 offen lds
    s_add_u32 m0, s36, 4096
    s_mov_b32 s38, 589824
    buffer_load_dwordx4 v9, s[16:19], s37 offen lds
    s_add_u32 m0, s36, 8192
    s_nop 0
    buffer_load_dwordx4 v10, s[12:15], s38 offen lds
    s_add_u32 m0, s36, 12288
    s_nop 0
    buffer_load_dwordx4 v11, s[12:15], s38 offen lds
    ds_read_b128 v[80:83], v20 offset:16384
    ds_read_b64_tr_b16 v[96:97], v24 offset:16384
    ds_read_b64_tr_b16 v[98:99], v24 offset:16896
    ds_read_b128 v[84:87], v21 offset:16384
    ds_read_b64_tr_b16 v[100:101], v24 offset:18432
    ds_read_b64_tr_b16 v[102:103], v24 offset:18944
    ds_read_b128 v[88:91], v22 offset:16384
    ds_read_b64_tr_b16 v[104:105], v24 offset:20480
    ds_read_b64_tr_b16 v[106:107], v24 offset:20992
    ds_read_b128 v[92:95], v23 offset:16384
    ds_read_b64_tr_b16 v[108:109], v24 offset:22528
    ds_read_b64_tr_b16 v[110:111], v24 offset:23040
    s_waitcnt lgkmcnt(9)
    v_mfma_f32_32x32x16_bf16 v[64:79], v[80:83], v[96:99], v[64:79]
    s_waitcnt lgkmcnt(6)
    v_mfma_f32_32x32x16_bf16 v[64:79], v[84:87], v[100:103], v[64:79]
    s_waitcnt lgkmcnt(3)
    v_mfma_f32_32x32x16_bf16 v[64:79], v[88:91], v[104:107], v[64:79]
    s_waitcnt lgkmcnt(0)
    v_mfma_f32_32x32x16_bf16 v[64:79], v[92:95], v[108:111], v[64:79]
    s_waitcnt vmcnt(28)
    s_barrier
    s_add_u32 s36, s35, 16384
    s_mov_b32 m0, s36
    s_mov_b32 s37, 1280
    buffer_load_dwordx4 v8, s[16:19], s37 offen lds
    s_add_u32 m0, s36, 4096
    s_mov_b32 s38, 655360
    buffer_load_dwordx4 v9, s[16:19], s37 offen lds
    s_add_u32 m0, s36, 8192
    s_nop 0
    buffer_load_dwordx4 v10, s[12:15], s38 offen lds
    s_add_u32 m0, s36, 12288
    s_nop 0
    buffer_load_dwordx4 v11, s[12:15], s38 offen lds
    ds_read_b128 v[80:83], v20 offset:32768
    ds_read_b64_tr_b16 v[96:97], v24 offset:32768
    ds_read_b64_tr_b16 v[98:99], v24 offset:33280
    ds_read_b128 v[84:87], v21 offset:32768
    ds_read_b64_tr_b16 v[100:101], v24 offset:34816
    ds_read_b64_tr_b16 v[102:103], v24 offset:35328
    ds_read_b128 v[88:91], v22 offset:32768
    ds_read_b64_tr_b16 v[104:105], v24 offset:36864
    ds_read_b64_tr_b16 v[106:107], v24 offset:37376
    ds_read_b128 v[92:95], v23 offset:32768
    ds_read_b64_tr_b16 v[108:109], v24 offset:38912
    ds_read_b64_tr_b16 v[110:111], v24 offset:39424
    s_waitcnt lgkmcnt(9)
    v_mfma_f32_32x32x16_bf16 v[64:79], v[80:83], v[96:99], v[64:79]
    s_waitcnt lgkmcnt(6)
    v_mfma_f32_32x32x16_bf16 v[64:79], v[84:87], v[100:103], v[64:79]
    s_waitcnt lgkmcnt(3)
    v_mfma_f32_32x32x16_bf16 v[64:79], v[88:91], v[104:107], v[64:79]
    s_waitcnt lgkmcnt(0)
    v_mfma_f32_32x32x16_bf16 v[64:79], v[92:95], v[108:111], v[64:79]
    s_waitcnt vmcnt(28)
    s_barrier
    s_add_u32 s36, s35, 32768
    s_mov_b32 m0, s36
    s_mov_b32 s37, 1408
    buffer_load_dwordx4 v8, s[16:19], s37 offen lds
    s_add_u32 m0, s36, 4096
    s_mov_b32 s38, 720896
    buffer_load_dwordx4 v9, s[16:19], s37 offen lds
    s_add_u32 m0, s36, 8192
    s_nop 0
    buffer_load_dwordx4 v10, s[12:15], s38 offen lds
    s_add_u32 m0, s36, 12288
    s_nop 0
    buffer_load_dwordx4 v11, s[12:15], s38 offen lds
    ds_read_b128 v[80:83], v26 offset:0
    ds_read_b64_tr_b16 v[96:97], v30 offset:0
    ds_read_b64_tr_b16 v[98:99], v30 offset:512
    ds_read_b128 v[84:87], v27 offset:0
    ds_read_b64_tr_b16 v[100:101], v30 offset:2048
    ds_read_b64_tr_b16 v[102:103], v30 offset:2560
    ds_read_b128 v[88:91], v28 offset:0
    ds_read_b64_tr_b16 v[104:105], v30 offset:4096
    ds_read_b64_tr_b16 v[106:107], v30 offset:4608
    ds_read_b128 v[92:95], v29 offset:0
    ds_read_b64_tr_b16 v[108:109], v30 offset:6144
    ds_read_b64_tr_b16 v[110:111], v30 offset:6656
    s_waitcnt lgkmcnt(9)
    v_mfma_f32_32x32x16_bf16 v[64:79], v[80:83], v[96:99], v[64:79]
    s_waitcnt lgkmcnt(6)
    v_mfma_f32_32x32x16_bf16 v[64:79], v[84:87], v[100:103], v[64:79]
    s_waitcnt lgkmcnt(3)
    v_mfma_f32_32x32x16_bf16 v[64:79], v[88:91], v[104:107], v[64:79]
    s_waitcnt lgkmcnt(0)
    v_mfma_f32_32x32x16_bf16 v[64:79], v[92:95], v[108:111], v[64:79]
    s_waitcnt vmcnt(28)
    s_barrier
    s_add_u32 s36, s35, 49152
    s_mov_b32 m0, s36
    s_mov_b32 s37, 1536
    buffer_load_dwordx4 v8, s[16:19], s37 offen lds
    s_add_u32 m0, s36, 4096
    s_mov_b32 s38, 786432
    buffer_load_dwordx4 v9, s[16:19], s37 offen lds
    s_add_u32 m0, s36, 8192
    s_nop 0
    buffer_load_dwordx4 v10, s[12:15], s38 offen lds
    s_add_u32 m0, s36, 12288
    s_nop 0
    buffer_load_dwordx4 v11, s[12:15], s38 offen lds
    ds_read_b128 v[80:83], v26 offset:16384
    ds_read_b64_tr_b16 v[96:97], v30 offset:16384
    ds_read_b64_tr_b16 v[98:99], v30 offset:16896
    ds_read_b128 v[84:87], v27 offset:16384
    ds_read_b64_tr_b16 v[100:101], v30 offset:18432
    ds_read_b64_tr_b16 v[102:103], v30 offset:18944
    ds_read_b128 v[88:91], v28 offset:16384
    ds_read_b64_tr_b16 v[104:105], v30 offset:20480
    ds_read_b64_tr_b16 v[106:107], v30 offset:20992
    ds_read_b128 v[92:95], v29 offset:16384
    ds_read_b64_tr_b16 v[108:109], v30 offset:22528
    ds_read_b64_tr_b16 v[110:111], v30 offset:23040
    s_waitcnt lgkmcnt(9)
    v_mfma_f32_32x32x16_bf16 v[64:79], v[80:83], v[96:99], v[64:79]
    s_waitcnt lgkmcnt(6)
    v_mfma_f32_32x32x16_bf16 v[64:79], v[84:87], v[100:103], v[64:79]
    s_waitcnt lgkmcnt(3)
    v_mfma_f32_32x32x16_bf16 v[64:79], v[88:91], v[104:107], v[64:79]
    s_waitcnt lgkmcnt(0)
    v_mfma_f32_32x32x16_bf16 v[64:79], v[92:95], v[108:111], v[64:79]
    s_waitcnt vmcnt(28)
    s_barrier
    s_add_u32 s36, s35, 65536
    s_mov_b32 m0, s36
    s_mov_b32 s37, 1664
    buffer_load_dwordx4 v8, s[16:19], s37 offen lds
    s_add_u32 m0, s36, 4096
    s_mov_b32 s38, 851968
    buffer_load_dwordx4 v9, s[16:19], s37 offen lds
    s_add_u32 m0, s36, 8192
    s_nop 0
    buffer_load_dwordx4 v10, s[12:15], s38 offen lds
    s_add_u32 m0, s36, 12288
    s_nop 0
    buffer_load_dwordx4 v11, s[12:15], s38 offen lds
    ds_read_b128 v[80:83], v26 offset:32768
    ds_read_b64_tr_b16 v[96:97], v30 offset:32768
    ds_read_b64_tr_b16 v[98:99], v30 offset:33280
    ds_read_b128 v[84:87], v27 offset:32768
    ds_read_b64_tr_b16 v[100:101], v30 offset:34816
    ds_read_b64_tr_b16 v[102:103], v30 offset:35328
    ds_read_b128 v[88:91], v28 offset:32768
    ds_read_b64_tr_b16 v[104:105], v30 offset:36864
    ds_read_b64_tr_b16 v[106:107], v30 offset:37376
    ds_read_b128 v[92:95], v29 offset:32768
    ds_read_b64_tr_b16 v[108:109], v30 offset:38912
    ds_read_b64_tr_b16 v[110:111], v30 offset:39424
    s_waitcnt lgkmcnt(9)
    v_mfma_f32_32x32x16_bf16 v[64:79], v[80:83], v[96:99], v[64:79]
    s_waitcnt lgkmcnt(6)
    v_mfma_f32_32x32x16_bf16 v[64:79], v[84:87], v[100:103], v[64:79]
    s_waitcnt lgkmcnt(3)
    v_mfma_f32_32x32x16_bf16 v[64:79], v[88:91], v[104:107], v[64:79]
    s_waitcnt lgkmcnt(0)
    v_mfma_f32_32x32x16_bf16 v[64:79], v[92:95], v[108:111], v[64:79]
    s_waitcnt vmcnt(28)
    s_barrier
    s_add_u32 s36, s35, 81920
    s_mov_b32 m0, s36
    s_mov_b32 s37, 1792
    buffer_load_dwordx4 v8, s[16:19], s37 offen lds
    s_add_u32 m0, s36, 4096
    s_mov_b32 s38, 917504
    buffer_load_dwordx4 v9, s[16:19], s37 offen lds
    s_add_u32 m0, s36, 8192
    s_nop 0
    buffer_load_dwordx4 v10, s[12:15], s38 offen lds
    s_add_u32 m0, s36, 12288
    s_nop 0
    buffer_load_dwordx4 v11, s[12:15], s38 offen lds
    ds_read_b128 v[80:83], v32 offset:0
    ds_read_b64_tr_b16 v[96:97], v36 offset:0
    ds_read_b64_tr_b16 v[98:99], v36 offset:512
    ds_read_b128 v[84:87], v33 offset:0
    ds_read_b64_tr_b16 v[100:101], v36 offset:2048
    ds_read_b64_tr_b16 v[102:103], v36 offset:2560
    ds_read_b128 v[88:91], v34 offset:0
    ds_read_b64_tr_b16 v[104:105], v36 offset:4096
    ds_read_b64_tr_b16 v[106:107], v36 offset:4608
    ds_read_b128 v[92:95], v35 offset:0
    ds_read_b64_tr_b16 v[108:109], v36 offset:6144
    ds_read_b64_tr_b16 v[110:111], v36 offset:6656
    s_waitcnt lgkmcnt(9)
    v_mfma_f32_32x32x16_bf16 v[64:79], v[80:83], v[96:99], v[64:79]
    s_waitcnt lgkmcnt(6)
    v_mfma_f32_32x32x16_bf16 v[64:79], v[84:87], v[100:103], v[64:79]
    s_waitcnt lgkmcnt(3)
    v_mfma_f32_32x32x16_bf16 v[64:79], v[88:91], v[104:107], v[64:79]
    s_waitcnt lgkmcnt(0)
    v_mfma_f32_32x32x16_bf16 v[64:79], v[92:95], v[108:111], v[64:79]
    s_waitcnt vmcnt(28)
    s_barrier
    s_add_u32 s36, s35, 98304
    s_mov_b32 m0, s36
    s_mov_b32 s37, 1920
    buffer_load_dwordx4 v8, s[16:19], s37 offen lds
    s_add_u32 m0, s36, 4096
    s_mov_b32 s38, 983040
    buffer_load_dwordx4 v9, s[16:19], s37 offen lds
    s_add_u32 m0, s36, 8192
    s_nop 0
    buffer_load_dwordx4 v10, s[12:15], s38 offen lds
    s_add_u32 m0, s36, 12288
    s_nop 0
    buffer_load_dwordx4 v11, s[12:15], s38 offen lds
    ds_read_b128 v[80:83], v32 offset:16384
    ds_read_b64_tr_b16 v[96:97], v36 offset:16384
    ds_read_b64_tr_b16 v[98:99], v36 offset:16896
    ds_read_b128 v[84:87], v33 offset:16384
    ds_read_b64_tr_b16 v[100:101], v36 offset:18432
    ds_read_b64_tr_b16 v[102:103], v36 offset:18944
    ds_read_b128 v[88:91], v34 offset:16384
    ds_read_b64_tr_b16 v[104:105], v36 offset:20480
    ds_read_b64_tr_b16 v[106:107], v36 offset:20992
    ds_read_b128 v[92:95], v35 offset:16384
    ds_read_b64_tr_b16 v[108:109], v36 offset:22528
    ds_read_b64_tr_b16 v[110:111], v36 offset:23040
    s_waitcnt lgkmcnt(9)
    v_mfma_f32_32x32x16_bf16 v[64:79], v[80:83], v[96:99], v[64:79]
    s_waitcnt lgkmcnt(6)
    v_mfma_f32_32x32x16_bf16 v[64:79], v[84:87], v[100:103], v[64:79]
    s_waitcnt lgkmcnt(3)
    v_mfma_f32_32x32x16_bf16 v[64:79], v[88:91], v[104:107], v[64:79]
    s_waitcnt lgkmcnt(0)
    v_mfma_f32_32x32x16_bf16 v[64:79], v[92:95], v[108:111], v[64:79]
    s_waitcnt vmcnt(28)
    s_barrier
    s_add_u32 s36, s35, 114688
    s_mov_b32 m0, s36
    s_mov_b32 s37, 2048
    buffer_load_dwordx4 v8, s[16:19], s37 offen lds
    s_add_u32 m0, s36, 4096
    s_mov_b32 s38, 1048576
    buffer_load_dwordx4 v9, s[16:19], s37 offen lds
    s_add_u32 m0, s36, 8192
    s_nop 0
    buffer_load_dwordx4 v10, s[12:15], s38 offen lds
    s_add_u32 m0, s36, 12288
    s_nop 0
    buffer_load_dwordx4 v11, s[12:15], s38 offen lds
    ds_read_b128 v[80:83], v32 offset:32768
    ds_read_b64_tr_b16 v[96:97], v36 offset:32768
    ds_read_b64_tr_b16 v[98:99], v36 offset:33280
    ds_read_b128 v[84:87], v33 offset:32768
    ds_read_b64_tr_b16 v[100:101], v36 offset:34816
    ds_read_b64_tr_b16 v[102:103], v36 offset:35328
    ds_read_b128 v[88:91], v34 offset:32768
    ds_read_b64_tr_b16 v[104:105], v36 offset:36864
    ds_read_b64_tr_b16 v[106:107], v36 offset:37376
    ds_read_b128 v[92:95], v35 offset:32768
    ds_read_b64_tr_b16 v[108:109], v36 offset:38912
    ds_read_b64_tr_b16 v[110:111], v36 offset:39424
    s_waitcnt lgkmcnt(9)
    v_mfma_f32_32x32x16_bf16 v[64:79], v[80:83], v[96:99], v[64:79]
    s_waitcnt lgkmcnt(6)
    v_mfma_f32_32x32x16_bf16 v[64:79], v[84:87], v[100:103], v[64:79]
    s_waitcnt lgkmcnt(3)
    v_mfma_f32_32x32x16_bf16 v[64:79], v[88:91], v[104:107], v[64:79]
    s_waitcnt lgkmcnt(0)
    v_mfma_f32_32x32x16_bf16 v[64:79], v[92:95], v[108:111], v[64:79]
    s_waitcnt vmcnt(28)
    s_barrier
    s_add_u32 s36, s35, 131072
    s_mov_b32 m0, s36
    s_mov_b32 s37, 2176
    buffer_load_dwordx4 v8, s[16:19], s37 offen lds
    s_add_u32 m0, s36, 4096
    s_mov_b32 s38, 1114112
    buffer_load_dwordx4 v9, s[16:19], s37 offen lds
    s_add_u32 m0, s36, 8192
    s_nop 0
    buffer_load_dwordx4 v10, s[12:15], s38 offen lds
    s_add_u32 m0, s36, 12288
    s_nop 0
    buffer_load_dwordx4 v11, s[12:15], s38 offen lds
    ds_read_b128 v[80:83], v20 offset:0
    ds_read_b64_tr_b16 v[96:97], v24 offset:0
    ds_read_b64_tr_b16 v[98:99], v24 offset:512
    ds_read_b128 v[84:87], v21 offset:0
    ds_read_b64_tr_b16 v[100:101], v24 offset:2048
    ds_read_b64_tr_b16 v[102:103], v24 offset:2560
    ds_read_b128 v[88:91], v22 offset:0
    ds_read_b64_tr_b16 v[104:105], v24 offset:4096
    ds_read_b64_tr_b16 v[106:107], v24 offset:4608
    ds_read_b128 v[92:95], v23 offset:0
    ds_read_b64_tr_b16 v[108:109], v24 offset:6144
    ds_read_b64_tr_b16 v[110:111], v24 offset:6656
    s_waitcnt lgkmcnt(9)
    v_mfma_f32_32x32x16_bf16 v[64:79], v[80:83], v[96:99], v[64:79]
    s_waitcnt lgkmcnt(6)
    v_mfma_f32_32x32x16_bf16 v[64:79], v[84:87], v[100:103], v[64:79]
    s_waitcnt lgkmcnt(3)
    v_mfma_f32_32x32x16_bf16 v[64:79], v[88:91], v[104:107], v[64:79]
    s_waitcnt lgkmcnt(0)
    v_mfma_f32_32x32x16_bf16 v[64:79], v[92:95], v[108:111], v[64:79]
    s_waitcnt vmcnt(28)
    s_barrier
    s_add_u32 s36, s35, 0
    s_mov_b32 m0, s36
    s_mov_b32 s37, 2304
    buffer_load_dwordx4 v8, s[16:19], s37 offen lds
    s_add_u32 m0, s36, 4096
    s_mov_b32 s38, 1179648
    buffer_load_dwordx4 v9, s[16:19], s37 offen lds
    s_add_u32 m0, s36, 8192
    s_nop 0
    buffer_load_dwordx4 v10, s[12:15], s38 offen lds
    s_add_u32 m0, s36, 12288
    s_nop 0
    buffer_load_dwordx4 v11, s[12:15], s38 offen lds
    ds_read_b128 v[80:83], v20 offset:16384
    ds_read_b64_tr_b16 v[96:97], v24 offset:16384
    ds_read_b64_tr_b16 v[98:99], v24 offset:16896
    ds_read_b128 v[84:87], v21 offset:16384
    ds_read_b64_tr_b16 v[100:101], v24 offset:18432
    ds_read_b64_tr_b16 v[102:103], v24 offset:18944
    ds_read_b128 v[88:91], v22 offset:16384
    ds_read_b64_tr_b16 v[104:105], v24 offset:20480
    ds_read_b64_tr_b16 v[106:107], v24 offset:20992
    ds_read_b128 v[92:95], v23 offset:16384
    ds_read_b64_tr_b16 v[108:109], v24 offset:22528
    ds_read_b64_tr_b16 v[110:111], v24 offset:23040
    s_waitcnt lgkmcnt(9)
    v_mfma_f32_32x32x16_bf16 v[64:79], v[80:83], v[96:99], v[64:79]
    s_waitcnt lgkmcnt(6)
    v_mfma_f32_32x32x16_bf16 v[64:79], v[84:87], v[100:103], v[64:79]
    s_waitcnt lgkmcnt(3)
    v_mfma_f32_32x32x16_bf16 v[64:79], v[88:91], v[104:107], v[64:79]
    s_waitcnt lgkmcnt(0)
    v_mfma_f32_32x32x16_bf16 v[64:79], v[92:95], v[108:111], v[64:79]
    s_waitcnt vmcnt(28)
    s_barrier
    s_add_u32 s36, s35, 16384
    s_mov_b32 m0, s36
    s_mov_b32 s37, 2432
    buffer_load_dwordx4 v8, s[16:19], s37 offen lds
    s_add_u32 m0, s36, 4096
    s_mov_b32 s38, 1245184
    buffer_load_dwordx4 v9, s[16:19], s37 offen lds
    s_add_u32 m0, s36, 8192
    s_nop 0
    buffer_load_dwordx4 v10, s[12:15], s38 offen lds
    s_add_u32 m0, s36, 12288
    s_nop 0
    buffer_load_dwordx4 v11, s[12:15], s38 offen lds
    ds_read_b128 v[80:83], v20 offset:32768
    ds_read_b64_tr_b16 v[96:97], v24 offset:32768
    ds_read_b64_tr_b16 v[98:99], v24 offset:33280
    ds_read_b128 v[84:87], v21 offset:32768
    ds_read_b64_tr_b16 v[100:101], v24 offset:34816
    ds_read_b64_tr_b16 v[102:103], v24 offset:35328
    ds_read_b128 v[88:91], v22 offset:32768
    ds_read_b64_tr_b16 v[104:105], v24 offset:36864
    ds_read_b64_tr_b16 v[106:107], v24 offset:37376
    ds_read_b128 v[92:95], v23 offset:32768
    ds_read_b64_tr_b16 v[108:109], v24 offset:38912
    ds_read_b64_tr_b16 v[110:111], v24 offset:39424
    s_waitcnt lgkmcnt(9)
    v_mfma_f32_32x32x16_bf16 v[64:79], v[80:83], v[96:99], v[64:79]
    s_waitcnt lgkmcnt(6)
    v_mfma_f32_32x32x16_bf16 v[64:79], v[84:87], v[100:103], v[64:79]
    s_waitcnt lgkmcnt(3)
    v_mfma_f32_32x32x16_bf16 v[64:79], v[88:91], v[104:107], v[64:79]
    s_waitcnt lgkmcnt(0)
    v_mfma_f32_32x32x16_bf16 v[64:79], v[92:95], v[108:111], v[64:79]
    s_waitcnt vmcnt(28)
    s_barrier
    s_add_u32 s36, s35, 32768
    s_mov_b32 m0, s36
    s_mov_b32 s37, 2560
    buffer_load_dwordx4 v8, s[16:19], s37 offen lds
    s_add_u32 m0, s36, 4096
    s_mov_b32 s38, 1310720
    buffer_load_dwordx4 v9, s[16:19], s37 offen lds
    s_add_u32 m0, s36, 8192
    s_nop 0
    buffer_load_dwordx4 v10, s[12:15], s38 offen lds
    s_add_u32 m0, s36, 12288
    s_nop 0
    buffer_load_dwordx4 v11, s[12:15], s38 offen lds
    ds_read_b128 v[80:83], v26 offset:0
    ds_read_b64_tr_b16 v[96:97], v30 offset:0
    ds_read_b64_tr_b16 v[98:99], v30 offset:512
    ds_read_b128 v[84:87], v27 offset:0
    ds_read_b64_tr_b16 v[100:101], v30 offset:2048
    ds_read_b64_tr_b16 v[102:103], v30 offset:2560
    ds_read_b128 v[88:91], v28 offset:0
    ds_read_b64_tr_b16 v[104:105], v30 offset:4096
    ds_read_b64_tr_b16 v[106:107], v30 offset:4608
    ds_read_b128 v[92:95], v29 offset:0
    ds_read_b64_tr_b16 v[108:109], v30 offset:6144
    ds_read_b64_tr_b16 v[110:111], v30 offset:6656
    s_waitcnt lgkmcnt(9)
    v_mfma_f32_32x32x16_bf16 v[64:79], v[80:83], v[96:99], v[64:79]
    s_waitcnt lgkmcnt(6)
    v_mfma_f32_32x32x16_bf16 v[64:79], v[84:87], v[100:103], v[64:79]
    s_waitcnt lgkmcnt(3)
    v_mfma_f32_32x32x16_bf16 v[64:79], v[88:91], v[104:107], v[64:79]
    s_waitcnt lgkmcnt(0)
    v_mfma_f32_32x32x16_bf16 v[64:79], v[92:95], v[108:111], v[64:79]
    s_waitcnt vmcnt(28)
    s_barrier
    s_add_u32 s36, s35, 49152
    s_mov_b32 m0, s36
    s_mov_b32 s37, 2688
    buffer_load_dwordx4 v8, s[16:19], s37 offen lds
    s_add_u32 m0, s36, 4096
    s_mov_b32 s38, 1376256
    buffer_load_dwordx4 v9, s[16:19], s37 offen lds
    s_add_u32 m0, s36, 8192
    s_nop 0
    buffer_load_dwordx4 v10, s[12:15], s38 offen lds
    s_add_u32 m0, s36, 12288
    s_nop 0
    buffer_load_dwordx4 v11, s[12:15], s38 offen lds
    ds_read_b128 v[80:83], v26 offset:16384
    ds_read_b64_tr_b16 v[96:97], v30 offset:16384
    ds_read_b64_tr_b16 v[98:99], v30 offset:16896
    ds_read_b128 v[84:87], v27 offset:16384
    ds_read_b64_tr_b16 v[100:101], v30 offset:18432
    ds_read_b64_tr_b16 v[102:103], v30 offset:18944
    ds_read_b128 v[88:91], v28 offset:16384
    ds_read_b64_tr_b16 v[104:105], v30 offset:20480
    ds_read_b64_tr_b16 v[106:107], v30 offset:20992
    ds_read_b128 v[92:95], v29 offset:16384
    ds_read_b64_tr_b16 v[108:109], v30 offset:22528
    ds_read_b64_tr_b16 v[110:111], v30 offset:23040
    s_waitcnt lgkmcnt(9)
    v_mfma_f32_32x32x16_bf16 v[64:79], v[80:83], v[96:99], v[64:79]
    s_waitcnt lgkmcnt(6)
    v_mfma_f32_32x32x16_bf16 v[64:79], v[84:87], v[100:103], v[64:79]
    s_waitcnt lgkmcnt(3)
    v_mfma_f32_32x32x16_bf16 v[64:79], v[88:91], v[104:107], v[64:79]
    s_waitcnt lgkmcnt(0)
    v_mfma_f32_32x32x16_bf16 v[64:79], v[92:95], v[108:111], v[64:79]
    s_waitcnt vmcnt(28)
    s_barrier
    ds_read_b128 v[80:83], v26 offset:32768
    ds_read_b64_tr_b16 v[96:97], v30 offset:32768
    ds_read_b64_tr_b16 v[98:99], v30 offset:33280
    ds_read_b128 v[84:87], v27 offset:32768
    ds_read_b64_tr_b16 v[100:101], v30 offset:34816
    ds_read_b64_tr_b16 v[102:103], v30 offset:35328
    ds_read_b128 v[88:91], v28 offset:32768
    ds_read_b64_tr_b16 v[104:105], v30 offset:36864
    ds_read_b64_tr_b16 v[106:107], v30 offset:37376
    ds_read_b128 v[92:95], v29 offset:32768
    ds_read_b64_tr_b16 v[108:109], v30 offset:38912
    ds_read_b64_tr_b16 v[110:111], v30 offset:39424
    s_waitcnt lgkmcnt(9)
    v_mfma_f32_32x32x16_bf16 v[64:79], v[80:83], v[96:99], v[64:79]
    s_waitcnt lgkmcnt(6)
    v_mfma_f32_32x32x16_bf16 v[64:79], v[84:87], v[100:103], v[64:79]
    s_waitcnt lgkmcnt(3)
    v_mfma_f32_32x32x16_bf16 v[64:79], v[88:91], v[104:107], v[64:79]
    s_waitcnt lgkmcnt(0)
    v_mfma_f32_32x32x16_bf16 v[64:79], v[92:95], v[108:111], v[64:79]
    s_waitcnt vmcnt(24)
    s_barrier
    ds_read_b128 v[80:83], v32 offset:0
    ds_read_b64_tr_b16 v[96:97], v36 offset:0
    ds_read_b64_tr_b16 v[98:99], v36 offset:512
    ds_read_b128 v[84:87], v33 offset:0
    ds_read_b64_tr_b16 v[100:101], v36 offset:2048
    ds_read_b64_tr_b16 v[102:103], v36 offset:2560
    ds_read_b128 v[88:91], v34 offset:0
    ds_read_b64_tr_b16 v[104:105], v36 offset:4096
    ds_read_b64_tr_b16 v[106:107], v36 offset:4608
    ds_read_b128 v[92:95], v35 offset:0
    ds_read_b64_tr_b16 v[108:109], v36 offset:6144
    ds_read_b64_tr_b16 v[110:111], v36 offset:6656
    s_waitcnt lgkmcnt(9)
    v_mfma_f32_32x32x16_bf16 v[64:79], v[80:83], v[96:99], v[64:79]
    s_waitcnt lgkmcnt(6)
    v_mfma_f32_32x32x16_bf16 v[64:79], v[84:87], v[100:103], v[64:79]
    s_waitcnt lgkmcnt(3)
    v_mfma_f32_32x32x16_bf16 v[64:79], v[88:91], v[104:107], v[64:79]
    s_waitcnt lgkmcnt(0)
    v_mfma_f32_32x32x16_bf16 v[64:79], v[92:95], v[108:111], v[64:79]
    s_waitcnt vmcnt(20)
    s_barrier
    ds_read_b128 v[80:83], v32 offset:16384
    ds_read_b64_tr_b16 v[96:97], v36 offset:16384
    ds_read_b64_tr_b16 v[98:99], v36 offset:16896
    ds_read_b128 v[84:87], v33 offset:16384
    ds_read_b64_tr_b16 v[100:101], v36 offset:18432
    ds_read_b64_tr_b16 v[102:103], v36 offset:18944
    ds_read_b128 v[88:91], v34 offset:16384
    ds_read_b64_tr_b16 v[104:105], v36 offset:20480
    ds_read_b64_tr_b16 v[106:107], v36 offset:20992
    ds_read_b128 v[92:95], v35 offset:16384
    ds_read_b64_tr_b16 v[108:109], v36 offset:22528
    ds_read_b64_tr_b16 v[110:111], v36 offset:23040
    s_waitcnt lgkmcnt(9)
    v_mfma_f32_32x32x16_bf16 v[64:79], v[80:83], v[96:99], v[64:79]
    s_waitcnt lgkmcnt(6)
    v_mfma_f32_32x32x16_bf16 v[64:79], v[84:87], v[100:103], v[64:79]
    s_waitcnt lgkmcnt(3)
    v_mfma_f32_32x32x16_bf16 v[64:79], v[88:91], v[104:107], v[64:79]
    s_waitcnt lgkmcnt(0)
    v_mfma_f32_32x32x16_bf16 v[64:79], v[92:95], v[108:111], v[64:79]
    s_waitcnt vmcnt(16)
    s_barrier
    ds_read_b128 v[80:83], v32 offset:32768
    ds_read_b64_tr_b16 v[96:97], v36 offset:32768
    ds_read_b64_tr_b16 v[98:99], v36 offset:33280
    ds_read_b128 v[84:87], v33 offset:32768
    ds_read_b64_tr_b16 v[100:101], v36 offset:34816
    ds_read_b64_tr_b16 v[102:103], v36 offset:35328
    ds_read_b128 v[88:91], v34 offset:32768
    ds_read_b64_tr_b16 v[104:105], v36 offset:36864
    ds_read_b64_tr_b16 v[106:107], v36 offset:37376
    ds_read_b128 v[92:95], v35 offset:32768
    ds_read_b64_tr_b16 v[108:109], v36 offset:38912
    ds_read_b64_tr_b16 v[110:111], v36 offset:39424
    s_waitcnt lgkmcnt(9)
    v_mfma_f32_32x32x16_bf16 v[64:79], v[80:83], v[96:99], v[64:79]
    s_waitcnt lgkmcnt(6)
    v_mfma_f32_32x32x16_bf16 v[64:79], v[84:87], v[100:103], v[64:79]
    s_waitcnt lgkmcnt(3)
    v_mfma_f32_32x32x16_bf16 v[64:79], v[88:91], v[104:107], v[64:79]
    s_waitcnt lgkmcnt(0)
    v_mfma_f32_32x32x16_bf16 v[64:79], v[92:95], v[108:111], v[64:79]
    s_waitcnt vmcnt(12)
    s_barrier
    ds_read_b128 v[80:83], v20 offset:0
    ds_read_b64_tr_b16 v[96:97], v24 offset:0
    ds_read_b64_tr_b16 v[98:99], v24 offset:512
    ds_read_b128 v[84:87], v21 offset:0
    ds_read_b64_tr_b16 v[100:101], v24 offset:2048
    ds_read_b64_tr_b16 v[102:103], v24 offset:2560
    ds_read_b128 v[88:91], v22 offset:0
    ds_read_b64_tr_b16 v[104:105], v24 offset:4096
    ds_read_b64_tr_b16 v[106:107], v24 offset:4608
    ds_read_b128 v[92:95], v23 offset:0
    ds_read_b64_tr_b16 v[108:109], v24 offset:6144
    ds_read_b64_tr_b16 v[110:111], v24 offset:6656
    s_waitcnt lgkmcnt(9)
    v_mfma_f32_32x32x16_bf16 v[64:79], v[80:83], v[96:99], v[64:79]
    s_waitcnt lgkmcnt(6)
    v_mfma_f32_32x32x16_bf16 v[64:79], v[84:87], v[100:103], v[64:79]
    s_waitcnt lgkmcnt(3)
    v_mfma_f32_32x32x16_bf16 v[64:79], v[88:91], v[104:107], v[64:79]
    s_waitcnt lgkmcnt(0)
    v_mfma_f32_32x32x16_bf16 v[64:79], v[92:95], v[108:111], v[64:79]
    s_waitcnt vmcnt(8)
    s_barrier
    ds_read_b128 v[80:83], v20 offset:16384
    ds_read_b64_tr_b16 v[96:97], v24 offset:16384
    ds_read_b64_tr_b16 v[98:99], v24 offset:16896
    ds_read_b128 v[84:87], v21 offset:16384
    ds_read_b64_tr_b16 v[100:101], v24 offset:18432
    ds_read_b64_tr_b16 v[102:103], v24 offset:18944
    ds_read_b128 v[88:91], v22 offset:16384
    ds_read_b64_tr_b16 v[104:105], v24 offset:20480
    ds_read_b64_tr_b16 v[106:107], v24 offset:20992
    ds_read_b128 v[92:95], v23 offset:16384
    ds_read_b64_tr_b16 v[108:109], v24 offset:22528
    ds_read_b64_tr_b16 v[110:111], v24 offset:23040
    s_waitcnt lgkmcnt(9)
    v_mfma_f32_32x32x16_bf16 v[64:79], v[80:83], v[96:99], v[64:79]
    s_waitcnt lgkmcnt(6)
    v_mfma_f32_32x32x16_bf16 v[64:79], v[84:87], v[100:103], v[64:79]
    s_waitcnt lgkmcnt(3)
    v_mfma_f32_32x32x16_bf16 v[64:79], v[88:91], v[104:107], v[64:79]
    s_waitcnt lgkmcnt(0)
    v_mfma_f32_32x32x16_bf16 v[64:79], v[92:95], v[108:111], v[64:79]
    s_waitcnt vmcnt(4)
    s_barrier
    ds_read_b128 v[80:83], v20 offset:32768
    ds_read_b64_tr_b16 v[96:97], v24 offset:32768
    ds_read_b64_tr_b16 v[98:99], v24 offset:33280
    ds_read_b128 v[84:87], v21 offset:32768
    ds_read_b64_tr_b16 v[100:101], v24 offset:34816
    ds_read_b64_tr_b16 v[102:103], v24 offset:35328
    ds_read_b128 v[88:91], v22 offset:32768
    ds_read_b64_tr_b16 v[104:105], v24 offset:36864
    ds_read_b64_tr_b16 v[106:107], v24 offset:37376
    ds_read_b128 v[92:95], v23 offset:32768
    ds_read_b64_tr_b16 v[108:109], v24 offset:38912
    ds_read_b64_tr_b16 v[110:111], v24 offset:39424
    s_waitcnt lgkmcnt(9)
    v_mfma_f32_32x32x16_bf16 v[64:79], v[80:83], v[96:99], v[64:79]
    s_waitcnt lgkmcnt(6)
    v_mfma_f32_32x32x16_bf16 v[64:79], v[84:87], v[100:103], v[64:79]
    s_waitcnt lgkmcnt(3)
    v_mfma_f32_32x32x16_bf16 v[64:79], v[88:91], v[104:107], v[64:79]
    s_waitcnt lgkmcnt(0)
    v_mfma_f32_32x32x16_bf16 v[64:79], v[92:95], v[108:111], v[64:79]
    s_waitcnt vmcnt(0)
    s_barrier
    ds_read_b128 v[80:83], v26 offset:0
    ds_read_b64_tr_b16 v[96:97], v30 offset:0
    ds_read_b64_tr_b16 v[98:99], v30 offset:512
    ds_read_b128 v[84:87], v27 offset:0
    ds_read_b64_tr_b16 v[100:101], v30 offset:2048
    ds_read_b64_tr_b16 v[102:103], v30 offset:2560
    ds_read_b128 v[88:91], v28 offset:0
    ds_read_b64_tr_b16 v[104:105], v30 offset:4096
    ds_read_b64_tr_b16 v[106:107], v30 offset:4608
    ds_read_b128 v[92:95], v29 offset:0
    ds_read_b64_tr_b16 v[108:109], v30 offset:6144
    ds_read_b64_tr_b16 v[110:111], v30 offset:6656
    s_waitcnt lgkmcnt(9)
    v_mfma_f32_32x32x16_bf16 v[64:79], v[80:83], v[96:99], v[64:79]
    s_waitcnt lgkmcnt(6)
    v_mfma_f32_32x32x16_bf16 v[64:79], v[84:87], v[100:103], v[64:79]
    s_waitcnt lgkmcnt(3)
    v_mfma_f32_32x32x16_bf16 v[64:79], v[88:91], v[104:107], v[64:79]
    s_waitcnt lgkmcnt(0)
    v_mfma_f32_32x32x16_bf16 v[64:79], v[92:95], v[108:111], v[64:79]
    s_nop 15
    s_barrier
    v_and_b32 v12, 31, v0
    v_bfe_u32 v13, v0, 5, 1
    s_lshl_b32 s33, s31, 5
    v_lshl_add_u32 v14, v13, 2, s33
    v_mul_u32_u24 v14, 144, v14
    s_lshl_b32 s33, s32, 5
    v_add_u32 v12, s33, v12
    v_lshl_add_u32 v14, v12, 1, v14
    v_cvt_pk_bf16_f32 v16, v64, v65
    v_lshlrev_b32 v17, 16, v16
    v_and_b32 v18, 0xffff0000, v16
    v_lshlrev_b32 v19, 16, v40
    v_and_b32 v16, 0xffff0000, v40
    v_add_f32 v17, v17, v19
    v_add_f32 v18, v18, v16
    v_cvt_pk_bf16_f32 v40, v17, v18
    ds_write_b16 v14, v40 offset:0
    ds_write_b16_d16_hi v14, v40 offset:144
    v_cvt_pk_bf16_f32 v16, v66, v67
    v_lshlrev_b32 v17, 16, v16
    v_and_b32 v18, 0xffff0000, v16
    v_lshlrev_b32 v19, 16, v41
    v_and_b32 v16, 0xffff0000, v41
    v_add_f32 v17, v17, v19
    v_add_f32 v18, v18, v16
    v_cvt_pk_bf16_f32 v41, v17, v18
    ds_write_b16 v14, v41 offset:288
    ds_write_b16_d16_hi v14, v41 offset:432
    v_cvt_pk_bf16_f32 v16, v68, v69
    v_lshlrev_b32 v17, 16, v16
    v_and_b32 v18, 0xffff0000, v16
    v_lshlrev_b32 v19, 16, v42
    v_and_b32 v16, 0xffff0000, v42
    v_add_f32 v17, v17, v19
    v_add_f32 v18, v18, v16
    v_cvt_pk_bf16_f32 v42, v17, v18
    ds_write_b16 v14, v42 offset:1152
    ds_write_b16_d16_hi v14, v42 offset:1296
    v_cvt_pk_bf16_f32 v16, v70, v71
    v_lshlrev_b32 v17, 16, v16
    v_and_b32 v18, 0xffff0000, v16
    v_lshlrev_b32 v19, 16, v43
    v_and_b32 v16, 0xffff0000, v43
    v_add_f32 v17, v17, v19
    v_add_f32 v18, v18, v16
    v_cvt_pk_bf16_f32 v43, v17, v18
    ds_write_b16 v14, v43 offset:1440
    ds_write_b16_d16_hi v14, v43 offset:1584
    v_cvt_pk_bf16_f32 v16, v72, v73
    v_lshlrev_b32 v17, 16, v16
    v_and_b32 v18, 0xffff0000, v16
    v_lshlrev_b32 v19, 16, v44
    v_and_b32 v16, 0xffff0000, v44
    v_add_f32 v17, v17, v19
    v_add_f32 v18, v18, v16
    v_cvt_pk_bf16_f32 v44, v17, v18
    ds_write_b16 v14, v44 offset:2304
    ds_write_b16_d16_hi v14, v44 offset:2448
    v_cvt_pk_bf16_f32 v16, v74, v75
    v_lshlrev_b32 v17, 16, v16
    v_and_b32 v18, 0xffff0000, v16
    v_lshlrev_b32 v19, 16, v45
    v_and_b32 v16, 0xffff0000, v45
    v_add_f32 v17, v17, v19
    v_add_f32 v18, v18, v16
    v_cvt_pk_bf16_f32 v45, v17, v18
    ds_write_b16 v14, v45 offset:2592
    ds_write_b16_d16_hi v14, v45 offset:2736
    v_cvt_pk_bf16_f32 v16, v76, v77
    v_lshlrev_b32 v17, 16, v16
    v_and_b32 v18, 0xffff0000, v16
    v_lshlrev_b32 v19, 16, v46
    v_and_b32 v16, 0xffff0000, v46
    v_add_f32 v17, v17, v19
    v_add_f32 v18, v18, v16
    v_cvt_pk_bf16_f32 v46, v17, v18
    ds_write_b16 v14, v46 offset:3456
    ds_write_b16_d16_hi v14, v46 offset:3600
    v_cvt_pk_bf16_f32 v16, v78, v79
    v_lshlrev_b32 v17, 16, v16
    v_and_b32 v18, 0xffff0000, v16
    v_lshlrev_b32 v19, 16, v47
    v_and_b32 v16, 0xffff0000, v47
    v_add_f32 v17, v17, v19
    v_add_f32 v18, v18, v16
    v_cvt_pk_bf16_f32 v47, v17, v18
    ds_write_b16 v14, v47 offset:3744
    ds_write_b16_d16_hi v14, v47 offset:3888
    s_waitcnt lgkmcnt(0)
    s_barrier
    v_lshrrev_b32 v12, 2, v0
    v_and_b32 v13, 3, v0
    v_mul_u32_u24 v14, 144, v12
    v_lshl_add_u32 v14, v13, 5, v14
    ds_read_b128 v[48:51], v14
    ds_read_b128 v[52:55], v14 offset:16
    s_lshl_b32 s33, s29, 6
    v_add_u32 v12, s33, v12
    s_waitcnt lgkmcnt(0)
    v_lshlrev_b32 v12, 10, v12
    v_lshl_add_u32 v12, v13, 5, v12
    s_lshl_b32 s33, s28, 7
    v_add_u32 v12, s33, v12
    buffer_store_dwordx4 v[48:51], v12, s[24:27], 0 offen
    buffer_store_dwordx4 v[52:55], v12, s[24:27], 0 offen offset:16
    s_mov_b64 exec, -1
gemm2b_kernel_end:
    s_endpgm
.section .rodata,"a"
.p2align 6
.amdhsa_kernel gemm2b_kernel
  .amdhsa_next_free_vgpr 128
  .amdhsa_next_free_sgpr 102
  .amdhsa_accum_offset 128
  .amdhsa_group_segment_fixed_size 0
  .amdhsa_kernarg_size 112
  .amdhsa_user_sgpr_count 2
  .amdhsa_user_sgpr_kernarg_segment_ptr 1
  .amdhsa_system_sgpr_workgroup_id_x 1
.end_amdhsa_kernel
.text
```
